```python
import torch

def _softmax(x, axis=-1):
    return torch.softmax(x, dim=axis)

def _gelu(x):
    return torch.nn.functional.gelu(x, approximate='tanh')

def _silu(x):
    return torch.nn.functional.silu(x)

def _sigmoid(x):
    return torch.sigmoid(x)

def _layernorm(x, axis=-1, eps=1e-05):
    m = x.mean(dim=axis, keepdim=True)
    v = x.var(dim=axis, keepdim=True, unbiased=False)
    return (x - m) / torch.sqrt(v + eps)

def _scatter_add(tgt, idx, src, axis=0):
    return tgt.clone().index_add_(axis, idx, src)

def _segment_sum(src, seg, n):
    out = torch.zeros((n,) + src.shape[1:], dtype=src.dtype)
    return out.index_add_(0, seg, src)

def _pad(x, pw):
    flat = tuple((v for pair in reversed(pw) for v in pair))
    return torch.nn.functional.pad(x, flat)
kernel_name = 'adaLN_cond__sliding_block_cached__glu_gated_bilinear__prompt'

def setup_inputs():

    _w = lambda a: (lambda t: t.to(torch.bfloat16) if t.is_floating_point() else t)(torch.as_tensor(a))

    def _A_setup():
        B, Sq, D = (1, 2048, 512)
        Hq, Hkv, Sk, Dh = (32, 32, 2048, 128)
        assert Hq % Hkv == 0, (Hq, Hkv)
        return {'x': _w((lambda *s: torch.randn(*s, dtype=torch.bfloat16) * 0.05)(B, Sq, D)), 'k_cache': _w((lambda *s: torch.randn(*s, dtype=torch.bfloat16) * 1.6)(B, Hkv, Sk, Dh)), 'v_cache': _w((lambda *s: torch.randn(*s, dtype=torch.bfloat16) * 0.8)(B, Hkv, Sk, Dh)), 'wq': _w((lambda *s: torch.randn(*s, dtype=torch.bfloat16) * 1.6)(D, Hq * Dh) * D ** (-0.5)), 'wo': _w((lambda *s: torch.randn(*s, dtype=torch.bfloat16) * 0.8)(Hq * Dh, D) * (Hq * Dh) ** (-0.5))}
    _A_in = _A_setup()

    def _B_setup():
        B, S, D, F = (1, 2048, 512, 1376)
        return {'x': _w((lambda *s: torch.randn(*s, dtype=torch.bfloat16) * 0.05)(B, S, D)), 'w_gate': _w((lambda *s: torch.randn(*s, dtype=torch.bfloat16) * 0.4)(D, F) * D ** (-0.5)), 'w_up': _w((lambda *s: torch.randn(*s, dtype=torch.bfloat16) * 0.4)(D, F) * D ** (-0.5)), 'w_down': _w((lambda *s: torch.randn(*s, dtype=torch.bfloat16) * 0.4)(F, D) * F ** (-0.5))}
    _B_in = _B_setup()
    return {'A_x': _A_in['x'], 'A_k_cache': _A_in['k_cache'], 'A_v_cache': _A_in['v_cache'], 'A_wq': _A_in['wq'], 'A_wo': _A_in['wo'], 'B_x': _B_in['x'], 'B_w_gate': _B_in['w_gate'], 'B_w_up': _B_in['w_up'], 'B_w_down': _B_in['w_down'], 'c': _w((lambda *s: torch.randn(*s, dtype=torch.bfloat16) * 0.2)(1, 512) * 8.0), 'w_mod': _w((lambda *s: torch.randn(*s, dtype=torch.bfloat16) * 0.2)(512, 6 * 512) * 512 ** (-0.5) * 8.0)}

def reference(A_x, A_k_cache, A_v_cache, A_wq, A_wo, B_x, B_w_gate, B_w_up, B_w_down, c, w_mod):

    def _A_ref(x, k_cache, v_cache, wq, wo):
        B, Sq, D = x.shape
        Hq, Dh = (32, 128)
        Hkv, Sk = (k_cache.shape[1], k_cache.shape[2])
        W = min(4096, max(256, Sk // 4))
        rep = Hq // Hkv
        q = (lambda x, *d: x.permute(*d))((x @ wq).reshape(B, Sq, Hq, Dh), 0, 2, 1, 3)
        k = (lambda x, n, axis: torch.repeat_interleave(x, n, dim=axis))(k_cache[:, :, Sk - W:, :], rep, axis=1)
        v = (lambda x, n, axis: torch.repeat_interleave(x, n, dim=axis))(v_cache[:, :, Sk - W:, :], rep, axis=1)
        scores = torch.einsum('bhqd,bhkd->bhqk', q, k) * Dh ** (-0.5)
        p = _softmax(scores, axis=-1)
        o = torch.einsum('bhqk,bhkd->bhqd', p, v)
        return (lambda x, *d: x.permute(*d))(o, 0, 2, 1, 3).reshape(B, Sq, Hq * Dh) @ wo

    def _B_ref(x, w_gate, w_up, w_down):
        g = torch.einsum('bsd,df->bsf', x, w_gate)
        u = torch.einsum('bsd,df->bsf', x, w_up)
        h = g * u
        return torch.einsum('bsf,fd->bsd', h, w_down)
    x = A_x
    mod = (_silu(c) @ w_mod).reshape(c.shape[0], 6, 1, -1)
    sa, ca, ga, sb, cb, gb = (mod[:, 0].clone(), mod[:, 1].clone(), mod[:, 2].clone(), mod[:, 3].clone(), mod[:, 4].clone(), mod[:, 5].clone())
    h = _layernorm(x, axis=-1) * (1 + ca) + sa
    x = x + ga * _A_ref(h, A_k_cache, A_v_cache, A_wq, A_wo)
    h = _layernorm(x, axis=-1) * (1 + cb) + sb
    x = x + gb * _B_ref(h, B_w_gate, B_w_up, B_w_down)
    return x
```

```asm
; @launch grid=(256,1,1) block=(256,1,1) lds=163840
.amdgcn_target "amdgcn-amd-amdhsa--gfx950"
.text
.globl adaLN_cond__sliding_block_cached__glu_gated_bilinear__prompt_kernel
.p2align 8
.type adaLN_cond__sliding_block_cached__glu_gated_bilinear__prompt_kernel,@function
adaLN_cond__sliding_block_cached__glu_gated_bilinear__prompt_kernel:
  s_cmp_ge_u32 s2, 256
  s_cbranch_scc1 adaLN_cond__sliding_block_cached__glu_gated_bilinear__prompt_kernel_end
  s_lshr_b32 s24, s2, 3
  s_sub_u32 s24, s24, 0
  s_cmp_ge_u32 s24, 2
  s_cbranch_scc1 Lcodepf1
  s_getpc_b64 s[8:9]
  s_and_b32 s8, s8, 0xffffff00
  s_mov_b32 s10, adaLN_cond__sliding_block_cached__glu_gated_bilinear__prompt_kernel_end - adaLN_cond__sliding_block_cached__glu_gated_bilinear__prompt_kernel + 256
  s_mov_b32 s11, 0x20000
  v_lshlrev_b32 v2, 7, v0
  s_lshl_b32 s24, s24, 15
  buffer_load_dword v251, v2, s[8:11], s24 offen
Lcodepf1:
  s_load_dwordx16 s[64:79], s[0:1], 0
  s_load_dwordx8 s[80:87], s[0:1], 64
  s_load_dwordx4 s[88:91], s[0:1], 96
  v_lshrrev_b32 v1, 6, v0
  v_and_b32 v0, 63, v0
  s_nop 0
  v_readfirstlane_b32 s3, v1
  s_waitcnt lgkmcnt(0)
  s_mov_b32 s4, s90
  s_mov_b32 s5, s91
  s_mov_b32 s6, 0x10000000
  s_mov_b32 s7, 0x20000
  s_mov_b32 s100, 0xffff0000
  s_mov_b32 s56, s88
  s_mov_b32 s57, s89
  s_mov_b32 s58, 0x100
  s_mov_b32 s59, 0x20000
  s_lshl_b32 s24, s3, 6
  v_add_u32 v3, s24, v0
  s_cmp_ge_u32 s2, 96
  s_cbranch_scc1 Lnotp02
  s_mov_b32 s8, s82
  s_mov_b32 s9, s83
  s_mov_b32 s10, 0x400
  s_mov_b32 s11, 0x20000
  s_mov_b32 s12, s84
  s_mov_b32 s13, s85
  s_mov_b32 s14, 0x300000
  s_mov_b32 s15, 0x20000
  v_lshlrev_b32 v80, 2, v0
  s_lshl_b32 s26, s3, 8
  buffer_load_dword v84, v80, s[8:11], s26 offen
  v_lshrrev_b32 v81, 2, v0
  v_mul_u32_u24 v81, 6144, v81
  v_and_b32 v82, 3, v0
  v_lshl_add_u32 v81, v82, 4, v81
  s_and_b32 s37, s2, 7
  s_lshl_b32 s37, s37, 1
  s_bfe_u32 s38, s2, 0x10003
  s_or_b32 s37, s37, s38
  s_and_b32 s38, s2, 0x70
  s_or_b32 s37, s37, s38
  s_mul_i32 s27, s3, 786432
  s_lshl_b32 s28, s37, 6
  s_add_u32 s27, s27, s28
  s_lshl_b32 s28, s3, 13
  s_add_u32 m0, s28, 0
  s_add_u32 s29, s27, 0
  buffer_load_dwordx4 v81, s[12:15], s29 offen lds
  s_add_u32 m0, s28, 1024
  s_add_u32 s29, s27, 98304
  buffer_load_dwordx4 v81, s[12:15], s29 offen lds
  s_add_u32 m0, s28, 2048
  s_add_u32 s29, s27, 196608
  buffer_load_dwordx4 v81, s[12:15], s29 offen lds
  s_add_u32 m0, s28, 3072
  s_add_u32 s29, s27, 294912
  buffer_load_dwordx4 v81, s[12:15], s29 offen lds
  s_add_u32 m0, s28, 4096
  s_add_u32 s29, s27, 393216
  buffer_load_dwordx4 v81, s[12:15], s29 offen lds
  s_add_u32 m0, s28, 5120
  s_add_u32 s29, s27, 491520
  buffer_load_dwordx4 v81, s[12:15], s29 offen lds
  s_add_u32 m0, s28, 6144
  s_add_u32 s29, s27, 589824
  buffer_load_dwordx4 v81, s[12:15], s29 offen lds
  s_add_u32 m0, s28, 7168
  s_add_u32 s29, s27, 688128
  buffer_load_dwordx4 v81, s[12:15], s29 offen lds
Lnotp02:
  s_cmp_lg_u32 s2, 255
  s_cbranch_scc1 Lnotclr3
  v_lshlrev_b32 v80, 4, v3
  s_waitcnt vmcnt(8)
  v_mov_b32 v84, -1
  v_mov_b32 v85, -1
  v_mov_b32 v86, -1
  v_mov_b32 v87, -1
  s_mov_b32 s26, 0
  buffer_store_dwordx4 v[84:87], v80, s[4:7], s26 offen sc1
  s_mov_b32 s26, 4096
  buffer_store_dwordx4 v[84:87], v80, s[4:7], s26 offen sc1
  s_mov_b32 s26, 8192
  buffer_store_dwordx4 v[84:87], v80, s[4:7], s26 offen sc1
  v_lshlrev_b32 v80, 7, v3
  v_mov_b32 v88, 0
  v_cmp_gt_u32 vcc, 88, v3
  s_nop 2
  s_and_saveexec_b64 s[34:35], vcc
  s_mov_b32 s26, 0x10000
  buffer_store_dword v88, v80, s[4:7], s26 offen sc1
  s_mov_b64 exec, s[34:35]
  s_waitcnt vmcnt(0)
  s_barrier
  s_cmp_lg_u32 s3, 0
  s_cbranch_scc1 Lnotclr3
  v_mov_b32 v88, 1
  buffer_store_dword v88, off, s[56:59], 0 sc1
Lnotclr3:
  s_mov_b32 s16, s64
  s_mov_b32 s17, s65
  s_mov_b32 s18, 0x200000
  s_mov_b32 s19, 0x20000
  v_and_b32 v1, 7, v0
  v_lshrrev_b32 v2, 3, v3
  v_and_b32 v5, 3, v2
  v_lshrrev_b32 v6, 2, v2
  v_lshlrev_b32 v4, 10, v1
  v_lshl_add_u32 v4, v6, 7, v4
  v_lshl_add_u32 v4, v5, 3, v4
  s_lshl_b32 s36, s2, 13
  buffer_load_dwordx2 v[8:9], v4, s[16:19], s36 offen offset:0
  buffer_load_dwordx2 v[10:11], v4, s[16:19], s36 offen offset:32
  buffer_load_dwordx2 v[12:13], v4, s[16:19], s36 offen offset:64
  buffer_load_dwordx2 v[14:15], v4, s[16:19], s36 offen offset:96
  v_lshlrev_b32 v7, 8, v6
  v_lshl_add_u32 v7, v5, 4, v7
  v_lshlrev_b32 v74, 11, v6
  v_lshl_add_u32 v74, v5, 8, v74
  s_and_b32 s24, s2, 1
  s_lshl_b32 s24, s24, 3
  v_add_u32 v6, s24, v1
  v_lshl_add_u32 v6, v6, 4, v74
  s_cmp_ge_u32 s2, 96
  s_cbranch_scc1 Lnop05
  s_waitcnt vmcnt(12)
  v_lshlrev_b32 v64, 16, v84
  v_and_b32 v65, s100, v84
  v_mul_f32 v66, 0xbfb8aa3b, v64
  v_mul_f32 v67, 0xbfb8aa3b, v65
  v_exp_f32 v66, v66
  v_exp_f32 v67, v67
  v_add_f32 v66, 1.0, v66
  v_add_f32 v67, 1.0, v67
  v_rcp_f32 v66, v66
  v_rcp_f32 v67, v67
  v_mul_f32 v64, v64, v66
  v_mul_f32 v65, v65, v67
  v_cvt_pk_bf16_f32 v64, v64, v65
  s_lshl_b32 s26, s3, 8
  s_add_u32 s26, s26, 32768
  v_lshl_add_u32 v65, v0, 2, s26
  ds_write_b32 v65, v64
  v_lshrrev_b32 v66, 4, v0
  v_lshl_add_u32 v67, v66, 4, s26
  v_bfe_u32 v68, v0, 2, 2
  v_lshl_add_u32 v68, v66, 3, v68
  v_lshlrev_b32 v68, 6, v68
  v_and_b32 v69, 3, v0
  v_lshl_add_u32 v68, v69, 3, v68
  s_lshl_b32 s27, s3, 13
  v_add_u32 v68, s27, v68
  s_waitcnt lgkmcnt(0)
  ds_read_b128 v[96:99], v67 offset:0
  ds_read_b128 v[100:103], v67 offset:64
  ds_read_b128 v[104:107], v67 offset:128
  ds_read_b128 v[108:111], v67 offset:192
  s_waitcnt vmcnt(4)
  buffer_load_dword v71, off, s[56:59], 0 sc1
  ds_read_b64_tr_b16 v[112:113], v68 offset:0
  ds_read_b64_tr_b16 v[114:115], v68 offset:256
  ds_read_b64_tr_b16 v[116:117], v68 offset:32
  ds_read_b64_tr_b16 v[118:119], v68 offset:288
  ds_read_b64_tr_b16 v[120:121], v68 offset:2048
  ds_read_b64_tr_b16 v[122:123], v68 offset:2304
  ds_read_b64_tr_b16 v[124:125], v68 offset:2080
  ds_read_b64_tr_b16 v[126:127], v68 offset:2336
  ds_read_b64_tr_b16 v[128:129], v68 offset:4096
  ds_read_b64_tr_b16 v[130:131], v68 offset:4352
  ds_read_b64_tr_b16 v[132:133], v68 offset:4128
  ds_read_b64_tr_b16 v[134:135], v68 offset:4384
  ds_read_b64_tr_b16 v[136:137], v68 offset:6144
  ds_read_b64_tr_b16 v[138:139], v68 offset:6400
  ds_read_b64_tr_b16 v[140:141], v68 offset:6176
  ds_read_b64_tr_b16 v[142:143], v68 offset:6432
  s_waitcnt lgkmcnt(11)
  v_mfma_f32_16x16x32_bf16 v[144:147], v[112:115], v[96:99], 0
  v_mfma_f32_16x16x32_bf16 v[148:151], v[116:119], v[96:99], 0
  s_waitcnt lgkmcnt(9)
  v_mfma_f32_16x16x32_bf16 v[144:147], v[120:123], v[100:103], v[144:147]
  s_waitcnt lgkmcnt(8)
  v_mfma_f32_16x16x32_bf16 v[148:151], v[124:127], v[100:103], v[148:151]
  s_waitcnt lgkmcnt(6)
  v_mfma_f32_16x16x32_bf16 v[144:147], v[128:131], v[104:107], v[144:147]
  s_waitcnt lgkmcnt(4)
  v_mfma_f32_16x16x32_bf16 v[148:151], v[132:135], v[104:107], v[148:151]
  s_waitcnt lgkmcnt(2)
  v_mfma_f32_16x16x32_bf16 v[144:147], v[136:139], v[108:111], v[144:147]
  s_waitcnt lgkmcnt(0)
  v_mfma_f32_16x16x32_bf16 v[148:151], v[140:143], v[108:111], v[148:151]
  s_lshl_b32 s26, s3, 7
  s_add_u32 s26, s26, 34816
  v_lshl_add_u32 v69, v66, 4, s26
  s_nop 2
  ds_write_b128 v69, v[144:147]
  s_nop 0
  ds_write_b128 v69, v[148:151] offset:64
  s_waitcnt lgkmcnt(0)
  s_barrier
  v_and_b32 v70, 31, v0
  v_lshlrev_b32 v70, 2, v70
  ds_read_b32 v96, v70 offset:34816
  ds_read_b32 v97, v70 offset:34944
  ds_read_b32 v98, v70 offset:35072
  ds_read_b32 v99, v70 offset:35200
  s_waitcnt lgkmcnt(2)
  v_add_f32 v96, v96, v97
  s_waitcnt lgkmcnt(0)
  v_add_f32 v98, v98, v99
  v_add_f32 v96, v96, v98
  v_cvt_pk_bf16_f32 v96, v96, v96
  v_and_b32 v96, s100, v96
  v_add_f32 v97, 1.0, v96
  v_cvt_pk_bf16_f32 v97, v97, v97
  v_and_b32 v97, s100, v97
  v_mul_f32 v98, 0x3e0293ee, v96
  s_lshr_b32 s26, s37, 4
  s_cmp_eq_u32 s26, 0
  s_cselect_b64 vcc, -1, 0
  v_cndmask_b32 v96, v96, v98, vcc
  s_cmp_eq_u32 s26, 1
  s_cselect_b64 vcc, -1, 0
  v_cndmask_b32 v96, v96, v97, vcc
  s_cmp_eq_u32 s26, 4
  s_cselect_b64 vcc, -1, 0
  v_cndmask_b32 v96, v96, v97, vcc
  s_waitcnt vmcnt(0)
  v_readfirstlane_b32 s62, v71
  s_nop 3
  s_cmp_lg_u32 s62, 0
  s_cbranch_scc1 Lisready6
  s_mov_b32 s61, 100000
Lrdy7:
  buffer_load_dword v255, off, s[56:59], 0 sc1
  s_waitcnt vmcnt(0)
  v_readfirstlane_b32 s62, v255
  s_nop 3
  s_cmp_lg_u32 s62, 0
  s_cbranch_scc1 Lrdyok8
  s_sub_u32 s61, s61, 1
  s_cmp_lg_u32 s61, 0
  s_cbranch_scc1 Lrdy7
Lrdyok8:
Lisready6:
  s_lshl_b32 s27, s37, 7
  s_cmp_lg_u32 s3, 0
  s_cbranch_scc1 Lp0done4
  s_mov_b32 exec_hi, 0
  buffer_store_dword v96, v70, s[4:7], s27 offen offset:0 sc1
  s_mov_b32 exec_hi, -1
  s_branch Lp0done4
Lnop05:
  s_waitcnt vmcnt(0)
Lp0done4:
  v_lshlrev_b32 v16, 16, v8
  v_and_b32 v17, s100, v8
  v_lshlrev_b32 v18, 16, v9
  v_and_b32 v19, s100, v9
  v_lshlrev_b32 v20, 16, v10
  v_and_b32 v21, s100, v10
  v_lshlrev_b32 v22, 16, v11
  v_and_b32 v23, s100, v11
  v_lshlrev_b32 v24, 16, v12
  v_and_b32 v25, s100, v12
  v_lshlrev_b32 v26, 16, v13
  v_and_b32 v27, s100, v13
  v_lshlrev_b32 v28, 16, v14
  v_and_b32 v29, s100, v14
  v_lshlrev_b32 v30, 16, v15
  v_and_b32 v31, s100, v15
  s_cmp_lt_u32 s2, 96
  s_cbranch_scc1 Lpf9
  s_mov_b32 s28, s70
  s_mov_b32 s29, s71
  s_mov_b32 s30, 0x400000
  s_mov_b32 s31, 0x20000
  v_lshrrev_b32 v72, 4, v0
  v_lshlrev_b32 v72, 13, v72
  v_and_b32 v73, 15, v0
  v_lshl_add_u32 v72, v73, 7, v72
  s_lshr_b32 s32, s2, 3
  s_sub_u32 s32, s32, 12
  s_lshl_b32 s32, s32, 2
  s_add_u32 s32, s32, s3
  s_lshl_b32 s32, s32, 16
  s_bfe_u32 s33, s2, 0x20001
  s_lshl_b32 s33, s33, 11
  s_add_u32 s32, s32, s33
  s_add_u32 s33, s32, 32768
  buffer_load_dword v250, v72, s[28:31], s32 offen
  buffer_load_dword v250, v72, s[28:31], s33 offen
  s_cmp_ge_u32 s3, 2
  s_cselect_b32 s28, s68, s66
  s_cselect_b32 s29, s69, s67
  s_mov_b32 s30, 0x1000000
  s_mov_b32 s31, 0x20000
  s_lshr_b32 s32, s2, 3
  s_sub_u32 s32, s32, 12
  s_lshr_b32 s33, s32, 1
  s_bfe_u32 s34, s2, 0x20001
  s_lshl_b32 s34, s34, 3
  s_add_u32 s34, s34, s33
  s_lshl_b32 s34, s34, 19
  s_add_u32 s34, s34, 393216
  s_and_b32 s35, s32, 1
  s_lshl_b32 s35, s35, 14
  s_add_u32 s34, s34, s35
  s_and_b32 s35, s3, 1
  s_lshl_b32 s35, s35, 13
  s_add_u32 s34, s34, s35
  s_cmp_ge_u32 s33, 8
  s_cselect_b32 s34, 0x10000000, s34
  v_lshlrev_b32 v72, 7, v0
  buffer_load_dword v250, v72, s[28:31], s34 offen
Lpf9:
  v_lshlrev_b32 v39, 4, v1
  v_add_u32 v39, 163328, v39
  s_lshl_b32 s63, s3, 2
  v_add_u32 v38, s63, v39
  v_add_f32 v36, v16, v17
  v_add_f32 v36, v36, v18
  v_add_f32 v36, v36, v19
  v_add_f32 v36, v36, v20
  v_add_f32 v36, v36, v21
  v_add_f32 v36, v36, v22
  v_add_f32 v36, v36, v23
  v_add_f32 v36, v36, v24
  v_add_f32 v36, v36, v25
  v_add_f32 v36, v36, v26
  v_add_f32 v36, v36, v27
  v_add_f32 v36, v36, v28
  v_add_f32 v36, v36, v29
  v_add_f32 v36, v36, v30
  v_add_f32 v36, v36, v31
  s_nop 1
  v_add_f32_dpp v32, v36, v36 row_ror:8 row_mask:0xf bank_mask:0xf
  v_mov_b32 v36, v32
  v_mov_b32 v32, v36
  s_nop 1
  v_permlane16_swap_b32 v36, v32
  v_add_f32 v36, v36, v32
  v_mov_b32 v32, v36
  s_nop 1
  v_permlane32_swap_b32 v36, v32
  v_add_f32 v36, v36, v32
  ds_write_b32 v38, v36 offset:0
  s_waitcnt lgkmcnt(0)
  s_barrier
  ds_read_b128 v[32:35], v39 offset:0
  s_waitcnt lgkmcnt(0)
  v_add_f32 v32, v32, v33
  v_add_f32 v34, v34, v35
  v_add_f32 v36, v32, v34
  v_mul_f32 v36, 0x3b000000, v36
  v_sub_f32 v16, v16, v36
  v_sub_f32 v17, v17, v36
  v_sub_f32 v18, v18, v36
  v_sub_f32 v19, v19, v36
  v_sub_f32 v20, v20, v36
  v_sub_f32 v21, v21, v36
  v_sub_f32 v22, v22, v36
  v_sub_f32 v23, v23, v36
  v_sub_f32 v24, v24, v36
  v_sub_f32 v25, v25, v36
  v_sub_f32 v26, v26, v36
  v_sub_f32 v27, v27, v36
  v_sub_f32 v28, v28, v36
  v_sub_f32 v29, v29, v36
  v_sub_f32 v30, v30, v36
  v_sub_f32 v31, v31, v36
  v_mul_f32 v36, v16, v16
  v_fmac_f32 v36, v17, v17
  v_fmac_f32 v36, v18, v18
  v_fmac_f32 v36, v19, v19
  v_fmac_f32 v36, v20, v20
  v_fmac_f32 v36, v21, v21
  v_fmac_f32 v36, v22, v22
  v_fmac_f32 v36, v23, v23
  v_fmac_f32 v36, v24, v24
  v_fmac_f32 v36, v25, v25
  v_fmac_f32 v36, v26, v26
  v_fmac_f32 v36, v27, v27
  v_fmac_f32 v36, v28, v28
  v_fmac_f32 v36, v29, v29
  v_fmac_f32 v36, v30, v30
  v_fmac_f32 v36, v31, v31
  s_nop 1
  v_add_f32_dpp v32, v36, v36 row_ror:8 row_mask:0xf bank_mask:0xf
  v_mov_b32 v36, v32
  v_mov_b32 v32, v36
  s_nop 1
  v_permlane16_swap_b32 v36, v32
  v_add_f32 v36, v36, v32
  v_mov_b32 v32, v36
  s_nop 1
  v_permlane32_swap_b32 v36, v32
  v_add_f32 v36, v36, v32
  ds_write_b32 v38, v36 offset:128
  s_waitcnt lgkmcnt(0)
  s_barrier
  ds_read_b128 v[32:35], v39 offset:128
  s_waitcnt lgkmcnt(0)
  v_add_f32 v32, v32, v33
  v_add_f32 v34, v34, v35
  v_add_f32 v36, v32, v34
  v_mov_b32 v32, 0x3727c5ac
  v_fmac_f32 v32, 0x3b000000, v36
  v_rsq_f32 v32, v32
  s_nop 0
  v_mul_f32 v32, 0x3e0293ee, v32
  v_mul_f32 v16, v16, v32
  v_mul_f32 v17, v17, v32
  v_mul_f32 v18, v18, v32
  v_mul_f32 v19, v19, v32
  v_mul_f32 v20, v20, v32
  v_mul_f32 v21, v21, v32
  v_mul_f32 v22, v22, v32
  v_mul_f32 v23, v23, v32
  v_mul_f32 v24, v24, v32
  v_mul_f32 v25, v25, v32
  v_mul_f32 v26, v26, v32
  v_mul_f32 v27, v27, v32
  v_mul_f32 v28, v28, v32
  v_mul_f32 v29, v29, v32
  v_mul_f32 v30, v30, v32
  v_mul_f32 v31, v31, v32
  s_mov_b32 s61, 100000
Lrdy10:
  buffer_load_dword v255, off, s[56:59], 0 sc1
  s_waitcnt vmcnt(0)
  v_readfirstlane_b32 s62, v255
  s_nop 3
  s_cmp_lg_u32 s62, 0
  s_cbranch_scc1 Lrdyok11
  s_sub_u32 s61, s61, 1
  s_cmp_lg_u32 s61, 0
  s_cbranch_scc1 Lrdy10
Lrdyok11:
  s_mov_b32 s61, 100000
Lmod12:
  buffer_load_dwordx4 v[48:51], v7, s[4:7], 0 offen offset:0 sc1
  buffer_load_dwordx4 v[64:67], v7, s[4:7], 0 offen offset:2048 sc1
  buffer_load_dwordx4 v[52:55], v7, s[4:7], 0 offen offset:64 sc1
  buffer_load_dwordx4 v[68:71], v7, s[4:7], 0 offen offset:2112 sc1
  buffer_load_dwordx4 v[56:59], v7, s[4:7], 0 offen offset:128 sc1
  buffer_load_dwordx4 v[72:75], v7, s[4:7], 0 offen offset:2176 sc1
  buffer_load_dwordx4 v[60:63], v7, s[4:7], 0 offen offset:192 sc1
  buffer_load_dwordx4 v[76:79], v7, s[4:7], 0 offen offset:2240 sc1
  s_waitcnt vmcnt(0)
  v_max3_u32 v40, v48, v49, v50
  v_max3_u32 v40, v40, v51, v52
  v_max3_u32 v40, v40, v53, v54
  v_max3_u32 v40, v40, v55, v56
  v_max3_u32 v40, v40, v57, v58
  v_max3_u32 v40, v40, v59, v60
  v_max3_u32 v40, v40, v61, v62
  v_max3_u32 v40, v40, v63, v64
  v_max3_u32 v40, v40, v65, v66
  v_max3_u32 v40, v40, v67, v68
  v_max3_u32 v40, v40, v69, v70
  v_max3_u32 v40, v40, v71, v72
  v_max3_u32 v40, v40, v73, v74
  v_max3_u32 v40, v40, v75, v76
  v_max3_u32 v40, v40, v77, v78
  v_max_u32 v40, v40, v79
  v_cmp_eq_u32 vcc, -1, v40
  s_nop 4
  s_cmp_eq_u64 vcc, 0
  s_cbranch_scc1 Lmodok13
  s_sub_u32 s61, s61, 1
  s_cmp_lg_u32 s61, 0
  s_cbranch_scc1 Lmod12
Lmodok13:
  v_fmac_f32 v48, v16, v64
  v_fmac_f32 v49, v17, v65
  v_fmac_f32 v50, v18, v66
  v_fmac_f32 v51, v19, v67
  v_fmac_f32 v52, v20, v68
  v_fmac_f32 v53, v21, v69
  v_fmac_f32 v54, v22, v70
  v_fmac_f32 v55, v23, v71
  v_fmac_f32 v56, v24, v72
  v_fmac_f32 v57, v25, v73
  v_fmac_f32 v58, v26, v74
  v_fmac_f32 v59, v27, v75
  v_fmac_f32 v60, v28, v76
  v_fmac_f32 v61, v29, v77
  v_fmac_f32 v62, v30, v78
  v_fmac_f32 v63, v31, v79
  v_cvt_pk_bf16_f32 v8, v48, v49
  v_cvt_pk_bf16_f32 v9, v50, v51
  v_cvt_pk_bf16_f32 v10, v52, v53
  v_cvt_pk_bf16_f32 v11, v54, v55
  v_cvt_pk_bf16_f32 v12, v56, v57
  v_cvt_pk_bf16_f32 v13, v58, v59
  v_cvt_pk_bf16_f32 v14, v60, v61
  v_cvt_pk_bf16_f32 v15, v62, v63
  s_lshr_b32 s24, s2, 1
  s_lshl_b32 s24, s24, 14
  s_add_u32 s24, s24, 0x100000
  buffer_store_dwordx4 v[8:11], v6, s[4:7], s24 offen sc1
  buffer_store_dwordx4 v[12:15], v6, s[4:7], s24 offen offset:1024 sc1
  s_lshr_b32 s60, s2, 5
  s_lshl_b32 s60, s60, 7
  s_add_u32 s60, s60, 0x10000
  s_waitcnt vmcnt(0)
  s_barrier
  s_cmp_lg_u32 s3, 0
  s_cbranch_scc1 Lsig14
  s_mov_b64 exec, 1
  v_mov_b32 v255, 1
  buffer_atomic_add v255, off, s[4:7], s60
  s_mov_b64 exec, -1
Lsig14:
  s_and_b32 s40, s2, 7
  s_lshr_b32 s41, s2, 3
  s_lshr_b32 s24, s40, 1
  s_lshl_b32 s24, s24, 3
  s_lshr_b32 s42, s41, 2
  s_add_u32 s24, s24, s42
  s_and_b32 s25, s40, 1
  s_lshl_b32 s25, s25, 2
  s_and_b32 s41, s41, 3
  s_add_u32 s25, s25, s41
  s_mov_b32 s26, s3
  v_lshrrev_b32 v40, 4, v0
  v_and_b32 v41, 15, v0
  v_lshlrev_b32 v42, 1, v40
  v_xor_b32 v42, v42, v41
  v_lshlrev_b32 v42, 4, v42
  v_lshl_add_u32 v10, v40, 8, v42
  v_xor_b32 v11, 128, v10
  v_lshl_add_u32 v2, v40, 13, v42
  v_xor_b32 v44, 128, v2
  v_add_u32 v3, 31744, v44
  v_add_u32 v4, 63488, v2
  v_add_u32 v5, 95232, v44
  v_add_u32 v42, 0, v40
  v_xor_b32 v42, v42, v41
  v_lshlrev_b32 v42, 4, v42
  v_lshl_add_u32 v6, v40, 8, v42
  v_add_u32 v42, 4, v40
  v_xor_b32 v42, v42, v41
  v_lshlrev_b32 v42, 4, v42
  v_lshl_add_u32 v7, v40, 8, v42
  v_add_u32 v42, 8, v40
  v_xor_b32 v42, v42, v41
  v_lshlrev_b32 v42, 4, v42
  v_lshl_add_u32 v8, v40, 8, v42
  v_add_u32 v42, 12, v40
  v_xor_b32 v42, v42, v41
  v_lshlrev_b32 v42, 4, v42
  v_lshl_add_u32 v9, v40, 8, v42
  v_lshlrev_b32 v32, 4, v0
  v_add_u32 v12, 0, v32
  v_add_u32 v13, 16384, v32
  v_add_u32 v14, 32768, v32
  v_add_u32 v15, 49152, v32
  v_bfe_u32 v42, v0, 2, 2
  v_lshl_add_u32 v43, v40, 2, v42
  v_and_b32 v44, 7, v43
  v_lshlrev_b32 v43, 8, v43
  v_and_b32 v45, 3, v0
  v_lshl_add_u32 v43, v45, 3, v43
  v_xor_b32 v45, 0, v44
  v_lshl_add_u32 v16, v45, 5, v43
  v_xor_b32 v45, 1, v44
  v_lshl_add_u32 v17, v45, 5, v43
  v_xor_b32 v45, 2, v44
  v_lshl_add_u32 v18, v45, 5, v43
  v_xor_b32 v45, 3, v44
  v_lshl_add_u32 v19, v45, 5, v43
  v_xor_b32 v45, 4, v44
  v_lshl_add_u32 v20, v45, 5, v43
  v_xor_b32 v45, 5, v44
  v_lshl_add_u32 v21, v45, 5, v43
  v_xor_b32 v45, 6, v44
  v_lshl_add_u32 v22, v45, 5, v43
  v_xor_b32 v45, 7, v44
  v_lshl_add_u32 v23, v45, 5, v43
  v_lshlrev_b32 v44, 1, v44
  v_and_b32 v45, 3, v0
  v_xor_b32 v44, v44, v45
  v_bfe_u32 v42, v0, 2, 2
  v_lshl_add_u32 v43, v40, 2, v42
  v_lshlrev_b32 v43, 8, v43
  v_xor_b32 v45, 0, v44
  v_lshl_add_u32 v28, v45, 4, v43
  v_xor_b32 v45, 4, v44
  v_lshl_add_u32 v29, v45, 4, v43
  v_xor_b32 v45, 8, v44
  v_lshl_add_u32 v30, v45, 4, v43
  v_xor_b32 v45, 12, v44
  v_lshl_add_u32 v31, v45, 4, v43
  v_xor_b32 v42, v40, v41
  v_lshlrev_b32 v43, 8, v41
  v_xor_b32 v44, 0, v42
  v_lshl_add_u32 v24, v44, 4, v43
  v_xor_b32 v44, 4, v42
  v_lshl_add_u32 v25, v44, 4, v43
  v_xor_b32 v44, 8, v42
  v_lshl_add_u32 v26, v44, 4, v43
  v_xor_b32 v44, 12, v42
  v_lshl_add_u32 v27, v44, 4, v43
  s_lshl_b32 s28, s26, 13
  s_lshl_b32 s29, s26, 12
  s_lshl_b32 s40, s24, 8
  s_add_u32 s8, s70, s40
  s_addc_u32 s9, s71, 0
  s_mov_b32 s11, 0x20000
  s_sub_u32 s10, 4194304, s40
  s_lshl_b32 s40, s24, 19
  s_add_u32 s40, s40, 393216
  s_add_u32 s12, s66, s40
  s_addc_u32 s13, s67, 0
  s_mov_b32 s14, 0x20000
  s_mov_b32 s15, 0x20000
  s_add_u32 s16, s68, s40
  s_addc_u32 s17, s69, 0
  s_mov_b32 s18, 0x20000
  s_mov_b32 s19, 0x20000
  s_lshl_b32 s32, s26, 18
  s_lshl_b32 s40, s25, 4
  s_lshl_b32 s41, s26, 2
  s_add_u32 s40, s40, s41
  s_lshl_b32 s33, s40, 14
  s_add_u32 s33, s33, 0x100000
  s_lshl_b32 s43, s40, 17
  s_lshl_b32 s41, s24, 12
  s_add_u32 s43, s43, s41
  s_add_u32 s43, s43, 0x400000
  s_mov_b32 s44, 0
  s_mov_b32 s20, s72
  s_mov_b32 s21, s73
  s_mov_b32 s22, 0x400000
  s_mov_b32 s23, 0x20000
  s_mov_b32 s48, s76
  s_mov_b32 s49, s77
  s_mov_b32 s50, 0x158000
  s_mov_b32 s51, 0x20000
  s_mov_b32 s52, s78
  s_mov_b32 s53, s79
  s_mov_b32 s54, 0x158000
  s_mov_b32 s55, 0x20000
  s_mov_b32 s56, s80
  s_mov_b32 s57, s81
  s_mov_b32 s58, 0x158000
  s_mov_b32 s59, 0x20000
  s_bfe_u32 s30, s2, 0x20001
  s_lshl_b32 s30, s30, 20
  s_lshr_b32 s41, s2, 3
  s_lshl_b32 s41, s41, 15
  s_add_u32 s30, s30, s41
  s_add_u32 s30, s30, s28
  s_add_u32 m0, s28, 0
  s_add_u32 s40, s32, 0
  buffer_load_dwordx4 v2, s[8:11], s40 offen offset:0 lds
  buffer_load_dwordx4 v3, s[8:11], s40 offen offset:1024 lds
  buffer_load_dwordx4 v4, s[8:11], s40 offen offset:2048 lds
  buffer_load_dwordx4 v5, s[8:11], s40 offen offset:3072 lds
  s_add_u32 m0, s28, 4096
  s_add_u32 s40, s32, 131072
  buffer_load_dwordx4 v2, s[8:11], s40 offen offset:0 lds
  buffer_load_dwordx4 v3, s[8:11], s40 offen offset:1024 lds
  buffer_load_dwordx4 v4, s[8:11], s40 offen offset:2048 lds
  buffer_load_dwordx4 v5, s[8:11], s40 offen offset:3072 lds
  s_add_u32 m0, s28, 32768
  s_add_u32 s40, s32, 1048576
  buffer_load_dwordx4 v2, s[8:11], s40 offen offset:0 lds
  buffer_load_dwordx4 v3, s[8:11], s40 offen offset:1024 lds
  buffer_load_dwordx4 v4, s[8:11], s40 offen offset:2048 lds
  buffer_load_dwordx4 v5, s[8:11], s40 offen offset:3072 lds
  s_add_u32 m0, s28, 36864
  s_add_u32 s40, s32, 1179648
  buffer_load_dwordx4 v2, s[8:11], s40 offen offset:0 lds
  buffer_load_dwordx4 v3, s[8:11], s40 offen offset:1024 lds
  buffer_load_dwordx4 v4, s[8:11], s40 offen offset:2048 lds
  buffer_load_dwordx4 v5, s[8:11], s40 offen offset:3072 lds
  s_lshl_b32 s63, s25, 7
  s_add_u32 s63, s63, 0x10000
  s_cmp_lg_u32 s3, 0
  s_cbranch_scc1 Lgot16
  s_mov_b32 s61, 100000
Lpoll15:
  buffer_load_dword v255, off, s[4:7], s63 sc1
  s_waitcnt vmcnt(0)
  v_readfirstlane_b32 s62, v255
  s_nop 3
  s_cmp_ge_u32 s62, 32
  s_cbranch_scc1 Lgot16
  s_sub_u32 s61, s61, 1
  s_cmp_lg_u32 s61, 0
  s_cbranch_scc1 Lpoll15
Lgot16:
  s_barrier
  s_add_u32 s42, s33, 0
  buffer_load_dwordx4 a[0:3], v12, s[4:7], s42 offen offset:0 sc1
  buffer_load_dwordx4 a[4:7], v13, s[4:7], s42 offen offset:0 sc1
  buffer_load_dwordx4 a[8:11], v14, s[4:7], s42 offen offset:0 sc1
  buffer_load_dwordx4 a[12:15], v15, s[4:7], s42 offen offset:0 sc1
  buffer_load_dwordx4 a[16:19], v12, s[4:7], s42 offen offset:1024 sc1
  buffer_load_dwordx4 a[20:23], v13, s[4:7], s42 offen offset:1024 sc1
  buffer_load_dwordx4 a[24:27], v14, s[4:7], s42 offen offset:1024 sc1
  buffer_load_dwordx4 a[28:31], v15, s[4:7], s42 offen offset:1024 sc1
  buffer_load_dwordx4 a[32:35], v12, s[4:7], s42 offen offset:2048 sc1
  buffer_load_dwordx4 a[36:39], v13, s[4:7], s42 offen offset:2048 sc1
  buffer_load_dwordx4 a[40:43], v14, s[4:7], s42 offen offset:2048 sc1
  buffer_load_dwordx4 a[44:47], v15, s[4:7], s42 offen offset:2048 sc1
  buffer_load_dwordx4 a[48:51], v12, s[4:7], s42 offen offset:3072 sc1
  buffer_load_dwordx4 a[52:55], v13, s[4:7], s42 offen offset:3072 sc1
  buffer_load_dwordx4 a[56:59], v14, s[4:7], s42 offen offset:3072 sc1
  buffer_load_dwordx4 a[60:63], v15, s[4:7], s42 offen offset:3072 sc1
  s_waitcnt vmcnt(24)
  s_barrier
  ds_read_b64_tr_b16 v[64:65], v28 offset:0
  ds_read_b64_tr_b16 v[66:67], v28 offset:4096
  ds_read_b64_tr_b16 v[68:69], v28 offset:8
  ds_read_b64_tr_b16 v[70:71], v28 offset:4104
  ds_read_b64_tr_b16 v[72:73], v29 offset:0
  ds_read_b64_tr_b16 v[74:75], v29 offset:4096
  ds_read_b64_tr_b16 v[76:77], v29 offset:8
  ds_read_b64_tr_b16 v[78:79], v29 offset:4104
  ds_read_b64_tr_b16 v[80:81], v30 offset:0
  ds_read_b64_tr_b16 v[82:83], v30 offset:4096
  ds_read_b64_tr_b16 v[84:85], v30 offset:8
  ds_read_b64_tr_b16 v[86:87], v30 offset:4104
  ds_read_b64_tr_b16 v[88:89], v31 offset:0
  ds_read_b64_tr_b16 v[90:91], v31 offset:4096
  ds_read_b64_tr_b16 v[92:93], v31 offset:8
  ds_read_b64_tr_b16 v[94:95], v31 offset:4104
  s_waitcnt vmcnt(15) lgkmcnt(11)
  v_mfma_f32_16x16x32_bf16 v[128:131], v[64:67], a[0:3], 0
  ds_read_b64_tr_b16 v[96:97], v28 offset:8192
  s_waitcnt vmcnt(14)
  v_mfma_f32_16x16x32_bf16 v[132:135], v[64:67], a[4:7], 0
  s_add_u32 s42, s33, 4096
  s_waitcnt vmcnt(13)
  v_mfma_f32_16x16x32_bf16 v[136:139], v[64:67], a[8:11], 0
  ds_read_b64_tr_b16 v[98:99], v28 offset:12288
  s_waitcnt vmcnt(12)
  v_mfma_f32_16x16x32_bf16 v[140:143], v[64:67], a[12:15], 0
  s_add_u32 m0, s28, 65536
  v_mfma_f32_16x16x32_bf16 v[144:147], v[68:71], a[0:3], 0
  ds_read_b64_tr_b16 v[100:101], v28 offset:8200
  v_mfma_f32_16x16x32_bf16 v[148:151], v[68:71], a[4:7], 0
  v_mfma_f32_16x16x32_bf16 v[152:155], v[68:71], a[8:11], 0
  ds_read_b64_tr_b16 v[102:103], v28 offset:12296
  v_mfma_f32_16x16x32_bf16 v[156:159], v[68:71], a[12:15], 0
  buffer_load_dwordx4 a[64:67], v12, s[4:7], s42 offen offset:0 sc1
  s_add_u32 s40, s32, 2097152
  s_waitcnt lgkmcnt(3)
  v_mfma_f32_16x16x32_bf16 v[160:163], v[72:75], a[0:3], 0
  ds_read_b64_tr_b16 v[104:105], v29 offset:8192
  v_mfma_f32_16x16x32_bf16 v[164:167], v[72:75], a[4:7], 0
  v_mfma_f32_16x16x32_bf16 v[168:171], v[72:75], a[8:11], 0
  ds_read_b64_tr_b16 v[106:107], v29 offset:12288
  v_mfma_f32_16x16x32_bf16 v[172:175], v[72:75], a[12:15], 0
  buffer_load_dwordx4 v2, s[8:11], s40 offen offset:0 lds
  v_mfma_f32_16x16x32_bf16 v[176:179], v[76:79], a[0:3], 0
  ds_read_b64_tr_b16 v[108:109], v29 offset:8200
  v_mfma_f32_16x16x32_bf16 v[180:183], v[76:79], a[4:7], 0
  buffer_load_dwordx4 a[68:71], v13, s[4:7], s42 offen offset:0 sc1
  v_mfma_f32_16x16x32_bf16 v[184:187], v[76:79], a[8:11], 0
  ds_read_b64_tr_b16 v[110:111], v29 offset:12296
  v_mfma_f32_16x16x32_bf16 v[188:191], v[76:79], a[12:15], 0
  buffer_load_dwordx4 v3, s[8:11], s40 offen offset:1024 lds
  v_mfma_f32_16x16x32_bf16 v[192:195], v[80:83], a[0:3], 0
  ds_read_b64_tr_b16 v[112:113], v30 offset:8192
  v_mfma_f32_16x16x32_bf16 v[196:199], v[80:83], a[4:7], 0
  v_mfma_f32_16x16x32_bf16 v[200:203], v[80:83], a[8:11], 0
  ds_read_b64_tr_b16 v[114:115], v30 offset:12288
  v_mfma_f32_16x16x32_bf16 v[204:207], v[80:83], a[12:15], 0
  buffer_load_dwordx4 a[72:75], v14, s[4:7], s42 offen offset:0 sc1
  buffer_load_dwordx4 v4, s[8:11], s40 offen offset:2048 lds
  v_mfma_f32_16x16x32_bf16 v[208:211], v[84:87], a[0:3], 0
  ds_read_b64_tr_b16 v[116:117], v30 offset:8200
  v_mfma_f32_16x16x32_bf16 v[212:215], v[84:87], a[4:7], 0
  v_mfma_f32_16x16x32_bf16 v[216:219], v[84:87], a[8:11], 0
  ds_read_b64_tr_b16 v[118:119], v30 offset:12296
  v_mfma_f32_16x16x32_bf16 v[220:223], v[84:87], a[12:15], 0
  buffer_load_dwordx4 v5, s[8:11], s40 offen offset:3072 lds
  v_mfma_f32_16x16x32_bf16 v[224:227], v[88:91], a[0:3], 0
  ds_read_b64_tr_b16 v[120:121], v31 offset:8192
  v_mfma_f32_16x16x32_bf16 v[228:231], v[88:91], a[4:7], 0
  buffer_load_dwordx4 a[76:79], v15, s[4:7], s42 offen offset:0 sc1
  v_mfma_f32_16x16x32_bf16 v[232:235], v[88:91], a[8:11], 0
  ds_read_b64_tr_b16 v[122:123], v31 offset:12288
  v_mfma_f32_16x16x32_bf16 v[236:239], v[88:91], a[12:15], 0
  v_mfma_f32_16x16x32_bf16 v[240:243], v[92:95], a[0:3], 0
  ds_read_b64_tr_b16 v[124:125], v31 offset:8200
  v_mfma_f32_16x16x32_bf16 v[244:247], v[92:95], a[4:7], 0
  v_mfma_f32_16x16x32_bf16 v[248:251], v[92:95], a[8:11], 0
  ds_read_b64_tr_b16 v[126:127], v31 offset:12296
  v_mfma_f32_16x16x32_bf16 v[252:255], v[92:95], a[12:15], 0
  s_waitcnt vmcnt(19) lgkmcnt(3)
  v_mfma_f32_16x16x32_bf16 v[128:131], v[96:99], a[16:19], v[128:131]
  ds_read_b64_tr_b16 v[64:65], v28 offset:16384
  s_waitcnt vmcnt(18)
  v_mfma_f32_16x16x32_bf16 v[132:135], v[96:99], a[20:23], v[132:135]
  buffer_load_dwordx4 a[80:83], v12, s[4:7], s42 offen offset:1024 sc1
  s_waitcnt vmcnt(18)
  v_mfma_f32_16x16x32_bf16 v[136:139], v[96:99], a[24:27], v[136:139]
  ds_read_b64_tr_b16 v[66:67], v28 offset:20480
  s_waitcnt vmcnt(17)
  v_mfma_f32_16x16x32_bf16 v[140:143], v[96:99], a[28:31], v[140:143]
  s_add_u32 m0, s28, 69632
  v_mfma_f32_16x16x32_bf16 v[144:147], v[100:103], a[16:19], v[144:147]
  ds_read_b64_tr_b16 v[68:69], v28 offset:16392
  v_mfma_f32_16x16x32_bf16 v[148:151], v[100:103], a[20:23], v[148:151]
  v_mfma_f32_16x16x32_bf16 v[152:155], v[100:103], a[24:27], v[152:155]
  ds_read_b64_tr_b16 v[70:71], v28 offset:20488
  v_mfma_f32_16x16x32_bf16 v[156:159], v[100:103], a[28:31], v[156:159]
  buffer_load_dwordx4 a[84:87], v13, s[4:7], s42 offen offset:1024 sc1
  s_add_u32 s40, s32, 2228224
  v_mfma_f32_16x16x32_bf16 v[160:163], v[104:107], a[16:19], v[160:163]
  ds_read_b64_tr_b16 v[72:73], v29 offset:16384
  v_mfma_f32_16x16x32_bf16 v[164:167], v[104:107], a[20:23], v[164:167]
  v_mfma_f32_16x16x32_bf16 v[168:171], v[104:107], a[24:27], v[168:171]
  ds_read_b64_tr_b16 v[74:75], v29 offset:20480
  v_mfma_f32_16x16x32_bf16 v[172:175], v[104:107], a[28:31], v[172:175]
  buffer_load_dwordx4 v2, s[8:11], s40 offen offset:0 lds
  v_mfma_f32_16x16x32_bf16 v[176:179], v[108:111], a[16:19], v[176:179]
  ds_read_b64_tr_b16 v[76:77], v29 offset:16392
  v_mfma_f32_16x16x32_bf16 v[180:183], v[108:111], a[20:23], v[180:183]
  buffer_load_dwordx4 a[88:91], v14, s[4:7], s42 offen offset:1024 sc1
  v_mfma_f32_16x16x32_bf16 v[184:187], v[108:111], a[24:27], v[184:187]
  ds_read_b64_tr_b16 v[78:79], v29 offset:20488
  v_mfma_f32_16x16x32_bf16 v[188:191], v[108:111], a[28:31], v[188:191]
  buffer_load_dwordx4 v3, s[8:11], s40 offen offset:1024 lds
  v_mfma_f32_16x16x32_bf16 v[192:195], v[112:115], a[16:19], v[192:195]
  ds_read_b64_tr_b16 v[80:81], v30 offset:16384
  v_mfma_f32_16x16x32_bf16 v[196:199], v[112:115], a[20:23], v[196:199]
  v_mfma_f32_16x16x32_bf16 v[200:203], v[112:115], a[24:27], v[200:203]
  ds_read_b64_tr_b16 v[82:83], v30 offset:20480
  v_mfma_f32_16x16x32_bf16 v[204:207], v[112:115], a[28:31], v[204:207]
  buffer_load_dwordx4 a[92:95], v15, s[4:7], s42 offen offset:1024 sc1
  buffer_load_dwordx4 v4, s[8:11], s40 offen offset:2048 lds
  v_mfma_f32_16x16x32_bf16 v[208:211], v[116:119], a[16:19], v[208:211]
  ds_read_b64_tr_b16 v[84:85], v30 offset:16392
  v_mfma_f32_16x16x32_bf16 v[212:215], v[116:119], a[20:23], v[212:215]
  v_mfma_f32_16x16x32_bf16 v[216:219], v[116:119], a[24:27], v[216:219]
  ds_read_b64_tr_b16 v[86:87], v30 offset:20488
  v_mfma_f32_16x16x32_bf16 v[220:223], v[116:119], a[28:31], v[220:223]
  buffer_load_dwordx4 v5, s[8:11], s40 offen offset:3072 lds
  s_waitcnt lgkmcnt(3)
  v_mfma_f32_16x16x32_bf16 v[224:227], v[120:123], a[16:19], v[224:227]
  ds_read_b64_tr_b16 v[88:89], v31 offset:16384
  v_mfma_f32_16x16x32_bf16 v[228:231], v[120:123], a[20:23], v[228:231]
  v_mfma_f32_16x16x32_bf16 v[232:235], v[120:123], a[24:27], v[232:235]
  ds_read_b64_tr_b16 v[90:91], v31 offset:20480
  v_mfma_f32_16x16x32_bf16 v[236:239], v[120:123], a[28:31], v[236:239]
  v_mfma_f32_16x16x32_bf16 v[240:243], v[124:127], a[16:19], v[240:243]
  ds_read_b64_tr_b16 v[92:93], v31 offset:16392
  v_mfma_f32_16x16x32_bf16 v[244:247], v[124:127], a[20:23], v[244:247]
  v_mfma_f32_16x16x32_bf16 v[248:251], v[124:127], a[24:27], v[248:251]
  ds_read_b64_tr_b16 v[94:95], v31 offset:20488
  v_mfma_f32_16x16x32_bf16 v[252:255], v[124:127], a[28:31], v[252:255]
  s_waitcnt vmcnt(23)
  v_mfma_f32_16x16x32_bf16 v[128:131], v[64:67], a[32:35], v[128:131]
  ds_read_b64_tr_b16 v[96:97], v28 offset:24576
  s_waitcnt vmcnt(22)
  v_mfma_f32_16x16x32_bf16 v[132:135], v[64:67], a[36:39], v[132:135]
  buffer_load_dwordx4 a[96:99], v12, s[4:7], s42 offen offset:2048 sc1
  s_waitcnt vmcnt(22)
  v_mfma_f32_16x16x32_bf16 v[136:139], v[64:67], a[40:43], v[136:139]
  ds_read_b64_tr_b16 v[98:99], v28 offset:28672
  s_waitcnt vmcnt(21)
  v_mfma_f32_16x16x32_bf16 v[140:143], v[64:67], a[44:47], v[140:143]
  s_add_u32 m0, s29, 131072
  v_mfma_f32_16x16x32_bf16 v[144:147], v[68:71], a[32:35], v[144:147]
  ds_read_b64_tr_b16 v[100:101], v28 offset:24584
  v_mfma_f32_16x16x32_bf16 v[148:151], v[68:71], a[36:39], v[148:151]
  v_mfma_f32_16x16x32_bf16 v[152:155], v[68:71], a[40:43], v[152:155]
  ds_read_b64_tr_b16 v[102:103], v28 offset:28680
  v_mfma_f32_16x16x32_bf16 v[156:159], v[68:71], a[44:47], v[156:159]
  buffer_load_dwordx4 a[100:103], v13, s[4:7], s42 offen offset:2048 sc1
  s_add_u32 s46, s29, 0
  v_mfma_f32_16x16x32_bf16 v[160:163], v[72:75], a[32:35], v[160:163]
  ds_read_b64_tr_b16 v[104:105], v29 offset:24576
  v_mfma_f32_16x16x32_bf16 v[164:167], v[72:75], a[36:39], v[164:167]
  v_mfma_f32_16x16x32_bf16 v[168:171], v[72:75], a[40:43], v[168:171]
  ds_read_b64_tr_b16 v[106:107], v29 offset:28672
  v_mfma_f32_16x16x32_bf16 v[172:175], v[72:75], a[44:47], v[172:175]
  buffer_load_dwordx4 v6, s[12:15], s46 offen offset:0 lds
  v_mfma_f32_16x16x32_bf16 v[176:179], v[76:79], a[32:35], v[176:179]
  ds_read_b64_tr_b16 v[108:109], v29 offset:24584
  v_mfma_f32_16x16x32_bf16 v[180:183], v[76:79], a[36:39], v[180:183]
  buffer_load_dwordx4 a[104:107], v14, s[4:7], s42 offen offset:2048 sc1
  v_mfma_f32_16x16x32_bf16 v[184:187], v[76:79], a[40:43], v[184:187]
  ds_read_b64_tr_b16 v[110:111], v29 offset:28680
  v_mfma_f32_16x16x32_bf16 v[188:191], v[76:79], a[44:47], v[188:191]
  buffer_load_dwordx4 v7, s[12:15], s46 offen offset:1024 lds
  s_waitcnt lgkmcnt(3)
  v_mfma_f32_16x16x32_bf16 v[192:195], v[80:83], a[32:35], v[192:195]
  ds_read_b64_tr_b16 v[112:113], v30 offset:24576
  v_mfma_f32_16x16x32_bf16 v[196:199], v[80:83], a[36:39], v[196:199]
  v_mfma_f32_16x16x32_bf16 v[200:203], v[80:83], a[40:43], v[200:203]
  ds_read_b64_tr_b16 v[114:115], v30 offset:28672
  v_mfma_f32_16x16x32_bf16 v[204:207], v[80:83], a[44:47], v[204:207]
  buffer_load_dwordx4 a[108:111], v15, s[4:7], s42 offen offset:2048 sc1
  buffer_load_dwordx4 v8, s[12:15], s46 offen offset:2048 lds
  v_mfma_f32_16x16x32_bf16 v[208:211], v[84:87], a[32:35], v[208:211]
  ds_read_b64_tr_b16 v[116:117], v30 offset:24584
  v_mfma_f32_16x16x32_bf16 v[212:215], v[84:87], a[36:39], v[212:215]
  v_mfma_f32_16x16x32_bf16 v[216:219], v[84:87], a[40:43], v[216:219]
  ds_read_b64_tr_b16 v[118:119], v30 offset:28680
  v_mfma_f32_16x16x32_bf16 v[220:223], v[84:87], a[44:47], v[220:223]
  buffer_load_dwordx4 v9, s[12:15], s46 offen offset:3072 lds
  v_mfma_f32_16x16x32_bf16 v[224:227], v[88:91], a[32:35], v[224:227]
  ds_read_b64_tr_b16 v[120:121], v31 offset:24576
  v_mfma_f32_16x16x32_bf16 v[228:231], v[88:91], a[36:39], v[228:231]
  v_mfma_f32_16x16x32_bf16 v[232:235], v[88:91], a[40:43], v[232:235]
  ds_read_b64_tr_b16 v[122:123], v31 offset:28672
  v_mfma_f32_16x16x32_bf16 v[236:239], v[88:91], a[44:47], v[236:239]
  v_mfma_f32_16x16x32_bf16 v[240:243], v[92:95], a[32:35], v[240:243]
  ds_read_b64_tr_b16 v[124:125], v31 offset:24584
  v_mfma_f32_16x16x32_bf16 v[244:247], v[92:95], a[36:39], v[244:247]
  v_mfma_f32_16x16x32_bf16 v[248:251], v[92:95], a[40:43], v[248:251]
  ds_read_b64_tr_b16 v[126:127], v31 offset:28680
  v_mfma_f32_16x16x32_bf16 v[252:255], v[92:95], a[44:47], v[252:255]
  s_waitcnt vmcnt(27)
  v_mfma_f32_16x16x32_bf16 v[128:131], v[96:99], a[48:51], v[128:131]
  s_barrier
  ds_read_b64_tr_b16 v[64:65], v28 offset:32768
  s_waitcnt vmcnt(26)
  v_mfma_f32_16x16x32_bf16 v[132:135], v[96:99], a[52:55], v[132:135]
  buffer_load_dwordx4 a[112:115], v12, s[4:7], s42 offen offset:3072 sc1
  s_waitcnt vmcnt(26)
  v_mfma_f32_16x16x32_bf16 v[136:139], v[96:99], a[56:59], v[136:139]
  ds_read_b64_tr_b16 v[66:67], v28 offset:36864
  s_waitcnt vmcnt(25)
  v_mfma_f32_16x16x32_bf16 v[140:143], v[96:99], a[60:63], v[140:143]
  s_add_u32 m0, s29, 147456
  v_mfma_f32_16x16x32_bf16 v[144:147], v[100:103], a[48:51], v[144:147]
  ds_read_b64_tr_b16 v[68:69], v28 offset:32776
  v_mfma_f32_16x16x32_bf16 v[148:151], v[100:103], a[52:55], v[148:151]
  v_mfma_f32_16x16x32_bf16 v[152:155], v[100:103], a[56:59], v[152:155]
  ds_read_b64_tr_b16 v[70:71], v28 offset:36872
  v_mfma_f32_16x16x32_bf16 v[156:159], v[100:103], a[60:63], v[156:159]
  buffer_load_dwordx4 a[116:119], v13, s[4:7], s42 offen offset:3072 sc1
  buffer_load_dwordx4 v10, s[16:19], s46 offen offset:0 lds
  s_waitcnt lgkmcnt(3)
  v_mfma_f32_16x16x32_bf16 v[160:163], v[104:107], a[48:51], v[160:163]
  ds_read_b64_tr_b16 v[72:73], v29 offset:32768
  v_mfma_f32_16x16x32_bf16 v[164:167], v[104:107], a[52:55], v[164:167]
  v_mfma_f32_16x16x32_bf16 v[168:171], v[104:107], a[56:59], v[168:171]
  ds_read_b64_tr_b16 v[74:75], v29 offset:36864
  v_mfma_f32_16x16x32_bf16 v[172:175], v[104:107], a[60:63], v[172:175]
  buffer_load_dwordx4 v11, s[16:19], s46 offen offset:1024 lds
  v_mfma_f32_16x16x32_bf16 v[176:179], v[108:111], a[48:51], v[176:179]
  ds_read_b64_tr_b16 v[76:77], v29 offset:32776
  v_mfma_f32_16x16x32_bf16 v[180:183], v[108:111], a[52:55], v[180:183]
  buffer_load_dwordx4 a[120:123], v14, s[4:7], s42 offen offset:3072 sc1
  v_mfma_f32_16x16x32_bf16 v[184:187], v[108:111], a[56:59], v[184:187]
  ds_read_b64_tr_b16 v[78:79], v29 offset:36872
  v_mfma_f32_16x16x32_bf16 v[188:191], v[108:111], a[60:63], v[188:191]
  buffer_load_dwordx4 v10, s[16:19], s46 offen offset:2048 lds
  v_mfma_f32_16x16x32_bf16 v[192:195], v[112:115], a[48:51], v[192:195]
  ds_read_b64_tr_b16 v[80:81], v30 offset:32768
  v_mfma_f32_16x16x32_bf16 v[196:199], v[112:115], a[52:55], v[196:199]
  v_mfma_f32_16x16x32_bf16 v[200:203], v[112:115], a[56:59], v[200:203]
  ds_read_b64_tr_b16 v[82:83], v30 offset:36864
  v_mfma_f32_16x16x32_bf16 v[204:207], v[112:115], a[60:63], v[204:207]
  buffer_load_dwordx4 a[124:127], v15, s[4:7], s42 offen offset:3072 sc1
  buffer_load_dwordx4 v11, s[16:19], s46 offen offset:3072 lds
  v_mfma_f32_16x16x32_bf16 v[208:211], v[116:119], a[48:51], v[208:211]
  ds_read_b64_tr_b16 v[84:85], v30 offset:32776
  v_mfma_f32_16x16x32_bf16 v[212:215], v[116:119], a[52:55], v[212:215]
  v_mfma_f32_16x16x32_bf16 v[216:219], v[116:119], a[56:59], v[216:219]
  ds_read_b64_tr_b16 v[86:87], v30 offset:36872
  v_mfma_f32_16x16x32_bf16 v[220:223], v[116:119], a[60:63], v[220:223]
  v_mfma_f32_16x16x32_bf16 v[224:227], v[120:123], a[48:51], v[224:227]
  ds_read_b64_tr_b16 v[88:89], v31 offset:32768
  v_mfma_f32_16x16x32_bf16 v[228:231], v[120:123], a[52:55], v[228:231]
  v_mfma_f32_16x16x32_bf16 v[232:235], v[120:123], a[56:59], v[232:235]
  ds_read_b64_tr_b16 v[90:91], v31 offset:36864
  v_mfma_f32_16x16x32_bf16 v[236:239], v[120:123], a[60:63], v[236:239]
  v_mfma_f32_16x16x32_bf16 v[240:243], v[124:127], a[48:51], v[240:243]
  ds_read_b64_tr_b16 v[92:93], v31 offset:32776
  v_mfma_f32_16x16x32_bf16 v[244:247], v[124:127], a[52:55], v[244:247]
  v_mfma_f32_16x16x32_bf16 v[248:251], v[124:127], a[56:59], v[248:251]
  ds_read_b64_tr_b16 v[94:95], v31 offset:36872
  v_mfma_f32_16x16x32_bf16 v[252:255], v[124:127], a[60:63], v[252:255]
  s_waitcnt vmcnt(31) lgkmcnt(4)
  v_mfma_f32_16x16x32_bf16 v[128:131], v[64:67], a[64:67], v[128:131]
  ds_read_b64_tr_b16 v[96:97], v28 offset:40960
  s_waitcnt vmcnt(29)
  v_mfma_f32_16x16x32_bf16 v[132:135], v[64:67], a[68:71], v[132:135]
  s_add_u32 s42, s33, 8192
  s_waitcnt vmcnt(27)
  v_mfma_f32_16x16x32_bf16 v[136:139], v[64:67], a[72:75], v[136:139]
  ds_read_b64_tr_b16 v[98:99], v28 offset:45056
  s_waitcnt vmcnt(24)
  v_mfma_f32_16x16x32_bf16 v[140:143], v[64:67], a[76:79], v[140:143]
  s_add_u32 m0, s28, 98304
  v_mfma_f32_16x16x32_bf16 v[144:147], v[68:71], a[64:67], v[144:147]
  ds_read_b64_tr_b16 v[100:101], v28 offset:40968
  v_mfma_f32_16x16x32_bf16 v[148:151], v[68:71], a[68:71], v[148:151]
  v_mfma_f32_16x16x32_bf16 v[152:155], v[68:71], a[72:75], v[152:155]
  ds_read_b64_tr_b16 v[102:103], v28 offset:45064
  v_mfma_f32_16x16x32_bf16 v[156:159], v[68:71], a[76:79], v[156:159]
  buffer_load_dwordx4 a[128:131], v12, s[4:7], s42 offen offset:0 sc1
  s_add_u32 s40, s32, 3145728
  v_mfma_f32_16x16x32_bf16 v[160:163], v[72:75], a[64:67], v[160:163]
  ds_read_b64_tr_b16 v[104:105], v29 offset:40960
  v_mfma_f32_16x16x32_bf16 v[164:167], v[72:75], a[68:71], v[164:167]
  v_mfma_f32_16x16x32_bf16 v[168:171], v[72:75], a[72:75], v[168:171]
  ds_read_b64_tr_b16 v[106:107], v29 offset:45056
  v_mfma_f32_16x16x32_bf16 v[172:175], v[72:75], a[76:79], v[172:175]
  buffer_load_dwordx4 v2, s[8:11], s40 offen offset:0 lds
  v_mfma_f32_16x16x32_bf16 v[176:179], v[76:79], a[64:67], v[176:179]
  ds_read_b64_tr_b16 v[108:109], v29 offset:40968
  v_mfma_f32_16x16x32_bf16 v[180:183], v[76:79], a[68:71], v[180:183]
  buffer_load_dwordx4 a[132:135], v13, s[4:7], s42 offen offset:0 sc1
  v_mfma_f32_16x16x32_bf16 v[184:187], v[76:79], a[72:75], v[184:187]
  ds_read_b64_tr_b16 v[110:111], v29 offset:45064
  v_mfma_f32_16x16x32_bf16 v[188:191], v[76:79], a[76:79], v[188:191]
  v_mfma_f32_16x16x32_bf16 v[192:195], v[80:83], a[64:67], v[192:195]
  ds_read_b64_tr_b16 v[112:113], v30 offset:40960
  v_mfma_f32_16x16x32_bf16 v[196:199], v[80:83], a[68:71], v[196:199]
  v_mfma_f32_16x16x32_bf16 v[200:203], v[80:83], a[72:75], v[200:203]
  ds_read_b64_tr_b16 v[114:115], v30 offset:45056
  v_mfma_f32_16x16x32_bf16 v[204:207], v[80:83], a[76:79], v[204:207]
  buffer_load_dwordx4 a[136:139], v14, s[4:7], s42 offen offset:0 sc1
  v_mfma_f32_16x16x32_bf16 v[208:211], v[84:87], a[64:67], v[208:211]
  ds_read_b64_tr_b16 v[116:117], v30 offset:40968
  v_mfma_f32_16x16x32_bf16 v[212:215], v[84:87], a[68:71], v[212:215]
  v_mfma_f32_16x16x32_bf16 v[216:219], v[84:87], a[72:75], v[216:219]
  ds_read_b64_tr_b16 v[118:119], v30 offset:45064
  v_mfma_f32_16x16x32_bf16 v[220:223], v[84:87], a[76:79], v[220:223]
  s_waitcnt lgkmcnt(3)
  v_mfma_f32_16x16x32_bf16 v[224:227], v[88:91], a[64:67], v[224:227]
  ds_read_b64_tr_b16 v[120:121], v31 offset:40960
  v_mfma_f32_16x16x32_bf16 v[228:231], v[88:91], a[68:71], v[228:231]
  buffer_load_dwordx4 a[140:143], v15, s[4:7], s42 offen offset:0 sc1
  v_mfma_f32_16x16x32_bf16 v[232:235], v[88:91], a[72:75], v[232:235]
  ds_read_b64_tr_b16 v[122:123], v31 offset:45056
  v_mfma_f32_16x16x32_bf16 v[236:239], v[88:91], a[76:79], v[236:239]
  v_mfma_f32_16x16x32_bf16 v[240:243], v[92:95], a[64:67], v[240:243]
  ds_read_b64_tr_b16 v[124:125], v31 offset:40968
  v_mfma_f32_16x16x32_bf16 v[244:247], v[92:95], a[68:71], v[244:247]
  v_mfma_f32_16x16x32_bf16 v[248:251], v[92:95], a[72:75], v[248:251]
  ds_read_b64_tr_b16 v[126:127], v31 offset:45064
  v_mfma_f32_16x16x32_bf16 v[252:255], v[92:95], a[76:79], v[252:255]
  s_waitcnt vmcnt(28)
  v_mfma_f32_16x16x32_bf16 v[128:131], v[96:99], a[80:83], v[128:131]
  ds_read_b64_tr_b16 v[64:65], v28 offset:49152
  s_waitcnt vmcnt(27)
  v_mfma_f32_16x16x32_bf16 v[132:135], v[96:99], a[84:87], v[132:135]
  buffer_load_dwordx4 a[144:147], v12, s[4:7], s42 offen offset:1024 sc1
  s_waitcnt vmcnt(26)
  v_mfma_f32_16x16x32_bf16 v[136:139], v[96:99], a[88:91], v[136:139]
  ds_read_b64_tr_b16 v[66:67], v28 offset:53248
  s_waitcnt vmcnt(24)
  v_mfma_f32_16x16x32_bf16 v[140:143], v[96:99], a[92:95], v[140:143]
  buffer_load_dwordx4 v3, s[8:11], s40 offen offset:1024 lds
  v_mfma_f32_16x16x32_bf16 v[144:147], v[100:103], a[80:83], v[144:147]
  ds_read_b64_tr_b16 v[68:69], v28 offset:49160
  v_mfma_f32_16x16x32_bf16 v[148:151], v[100:103], a[84:87], v[148:151]
  v_mfma_f32_16x16x32_bf16 v[152:155], v[100:103], a[88:91], v[152:155]
  ds_read_b64_tr_b16 v[70:71], v28 offset:53256
  v_mfma_f32_16x16x32_bf16 v[156:159], v[100:103], a[92:95], v[156:159]
  buffer_load_dwordx4 a[148:151], v13, s[4:7], s42 offen offset:1024 sc1
  buffer_load_dwordx4 v4, s[8:11], s40 offen offset:2048 lds
  v_mfma_f32_16x16x32_bf16 v[160:163], v[104:107], a[80:83], v[160:163]
  ds_read_b64_tr_b16 v[72:73], v29 offset:49152
  v_mfma_f32_16x16x32_bf16 v[164:167], v[104:107], a[84:87], v[164:167]
  v_mfma_f32_16x16x32_bf16 v[168:171], v[104:107], a[88:91], v[168:171]
  ds_read_b64_tr_b16 v[74:75], v29 offset:53248
  v_mfma_f32_16x16x32_bf16 v[172:175], v[104:107], a[92:95], v[172:175]
  buffer_load_dwordx4 v5, s[8:11], s40 offen offset:3072 lds
  v_mfma_f32_16x16x32_bf16 v[176:179], v[108:111], a[80:83], v[176:179]
  ds_read_b64_tr_b16 v[76:77], v29 offset:49160
  v_mfma_f32_16x16x32_bf16 v[180:183], v[108:111], a[84:87], v[180:183]
  buffer_load_dwordx4 a[152:155], v14, s[4:7], s42 offen offset:1024 sc1
  v_mfma_f32_16x16x32_bf16 v[184:187], v[108:111], a[88:91], v[184:187]
  ds_read_b64_tr_b16 v[78:79], v29 offset:53256
  v_mfma_f32_16x16x32_bf16 v[188:191], v[108:111], a[92:95], v[188:191]
  s_waitcnt lgkmcnt(3)
  v_mfma_f32_16x16x32_bf16 v[192:195], v[112:115], a[80:83], v[192:195]
  ds_read_b64_tr_b16 v[80:81], v30 offset:49152
  v_mfma_f32_16x16x32_bf16 v[196:199], v[112:115], a[84:87], v[196:199]
  v_mfma_f32_16x16x32_bf16 v[200:203], v[112:115], a[88:91], v[200:203]
  ds_read_b64_tr_b16 v[82:83], v30 offset:53248
  v_mfma_f32_16x16x32_bf16 v[204:207], v[112:115], a[92:95], v[204:207]
  buffer_load_dwordx4 a[156:159], v15, s[4:7], s42 offen offset:1024 sc1
  v_mfma_f32_16x16x32_bf16 v[208:211], v[116:119], a[80:83], v[208:211]
  ds_read_b64_tr_b16 v[84:85], v30 offset:49160
  v_mfma_f32_16x16x32_bf16 v[212:215], v[116:119], a[84:87], v[212:215]
  v_mfma_f32_16x16x32_bf16 v[216:219], v[116:119], a[88:91], v[216:219]
  ds_read_b64_tr_b16 v[86:87], v30 offset:53256
  v_mfma_f32_16x16x32_bf16 v[220:223], v[116:119], a[92:95], v[220:223]
  v_mfma_f32_16x16x32_bf16 v[224:227], v[120:123], a[80:83], v[224:227]
  ds_read_b64_tr_b16 v[88:89], v31 offset:49152
  v_mfma_f32_16x16x32_bf16 v[228:231], v[120:123], a[84:87], v[228:231]
  v_mfma_f32_16x16x32_bf16 v[232:235], v[120:123], a[88:91], v[232:235]
  ds_read_b64_tr_b16 v[90:91], v31 offset:53248
  v_mfma_f32_16x16x32_bf16 v[236:239], v[120:123], a[92:95], v[236:239]
  v_mfma_f32_16x16x32_bf16 v[240:243], v[124:127], a[80:83], v[240:243]
  ds_read_b64_tr_b16 v[92:93], v31 offset:49160
  v_mfma_f32_16x16x32_bf16 v[244:247], v[124:127], a[84:87], v[244:247]
  v_mfma_f32_16x16x32_bf16 v[248:251], v[124:127], a[88:91], v[248:251]
  ds_read_b64_tr_b16 v[94:95], v31 offset:53256
  v_mfma_f32_16x16x32_bf16 v[252:255], v[124:127], a[92:95], v[252:255]
  s_waitcnt vmcnt(27)
  v_mfma_f32_16x16x32_bf16 v[128:131], v[64:67], a[96:99], v[128:131]
  ds_read_b64_tr_b16 v[96:97], v28 offset:57344
  s_waitcnt vmcnt(26)
  v_mfma_f32_16x16x32_bf16 v[132:135], v[64:67], a[100:103], v[132:135]
  buffer_load_dwordx4 a[160:163], v12, s[4:7], s42 offen offset:2048 sc1
  s_waitcnt vmcnt(25)
  v_mfma_f32_16x16x32_bf16 v[136:139], v[64:67], a[104:107], v[136:139]
  ds_read_b64_tr_b16 v[98:99], v28 offset:61440
  s_waitcnt vmcnt(23)
  v_mfma_f32_16x16x32_bf16 v[140:143], v[64:67], a[108:111], v[140:143]
  s_add_u32 m0, s28, 102400
  v_mfma_f32_16x16x32_bf16 v[144:147], v[68:71], a[96:99], v[144:147]
  ds_read_b64_tr_b16 v[100:101], v28 offset:57352
  v_mfma_f32_16x16x32_bf16 v[148:151], v[68:71], a[100:103], v[148:151]
  v_mfma_f32_16x16x32_bf16 v[152:155], v[68:71], a[104:107], v[152:155]
  ds_read_b64_tr_b16 v[102:103], v28 offset:61448
  v_mfma_f32_16x16x32_bf16 v[156:159], v[68:71], a[108:111], v[156:159]
  buffer_load_dwordx4 a[164:167], v13, s[4:7], s42 offen offset:2048 sc1
  s_add_u32 s40, s32, 3276800
  s_waitcnt lgkmcnt(3)
  v_mfma_f32_16x16x32_bf16 v[160:163], v[72:75], a[96:99], v[160:163]
  ds_read_b64_tr_b16 v[104:105], v29 offset:57344
  v_mfma_f32_16x16x32_bf16 v[164:167], v[72:75], a[100:103], v[164:167]
  v_mfma_f32_16x16x32_bf16 v[168:171], v[72:75], a[104:107], v[168:171]
  ds_read_b64_tr_b16 v[106:107], v29 offset:61440
  v_mfma_f32_16x16x32_bf16 v[172:175], v[72:75], a[108:111], v[172:175]
  buffer_load_dwordx4 v2, s[8:11], s40 offen offset:0 lds
  v_mfma_f32_16x16x32_bf16 v[176:179], v[76:79], a[96:99], v[176:179]
  ds_read_b64_tr_b16 v[108:109], v29 offset:57352
  v_mfma_f32_16x16x32_bf16 v[180:183], v[76:79], a[100:103], v[180:183]
  buffer_load_dwordx4 a[168:171], v14, s[4:7], s42 offen offset:2048 sc1
  v_mfma_f32_16x16x32_bf16 v[184:187], v[76:79], a[104:107], v[184:187]
  ds_read_b64_tr_b16 v[110:111], v29 offset:61448
  v_mfma_f32_16x16x32_bf16 v[188:191], v[76:79], a[108:111], v[188:191]
  v_mfma_f32_16x16x32_bf16 v[192:195], v[80:83], a[96:99], v[192:195]
  ds_read_b64_tr_b16 v[112:113], v30 offset:57344
  v_mfma_f32_16x16x32_bf16 v[196:199], v[80:83], a[100:103], v[196:199]
  v_mfma_f32_16x16x32_bf16 v[200:203], v[80:83], a[104:107], v[200:203]
  ds_read_b64_tr_b16 v[114:115], v30 offset:61440
  v_mfma_f32_16x16x32_bf16 v[204:207], v[80:83], a[108:111], v[204:207]
  buffer_load_dwordx4 a[172:175], v15, s[4:7], s42 offen offset:2048 sc1
  v_mfma_f32_16x16x32_bf16 v[208:211], v[84:87], a[96:99], v[208:211]
  ds_read_b64_tr_b16 v[116:117], v30 offset:57352
  v_mfma_f32_16x16x32_bf16 v[212:215], v[84:87], a[100:103], v[212:215]
  v_mfma_f32_16x16x32_bf16 v[216:219], v[84:87], a[104:107], v[216:219]
  ds_read_b64_tr_b16 v[118:119], v30 offset:61448
  v_mfma_f32_16x16x32_bf16 v[220:223], v[84:87], a[108:111], v[220:223]
  v_mfma_f32_16x16x32_bf16 v[224:227], v[88:91], a[96:99], v[224:227]
  ds_read_b64_tr_b16 v[120:121], v31 offset:57344
  v_mfma_f32_16x16x32_bf16 v[228:231], v[88:91], a[100:103], v[228:231]
  v_mfma_f32_16x16x32_bf16 v[232:235], v[88:91], a[104:107], v[232:235]
  ds_read_b64_tr_b16 v[122:123], v31 offset:61440
  v_mfma_f32_16x16x32_bf16 v[236:239], v[88:91], a[108:111], v[236:239]
  v_mfma_f32_16x16x32_bf16 v[240:243], v[92:95], a[96:99], v[240:243]
  ds_read_b64_tr_b16 v[124:125], v31 offset:57352
  v_mfma_f32_16x16x32_bf16 v[244:247], v[92:95], a[100:103], v[244:247]
  v_mfma_f32_16x16x32_bf16 v[248:251], v[92:95], a[104:107], v[248:251]
  ds_read_b64_tr_b16 v[126:127], v31 offset:61448
  v_mfma_f32_16x16x32_bf16 v[252:255], v[92:95], a[108:111], v[252:255]
  s_waitcnt vmcnt(24) lgkmcnt(4)
  v_mfma_f32_16x16x32_bf16 v[128:131], v[96:99], a[112:115], v[128:131]
  s_barrier
  v_add_u32 v28, 0x10000, v28
  v_add_u32 v29, 0x10000, v29
  s_waitcnt vmcnt(23)
  v_mfma_f32_16x16x32_bf16 v[132:135], v[96:99], a[116:119], v[132:135]
  v_add_u32 v30, 0x10000, v30
  v_add_u32 v31, 0x10000, v31
  buffer_load_dwordx4 a[176:179], v12, s[4:7], s42 offen offset:3072 sc1
  s_waitcnt vmcnt(21)
  v_mfma_f32_16x16x32_bf16 v[136:139], v[96:99], a[120:123], v[136:139]
  ds_read_b64_tr_b16 v[64:65], v28 offset:0
  ds_read_b64_tr_b16 v[66:67], v28 offset:4096
  s_waitcnt vmcnt(19)
  v_mfma_f32_16x16x32_bf16 v[140:143], v[96:99], a[124:127], v[140:143]
  buffer_load_dwordx4 v3, s[8:11], s40 offen offset:1024 lds
  v_mfma_f32_16x16x32_bf16 v[144:147], v[100:103], a[112:115], v[144:147]
  ds_read_b64_tr_b16 v[68:69], v28 offset:8
  v_mfma_f32_16x16x32_bf16 v[148:151], v[100:103], a[116:119], v[148:151]
  v_mfma_f32_16x16x32_bf16 v[152:155], v[100:103], a[120:123], v[152:155]
  ds_read_b64_tr_b16 v[70:71], v28 offset:4104
  v_mfma_f32_16x16x32_bf16 v[156:159], v[100:103], a[124:127], v[156:159]
  buffer_load_dwordx4 a[180:183], v13, s[4:7], s42 offen offset:3072 sc1
  buffer_load_dwordx4 v4, s[8:11], s40 offen offset:2048 lds
  v_mfma_f32_16x16x32_bf16 v[160:163], v[104:107], a[112:115], v[160:163]
  ds_read_b64_tr_b16 v[72:73], v29 offset:0
  v_mfma_f32_16x16x32_bf16 v[164:167], v[104:107], a[116:119], v[164:167]
  v_mfma_f32_16x16x32_bf16 v[168:171], v[104:107], a[120:123], v[168:171]
  ds_read_b64_tr_b16 v[74:75], v29 offset:4096
  v_mfma_f32_16x16x32_bf16 v[172:175], v[104:107], a[124:127], v[172:175]
  buffer_load_dwordx4 v5, s[8:11], s40 offen offset:3072 lds
  v_mfma_f32_16x16x32_bf16 v[176:179], v[108:111], a[112:115], v[176:179]
  ds_read_b64_tr_b16 v[76:77], v29 offset:8
  v_mfma_f32_16x16x32_bf16 v[180:183], v[108:111], a[116:119], v[180:183]
  buffer_load_dwordx4 a[184:187], v14, s[4:7], s42 offen offset:3072 sc1
  v_mfma_f32_16x16x32_bf16 v[184:187], v[108:111], a[120:123], v[184:187]
  ds_read_b64_tr_b16 v[78:79], v29 offset:4104
  v_mfma_f32_16x16x32_bf16 v[188:191], v[108:111], a[124:127], v[188:191]
  v_mfma_f32_16x16x32_bf16 v[192:195], v[112:115], a[112:115], v[192:195]
  ds_read_b64_tr_b16 v[80:81], v30 offset:0
  v_mfma_f32_16x16x32_bf16 v[196:199], v[112:115], a[116:119], v[196:199]
  v_mfma_f32_16x16x32_bf16 v[200:203], v[112:115], a[120:123], v[200:203]
  ds_read_b64_tr_b16 v[82:83], v30 offset:4096
  v_mfma_f32_16x16x32_bf16 v[204:207], v[112:115], a[124:127], v[204:207]
  buffer_load_dwordx4 a[188:191], v15, s[4:7], s42 offen offset:3072 sc1
  v_mfma_f32_16x16x32_bf16 v[208:211], v[116:119], a[112:115], v[208:211]
  ds_read_b64_tr_b16 v[84:85], v30 offset:8
  v_mfma_f32_16x16x32_bf16 v[212:215], v[116:119], a[116:119], v[212:215]
  v_mfma_f32_16x16x32_bf16 v[216:219], v[116:119], a[120:123], v[216:219]
  ds_read_b64_tr_b16 v[86:87], v30 offset:4104
  v_mfma_f32_16x16x32_bf16 v[220:223], v[116:119], a[124:127], v[220:223]
  s_waitcnt lgkmcnt(3)
  v_mfma_f32_16x16x32_bf16 v[224:227], v[120:123], a[112:115], v[224:227]
  ds_read_b64_tr_b16 v[88:89], v31 offset:0
  v_mfma_f32_16x16x32_bf16 v[228:231], v[120:123], a[116:119], v[228:231]
  v_mfma_f32_16x16x32_bf16 v[232:235], v[120:123], a[120:123], v[232:235]
  ds_read_b64_tr_b16 v[90:91], v31 offset:4096
  v_mfma_f32_16x16x32_bf16 v[236:239], v[120:123], a[124:127], v[236:239]
  v_mfma_f32_16x16x32_bf16 v[240:243], v[124:127], a[112:115], v[240:243]
  ds_read_b64_tr_b16 v[92:93], v31 offset:8
  v_mfma_f32_16x16x32_bf16 v[244:247], v[124:127], a[116:119], v[244:247]
  v_mfma_f32_16x16x32_bf16 v[248:251], v[124:127], a[120:123], v[248:251]
  ds_read_b64_tr_b16 v[94:95], v31 offset:4104
  v_mfma_f32_16x16x32_bf16 v[252:255], v[124:127], a[124:127], v[252:255]
  s_waitcnt vmcnt(23)
  v_mfma_f32_16x16x32_bf16 v[128:131], v[64:67], a[128:131], v[128:131]
  ds_read_b64_tr_b16 v[96:97], v28 offset:8192
  s_waitcnt vmcnt(21)
  v_mfma_f32_16x16x32_bf16 v[132:135], v[64:67], a[132:135], v[132:135]
  s_add_u32 s42, s33, 12288
  s_waitcnt vmcnt(20)
  v_mfma_f32_16x16x32_bf16 v[136:139], v[64:67], a[136:139], v[136:139]
  ds_read_b64_tr_b16 v[98:99], v28 offset:12288
  s_waitcnt vmcnt(19)
  v_mfma_f32_16x16x32_bf16 v[140:143], v[64:67], a[140:143], v[140:143]
  s_add_u32 m0, s29, 0
  v_mfma_f32_16x16x32_bf16 v[144:147], v[68:71], a[128:131], v[144:147]
  ds_read_b64_tr_b16 v[100:101], v28 offset:8200
  v_mfma_f32_16x16x32_bf16 v[148:151], v[68:71], a[132:135], v[148:151]
  v_mfma_f32_16x16x32_bf16 v[152:155], v[68:71], a[136:139], v[152:155]
  ds_read_b64_tr_b16 v[102:103], v28 offset:12296
  v_mfma_f32_16x16x32_bf16 v[156:159], v[68:71], a[140:143], v[156:159]
  buffer_load_dwordx4 a[192:195], v12, s[4:7], s42 offen offset:0 sc1
  s_add_u32 s46, s29, 16384
  v_mfma_f32_16x16x32_bf16 v[160:163], v[72:75], a[128:131], v[160:163]
  ds_read_b64_tr_b16 v[104:105], v29 offset:8192
  v_mfma_f32_16x16x32_bf16 v[164:167], v[72:75], a[132:135], v[164:167]
  v_mfma_f32_16x16x32_bf16 v[168:171], v[72:75], a[136:139], v[168:171]
  ds_read_b64_tr_b16 v[106:107], v29 offset:12288
  v_mfma_f32_16x16x32_bf16 v[172:175], v[72:75], a[140:143], v[172:175]
  buffer_load_dwordx4 v6, s[12:15], s46 offen offset:0 lds
  v_mfma_f32_16x16x32_bf16 v[176:179], v[76:79], a[128:131], v[176:179]
  ds_read_b64_tr_b16 v[108:109], v29 offset:8200
  v_mfma_f32_16x16x32_bf16 v[180:183], v[76:79], a[132:135], v[180:183]
  buffer_load_dwordx4 a[196:199], v13, s[4:7], s42 offen offset:0 sc1
  v_mfma_f32_16x16x32_bf16 v[184:187], v[76:79], a[136:139], v[184:187]
  ds_read_b64_tr_b16 v[110:111], v29 offset:12296
  v_mfma_f32_16x16x32_bf16 v[188:191], v[76:79], a[140:143], v[188:191]
  s_waitcnt lgkmcnt(3)
  v_mfma_f32_16x16x32_bf16 v[192:195], v[80:83], a[128:131], v[192:195]
  ds_read_b64_tr_b16 v[112:113], v30 offset:8192
  v_mfma_f32_16x16x32_bf16 v[196:199], v[80:83], a[132:135], v[196:199]
  v_mfma_f32_16x16x32_bf16 v[200:203], v[80:83], a[136:139], v[200:203]
  ds_read_b64_tr_b16 v[114:115], v30 offset:12288
  v_mfma_f32_16x16x32_bf16 v[204:207], v[80:83], a[140:143], v[204:207]
  buffer_load_dwordx4 a[200:203], v14, s[4:7], s42 offen offset:0 sc1
  v_mfma_f32_16x16x32_bf16 v[208:211], v[84:87], a[128:131], v[208:211]
  ds_read_b64_tr_b16 v[116:117], v30 offset:8200
  v_mfma_f32_16x16x32_bf16 v[212:215], v[84:87], a[132:135], v[212:215]
  v_mfma_f32_16x16x32_bf16 v[216:219], v[84:87], a[136:139], v[216:219]
  ds_read_b64_tr_b16 v[118:119], v30 offset:12296
  v_mfma_f32_16x16x32_bf16 v[220:223], v[84:87], a[140:143], v[220:223]
  v_mfma_f32_16x16x32_bf16 v[224:227], v[88:91], a[128:131], v[224:227]
  ds_read_b64_tr_b16 v[120:121], v31 offset:8192
  v_mfma_f32_16x16x32_bf16 v[228:231], v[88:91], a[132:135], v[228:231]
  buffer_load_dwordx4 a[204:207], v15, s[4:7], s42 offen offset:0 sc1
  v_mfma_f32_16x16x32_bf16 v[232:235], v[88:91], a[136:139], v[232:235]
  ds_read_b64_tr_b16 v[122:123], v31 offset:12288
  v_mfma_f32_16x16x32_bf16 v[236:239], v[88:91], a[140:143], v[236:239]
  v_mfma_f32_16x16x32_bf16 v[240:243], v[92:95], a[128:131], v[240:243]
  ds_read_b64_tr_b16 v[124:125], v31 offset:8200
  v_mfma_f32_16x16x32_bf16 v[244:247], v[92:95], a[132:135], v[244:247]
  v_mfma_f32_16x16x32_bf16 v[248:251], v[92:95], a[136:139], v[248:251]
  ds_read_b64_tr_b16 v[126:127], v31 offset:12296
  v_mfma_f32_16x16x32_bf16 v[252:255], v[92:95], a[140:143], v[252:255]
  s_waitcnt vmcnt(23)
  v_mfma_f32_16x16x32_bf16 v[128:131], v[96:99], a[144:147], v[128:131]
  ds_read_b64_tr_b16 v[64:65], v28 offset:16384
  s_waitcnt vmcnt(21)
  v_mfma_f32_16x16x32_bf16 v[132:135], v[96:99], a[148:151], v[132:135]
  buffer_load_dwordx4 a[208:211], v12, s[4:7], s42 offen offset:1024 sc1
  s_waitcnt vmcnt(19)
  v_mfma_f32_16x16x32_bf16 v[136:139], v[96:99], a[152:155], v[136:139]
  ds_read_b64_tr_b16 v[66:67], v28 offset:20480
  s_waitcnt vmcnt(18)
  v_mfma_f32_16x16x32_bf16 v[140:143], v[96:99], a[156:159], v[140:143]
  buffer_load_dwordx4 v7, s[12:15], s46 offen offset:1024 lds
  v_mfma_f32_16x16x32_bf16 v[144:147], v[100:103], a[144:147], v[144:147]
  ds_read_b64_tr_b16 v[68:69], v28 offset:16392
  v_mfma_f32_16x16x32_bf16 v[148:151], v[100:103], a[148:151], v[148:151]
  v_mfma_f32_16x16x32_bf16 v[152:155], v[100:103], a[152:155], v[152:155]
  ds_read_b64_tr_b16 v[70:71], v28 offset:20488
  v_mfma_f32_16x16x32_bf16 v[156:159], v[100:103], a[156:159], v[156:159]
  buffer_load_dwordx4 a[212:215], v13, s[4:7], s42 offen offset:1024 sc1
  buffer_load_dwordx4 v8, s[12:15], s46 offen offset:2048 lds
  s_waitcnt lgkmcnt(3)
  v_mfma_f32_16x16x32_bf16 v[160:163], v[104:107], a[144:147], v[160:163]
  ds_read_b64_tr_b16 v[72:73], v29 offset:16384
  v_mfma_f32_16x16x32_bf16 v[164:167], v[104:107], a[148:151], v[164:167]
  v_mfma_f32_16x16x32_bf16 v[168:171], v[104:107], a[152:155], v[168:171]
  ds_read_b64_tr_b16 v[74:75], v29 offset:20480
  v_mfma_f32_16x16x32_bf16 v[172:175], v[104:107], a[156:159], v[172:175]
  buffer_load_dwordx4 v9, s[12:15], s46 offen offset:3072 lds
  v_mfma_f32_16x16x32_bf16 v[176:179], v[108:111], a[144:147], v[176:179]
  ds_read_b64_tr_b16 v[76:77], v29 offset:16392
  v_mfma_f32_16x16x32_bf16 v[180:183], v[108:111], a[148:151], v[180:183]
  buffer_load_dwordx4 a[216:219], v14, s[4:7], s42 offen offset:1024 sc1
  v_mfma_f32_16x16x32_bf16 v[184:187], v[108:111], a[152:155], v[184:187]
  ds_read_b64_tr_b16 v[78:79], v29 offset:20488
  v_mfma_f32_16x16x32_bf16 v[188:191], v[108:111], a[156:159], v[188:191]
  v_mfma_f32_16x16x32_bf16 v[192:195], v[112:115], a[144:147], v[192:195]
  ds_read_b64_tr_b16 v[80:81], v30 offset:16384
  v_mfma_f32_16x16x32_bf16 v[196:199], v[112:115], a[148:151], v[196:199]
  v_mfma_f32_16x16x32_bf16 v[200:203], v[112:115], a[152:155], v[200:203]
  ds_read_b64_tr_b16 v[82:83], v30 offset:20480
  v_mfma_f32_16x16x32_bf16 v[204:207], v[112:115], a[156:159], v[204:207]
  buffer_load_dwordx4 a[220:223], v15, s[4:7], s42 offen offset:1024 sc1
  v_mfma_f32_16x16x32_bf16 v[208:211], v[116:119], a[144:147], v[208:211]
  ds_read_b64_tr_b16 v[84:85], v30 offset:16392
  v_mfma_f32_16x16x32_bf16 v[212:215], v[116:119], a[148:151], v[212:215]
  v_mfma_f32_16x16x32_bf16 v[216:219], v[116:119], a[152:155], v[216:219]
  ds_read_b64_tr_b16 v[86:87], v30 offset:20488
  v_mfma_f32_16x16x32_bf16 v[220:223], v[116:119], a[156:159], v[220:223]
  v_mfma_f32_16x16x32_bf16 v[224:227], v[120:123], a[144:147], v[224:227]
  ds_read_b64_tr_b16 v[88:89], v31 offset:16384
  v_mfma_f32_16x16x32_bf16 v[228:231], v[120:123], a[148:151], v[228:231]
  v_mfma_f32_16x16x32_bf16 v[232:235], v[120:123], a[152:155], v[232:235]
  ds_read_b64_tr_b16 v[90:91], v31 offset:20480
  v_mfma_f32_16x16x32_bf16 v[236:239], v[120:123], a[156:159], v[236:239]
  v_mfma_f32_16x16x32_bf16 v[240:243], v[124:127], a[144:147], v[240:243]
  ds_read_b64_tr_b16 v[92:93], v31 offset:16392
  v_mfma_f32_16x16x32_bf16 v[244:247], v[124:127], a[148:151], v[244:247]
  v_mfma_f32_16x16x32_bf16 v[248:251], v[124:127], a[152:155], v[248:251]
  ds_read_b64_tr_b16 v[94:95], v31 offset:20488
  v_mfma_f32_16x16x32_bf16 v[252:255], v[124:127], a[156:159], v[252:255]
  s_waitcnt vmcnt(23) lgkmcnt(4)
  v_mfma_f32_16x16x32_bf16 v[128:131], v[64:67], a[160:163], v[128:131]
  ds_read_b64_tr_b16 v[96:97], v28 offset:24576
  s_waitcnt vmcnt(22)
  v_mfma_f32_16x16x32_bf16 v[132:135], v[64:67], a[164:167], v[132:135]
  buffer_load_dwordx4 a[224:227], v12, s[4:7], s42 offen offset:2048 sc1
  s_waitcnt vmcnt(21)
  v_mfma_f32_16x16x32_bf16 v[136:139], v[64:67], a[168:171], v[136:139]
  ds_read_b64_tr_b16 v[98:99], v28 offset:28672
  s_waitcnt vmcnt(20)
  v_mfma_f32_16x16x32_bf16 v[140:143], v[64:67], a[172:175], v[140:143]
  s_add_u32 m0, s29, 16384
  v_mfma_f32_16x16x32_bf16 v[144:147], v[68:71], a[160:163], v[144:147]
  ds_read_b64_tr_b16 v[100:101], v28 offset:24584
  v_mfma_f32_16x16x32_bf16 v[148:151], v[68:71], a[164:167], v[148:151]
  v_mfma_f32_16x16x32_bf16 v[152:155], v[68:71], a[168:171], v[152:155]
  ds_read_b64_tr_b16 v[102:103], v28 offset:28680
  v_mfma_f32_16x16x32_bf16 v[156:159], v[68:71], a[172:175], v[156:159]
  buffer_load_dwordx4 a[228:231], v13, s[4:7], s42 offen offset:2048 sc1
  buffer_load_dwordx4 v10, s[16:19], s46 offen offset:0 lds
  v_mfma_f32_16x16x32_bf16 v[160:163], v[72:75], a[160:163], v[160:163]
  ds_read_b64_tr_b16 v[104:105], v29 offset:24576
  v_mfma_f32_16x16x32_bf16 v[164:167], v[72:75], a[164:167], v[164:167]
  v_mfma_f32_16x16x32_bf16 v[168:171], v[72:75], a[168:171], v[168:171]
  ds_read_b64_tr_b16 v[106:107], v29 offset:28672
  v_mfma_f32_16x16x32_bf16 v[172:175], v[72:75], a[172:175], v[172:175]
  buffer_load_dwordx4 v11, s[16:19], s46 offen offset:1024 lds
  v_mfma_f32_16x16x32_bf16 v[176:179], v[76:79], a[160:163], v[176:179]
  ds_read_b64_tr_b16 v[108:109], v29 offset:24584
  v_mfma_f32_16x16x32_bf16 v[180:183], v[76:79], a[164:167], v[180:183]
  buffer_load_dwordx4 a[232:235], v14, s[4:7], s42 offen offset:2048 sc1
  v_mfma_f32_16x16x32_bf16 v[184:187], v[76:79], a[168:171], v[184:187]
  ds_read_b64_tr_b16 v[110:111], v29 offset:28680
  v_mfma_f32_16x16x32_bf16 v[188:191], v[76:79], a[172:175], v[188:191]
  v_mfma_f32_16x16x32_bf16 v[192:195], v[80:83], a[160:163], v[192:195]
  ds_read_b64_tr_b16 v[112:113], v30 offset:24576
  v_mfma_f32_16x16x32_bf16 v[196:199], v[80:83], a[164:167], v[196:199]
  v_mfma_f32_16x16x32_bf16 v[200:203], v[80:83], a[168:171], v[200:203]
  ds_read_b64_tr_b16 v[114:115], v30 offset:28672
  v_mfma_f32_16x16x32_bf16 v[204:207], v[80:83], a[172:175], v[204:207]
  buffer_load_dwordx4 a[236:239], v15, s[4:7], s42 offen offset:2048 sc1
  v_mfma_f32_16x16x32_bf16 v[208:211], v[84:87], a[160:163], v[208:211]
  ds_read_b64_tr_b16 v[116:117], v30 offset:24584
  v_mfma_f32_16x16x32_bf16 v[212:215], v[84:87], a[164:167], v[212:215]
  v_mfma_f32_16x16x32_bf16 v[216:219], v[84:87], a[168:171], v[216:219]
  ds_read_b64_tr_b16 v[118:119], v30 offset:28680
  v_mfma_f32_16x16x32_bf16 v[220:223], v[84:87], a[172:175], v[220:223]
  s_waitcnt lgkmcnt(3)
  v_mfma_f32_16x16x32_bf16 v[224:227], v[88:91], a[160:163], v[224:227]
  ds_read_b64_tr_b16 v[120:121], v31 offset:24576
  v_mfma_f32_16x16x32_bf16 v[228:231], v[88:91], a[164:167], v[228:231]
  v_mfma_f32_16x16x32_bf16 v[232:235], v[88:91], a[168:171], v[232:235]
  ds_read_b64_tr_b16 v[122:123], v31 offset:28672
  v_mfma_f32_16x16x32_bf16 v[236:239], v[88:91], a[172:175], v[236:239]
  v_mfma_f32_16x16x32_bf16 v[240:243], v[92:95], a[160:163], v[240:243]
  ds_read_b64_tr_b16 v[124:125], v31 offset:24584
  v_mfma_f32_16x16x32_bf16 v[244:247], v[92:95], a[164:167], v[244:247]
  v_mfma_f32_16x16x32_bf16 v[248:251], v[92:95], a[168:171], v[248:251]
  ds_read_b64_tr_b16 v[126:127], v31 offset:28680
  v_mfma_f32_16x16x32_bf16 v[252:255], v[92:95], a[172:175], v[252:255]
  s_waitcnt vmcnt(24)
  v_mfma_f32_16x16x32_bf16 v[128:131], v[96:99], a[176:179], v[128:131]
  s_waitcnt vmcnt(20)
  s_barrier
  ds_read_b64_tr_b16 v[64:65], v28 offset:32768
  v_mfma_f32_16x16x32_bf16 v[132:135], v[96:99], a[180:183], v[132:135]
  buffer_load_dwordx4 a[240:243], v12, s[4:7], s42 offen offset:3072 sc1
  s_waitcnt vmcnt(20)
  v_mfma_f32_16x16x32_bf16 v[136:139], v[96:99], a[184:187], v[136:139]
  ds_read_b64_tr_b16 v[66:67], v28 offset:36864
  s_waitcnt vmcnt(19)
  v_mfma_f32_16x16x32_bf16 v[140:143], v[96:99], a[188:191], v[140:143]
  buffer_load_dwordx4 v10, s[16:19], s46 offen offset:2048 lds
  v_mfma_f32_16x16x32_bf16 v[144:147], v[100:103], a[176:179], v[144:147]
  ds_read_b64_tr_b16 v[68:69], v28 offset:32776
  v_mfma_f32_16x16x32_bf16 v[148:151], v[100:103], a[180:183], v[148:151]
  v_mfma_f32_16x16x32_bf16 v[152:155], v[100:103], a[184:187], v[152:155]
  ds_read_b64_tr_b16 v[70:71], v28 offset:36872
  v_mfma_f32_16x16x32_bf16 v[156:159], v[100:103], a[188:191], v[156:159]
  buffer_load_dwordx4 a[244:247], v13, s[4:7], s42 offen offset:3072 sc1
  buffer_load_dwordx4 v11, s[16:19], s46 offen offset:3072 lds
  v_mfma_f32_16x16x32_bf16 v[160:163], v[104:107], a[176:179], v[160:163]
  ds_read_b64_tr_b16 v[72:73], v29 offset:32768
  v_mfma_f32_16x16x32_bf16 v[164:167], v[104:107], a[180:183], v[164:167]
  v_mfma_f32_16x16x32_bf16 v[168:171], v[104:107], a[184:187], v[168:171]
  ds_read_b64_tr_b16 v[74:75], v29 offset:36864
  v_mfma_f32_16x16x32_bf16 v[172:175], v[104:107], a[188:191], v[172:175]
  v_mfma_f32_16x16x32_bf16 v[176:179], v[108:111], a[176:179], v[176:179]
  ds_read_b64_tr_b16 v[76:77], v29 offset:32776
  v_mfma_f32_16x16x32_bf16 v[180:183], v[108:111], a[180:183], v[180:183]
  buffer_load_dwordx4 a[248:251], v14, s[4:7], s42 offen offset:3072 sc1
  v_mfma_f32_16x16x32_bf16 v[184:187], v[108:111], a[184:187], v[184:187]
  ds_read_b64_tr_b16 v[78:79], v29 offset:36872
  v_mfma_f32_16x16x32_bf16 v[188:191], v[108:111], a[188:191], v[188:191]
  s_waitcnt lgkmcnt(3)
  v_mfma_f32_16x16x32_bf16 v[192:195], v[112:115], a[176:179], v[192:195]
  ds_read_b64_tr_b16 v[80:81], v30 offset:32768
  v_mfma_f32_16x16x32_bf16 v[196:199], v[112:115], a[180:183], v[196:199]
  v_mfma_f32_16x16x32_bf16 v[200:203], v[112:115], a[184:187], v[200:203]
  ds_read_b64_tr_b16 v[82:83], v30 offset:36864
  v_mfma_f32_16x16x32_bf16 v[204:207], v[112:115], a[188:191], v[204:207]
  buffer_load_dwordx4 a[252:255], v15, s[4:7], s42 offen offset:3072 sc1
  v_mfma_f32_16x16x32_bf16 v[208:211], v[116:119], a[176:179], v[208:211]
  ds_read_b64_tr_b16 v[84:85], v30 offset:32776
  v_mfma_f32_16x16x32_bf16 v[212:215], v[116:119], a[180:183], v[212:215]
  v_mfma_f32_16x16x32_bf16 v[216:219], v[116:119], a[184:187], v[216:219]
  ds_read_b64_tr_b16 v[86:87], v30 offset:36872
  v_mfma_f32_16x16x32_bf16 v[220:223], v[116:119], a[188:191], v[220:223]
  v_mfma_f32_16x16x32_bf16 v[224:227], v[120:123], a[176:179], v[224:227]
  ds_read_b64_tr_b16 v[88:89], v31 offset:32768
  v_mfma_f32_16x16x32_bf16 v[228:231], v[120:123], a[180:183], v[228:231]
  v_mfma_f32_16x16x32_bf16 v[232:235], v[120:123], a[184:187], v[232:235]
  ds_read_b64_tr_b16 v[90:91], v31 offset:36864
  v_mfma_f32_16x16x32_bf16 v[236:239], v[120:123], a[188:191], v[236:239]
  v_mfma_f32_16x16x32_bf16 v[240:243], v[124:127], a[176:179], v[240:243]
  ds_read_b64_tr_b16 v[92:93], v31 offset:32776
  v_mfma_f32_16x16x32_bf16 v[244:247], v[124:127], a[180:183], v[244:247]
  v_mfma_f32_16x16x32_bf16 v[248:251], v[124:127], a[184:187], v[248:251]
  ds_read_b64_tr_b16 v[94:95], v31 offset:36872
  v_mfma_f32_16x16x32_bf16 v[252:255], v[124:127], a[188:191], v[252:255]
  s_waitcnt vmcnt(23)
  v_mfma_f32_16x16x32_bf16 v[128:131], v[64:67], a[192:195], v[128:131]
  ds_read_b64_tr_b16 v[96:97], v28 offset:40960
  s_waitcnt vmcnt(21)
  v_mfma_f32_16x16x32_bf16 v[132:135], v[64:67], a[196:199], v[132:135]
  s_waitcnt vmcnt(20)
  v_mfma_f32_16x16x32_bf16 v[136:139], v[64:67], a[200:203], v[136:139]
  ds_read_b64_tr_b16 v[98:99], v28 offset:45056
  s_waitcnt vmcnt(19)
  v_mfma_f32_16x16x32_bf16 v[140:143], v[64:67], a[204:207], v[140:143]
  s_add_u32 m0, s29, 32768
  v_mfma_f32_16x16x32_bf16 v[144:147], v[68:71], a[192:195], v[144:147]
  ds_read_b64_tr_b16 v[100:101], v28 offset:40968
  v_mfma_f32_16x16x32_bf16 v[148:151], v[68:71], a[196:199], v[148:151]
  v_mfma_f32_16x16x32_bf16 v[152:155], v[68:71], a[200:203], v[152:155]
  ds_read_b64_tr_b16 v[102:103], v28 offset:45064
  v_mfma_f32_16x16x32_bf16 v[156:159], v[68:71], a[204:207], v[156:159]
  s_add_u32 s46, s29, 32768
  s_waitcnt lgkmcnt(3)
  v_mfma_f32_16x16x32_bf16 v[160:163], v[72:75], a[192:195], v[160:163]
  ds_read_b64_tr_b16 v[104:105], v29 offset:40960
  v_mfma_f32_16x16x32_bf16 v[164:167], v[72:75], a[196:199], v[164:167]
  v_mfma_f32_16x16x32_bf16 v[168:171], v[72:75], a[200:203], v[168:171]
  ds_read_b64_tr_b16 v[106:107], v29 offset:45056
  v_mfma_f32_16x16x32_bf16 v[172:175], v[72:75], a[204:207], v[172:175]
  buffer_load_dwordx4 v6, s[12:15], s46 offen offset:0 lds
  v_mfma_f32_16x16x32_bf16 v[176:179], v[76:79], a[192:195], v[176:179]
  ds_read_b64_tr_b16 v[108:109], v29 offset:40968
  v_mfma_f32_16x16x32_bf16 v[180:183], v[76:79], a[196:199], v[180:183]
  v_mfma_f32_16x16x32_bf16 v[184:187], v[76:79], a[200:203], v[184:187]
  ds_read_b64_tr_b16 v[110:111], v29 offset:45064
  v_mfma_f32_16x16x32_bf16 v[188:191], v[76:79], a[204:207], v[188:191]
  v_mfma_f32_16x16x32_bf16 v[192:195], v[80:83], a[192:195], v[192:195]
  ds_read_b64_tr_b16 v[112:113], v30 offset:40960
  v_mfma_f32_16x16x32_bf16 v[196:199], v[80:83], a[196:199], v[196:199]
  v_mfma_f32_16x16x32_bf16 v[200:203], v[80:83], a[200:203], v[200:203]
  ds_read_b64_tr_b16 v[114:115], v30 offset:45056
  v_mfma_f32_16x16x32_bf16 v[204:207], v[80:83], a[204:207], v[204:207]
  v_mfma_f32_16x16x32_bf16 v[208:211], v[84:87], a[192:195], v[208:211]
  ds_read_b64_tr_b16 v[116:117], v30 offset:40968
  v_mfma_f32_16x16x32_bf16 v[212:215], v[84:87], a[196:199], v[212:215]
  v_mfma_f32_16x16x32_bf16 v[216:219], v[84:87], a[200:203], v[216:219]
  ds_read_b64_tr_b16 v[118:119], v30 offset:45064
  v_mfma_f32_16x16x32_bf16 v[220:223], v[84:87], a[204:207], v[220:223]
  v_mfma_f32_16x16x32_bf16 v[224:227], v[88:91], a[192:195], v[224:227]
  ds_read_b64_tr_b16 v[120:121], v31 offset:40960
  v_mfma_f32_16x16x32_bf16 v[228:231], v[88:91], a[196:199], v[228:231]
  v_mfma_f32_16x16x32_bf16 v[232:235], v[88:91], a[200:203], v[232:235]
  ds_read_b64_tr_b16 v[122:123], v31 offset:45056
  v_mfma_f32_16x16x32_bf16 v[236:239], v[88:91], a[204:207], v[236:239]
  v_mfma_f32_16x16x32_bf16 v[240:243], v[92:95], a[192:195], v[240:243]
  ds_read_b64_tr_b16 v[124:125], v31 offset:40968
  v_mfma_f32_16x16x32_bf16 v[244:247], v[92:95], a[196:199], v[244:247]
  v_mfma_f32_16x16x32_bf16 v[248:251], v[92:95], a[200:203], v[248:251]
  ds_read_b64_tr_b16 v[126:127], v31 offset:45064
  v_mfma_f32_16x16x32_bf16 v[252:255], v[92:95], a[204:207], v[252:255]
  s_waitcnt vmcnt(19) lgkmcnt(4)
  v_mfma_f32_16x16x32_bf16 v[128:131], v[96:99], a[208:211], v[128:131]
  ds_read_b64_tr_b16 v[64:65], v28 offset:49152
  s_waitcnt vmcnt(17)
  v_mfma_f32_16x16x32_bf16 v[132:135], v[96:99], a[212:215], v[132:135]
  s_waitcnt vmcnt(14)
  v_mfma_f32_16x16x32_bf16 v[136:139], v[96:99], a[216:219], v[136:139]
  ds_read_b64_tr_b16 v[66:67], v28 offset:53248
  s_waitcnt vmcnt(13)
  v_mfma_f32_16x16x32_bf16 v[140:143], v[96:99], a[220:223], v[140:143]
  buffer_load_dwordx4 v7, s[12:15], s46 offen offset:1024 lds
  v_mfma_f32_16x16x32_bf16 v[144:147], v[100:103], a[208:211], v[144:147]
  ds_read_b64_tr_b16 v[68:69], v28 offset:49160
  v_mfma_f32_16x16x32_bf16 v[148:151], v[100:103], a[212:215], v[148:151]
  v_mfma_f32_16x16x32_bf16 v[152:155], v[100:103], a[216:219], v[152:155]
  ds_read_b64_tr_b16 v[70:71], v28 offset:53256
  v_mfma_f32_16x16x32_bf16 v[156:159], v[100:103], a[220:223], v[156:159]
  buffer_load_dwordx4 v8, s[12:15], s46 offen offset:2048 lds
  v_mfma_f32_16x16x32_bf16 v[160:163], v[104:107], a[208:211], v[160:163]
  ds_read_b64_tr_b16 v[72:73], v29 offset:49152
  v_mfma_f32_16x16x32_bf16 v[164:167], v[104:107], a[212:215], v[164:167]
  v_mfma_f32_16x16x32_bf16 v[168:171], v[104:107], a[216:219], v[168:171]
  ds_read_b64_tr_b16 v[74:75], v29 offset:53248
  v_mfma_f32_16x16x32_bf16 v[172:175], v[104:107], a[220:223], v[172:175]
  buffer_load_dwordx4 v9, s[12:15], s46 offen offset:3072 lds
  v_mfma_f32_16x16x32_bf16 v[176:179], v[108:111], a[208:211], v[176:179]
  ds_read_b64_tr_b16 v[76:77], v29 offset:49160
  v_mfma_f32_16x16x32_bf16 v[180:183], v[108:111], a[212:215], v[180:183]
  v_mfma_f32_16x16x32_bf16 v[184:187], v[108:111], a[216:219], v[184:187]
  ds_read_b64_tr_b16 v[78:79], v29 offset:53256
  v_mfma_f32_16x16x32_bf16 v[188:191], v[108:111], a[220:223], v[188:191]
  v_mfma_f32_16x16x32_bf16 v[192:195], v[112:115], a[208:211], v[192:195]
  ds_read_b64_tr_b16 v[80:81], v30 offset:49152
  v_mfma_f32_16x16x32_bf16 v[196:199], v[112:115], a[212:215], v[196:199]
  v_mfma_f32_16x16x32_bf16 v[200:203], v[112:115], a[216:219], v[200:203]
  ds_read_b64_tr_b16 v[82:83], v30 offset:53248
  v_mfma_f32_16x16x32_bf16 v[204:207], v[112:115], a[220:223], v[204:207]
  v_mfma_f32_16x16x32_bf16 v[208:211], v[116:119], a[208:211], v[208:211]
  ds_read_b64_tr_b16 v[84:85], v30 offset:49160
  v_mfma_f32_16x16x32_bf16 v[212:215], v[116:119], a[212:215], v[212:215]
  v_mfma_f32_16x16x32_bf16 v[216:219], v[116:119], a[216:219], v[216:219]
  ds_read_b64_tr_b16 v[86:87], v30 offset:53256
  v_mfma_f32_16x16x32_bf16 v[220:223], v[116:119], a[220:223], v[220:223]
  s_waitcnt lgkmcnt(4)
  v_mfma_f32_16x16x32_bf16 v[224:227], v[120:123], a[208:211], v[224:227]
  ds_read_b64_tr_b16 v[88:89], v31 offset:49152
  v_mfma_f32_16x16x32_bf16 v[228:231], v[120:123], a[212:215], v[228:231]
  v_mfma_f32_16x16x32_bf16 v[232:235], v[120:123], a[216:219], v[232:235]
  ds_read_b64_tr_b16 v[90:91], v31 offset:53248
  v_mfma_f32_16x16x32_bf16 v[236:239], v[120:123], a[220:223], v[236:239]
  v_mfma_f32_16x16x32_bf16 v[240:243], v[124:127], a[208:211], v[240:243]
  ds_read_b64_tr_b16 v[92:93], v31 offset:49160
  v_mfma_f32_16x16x32_bf16 v[244:247], v[124:127], a[212:215], v[244:247]
  v_mfma_f32_16x16x32_bf16 v[248:251], v[124:127], a[216:219], v[248:251]
  ds_read_b64_tr_b16 v[94:95], v31 offset:53256
  v_mfma_f32_16x16x32_bf16 v[252:255], v[124:127], a[220:223], v[252:255]
  s_waitcnt vmcnt(15)
  v_mfma_f32_16x16x32_bf16 v[128:131], v[64:67], a[224:227], v[128:131]
  ds_read_b64_tr_b16 v[96:97], v28 offset:57344
  s_waitcnt vmcnt(14)
  v_mfma_f32_16x16x32_bf16 v[132:135], v[64:67], a[228:231], v[132:135]
  s_waitcnt vmcnt(11)
  v_mfma_f32_16x16x32_bf16 v[136:139], v[64:67], a[232:235], v[136:139]
  ds_read_b64_tr_b16 v[98:99], v28 offset:61440
  s_waitcnt vmcnt(10)
  v_mfma_f32_16x16x32_bf16 v[140:143], v[64:67], a[236:239], v[140:143]
  s_add_u32 m0, s29, 49152
  v_mfma_f32_16x16x32_bf16 v[144:147], v[68:71], a[224:227], v[144:147]
  ds_read_b64_tr_b16 v[100:101], v28 offset:57352
  v_mfma_f32_16x16x32_bf16 v[148:151], v[68:71], a[228:231], v[148:151]
  v_mfma_f32_16x16x32_bf16 v[152:155], v[68:71], a[232:235], v[152:155]
  ds_read_b64_tr_b16 v[102:103], v28 offset:61448
  v_mfma_f32_16x16x32_bf16 v[156:159], v[68:71], a[236:239], v[156:159]
  buffer_load_dwordx4 v10, s[16:19], s46 offen offset:0 lds
  v_mfma_f32_16x16x32_bf16 v[160:163], v[72:75], a[224:227], v[160:163]
  ds_read_b64_tr_b16 v[104:105], v29 offset:57344
  v_mfma_f32_16x16x32_bf16 v[164:167], v[72:75], a[228:231], v[164:167]
  v_mfma_f32_16x16x32_bf16 v[168:171], v[72:75], a[232:235], v[168:171]
  ds_read_b64_tr_b16 v[106:107], v29 offset:61440
  v_mfma_f32_16x16x32_bf16 v[172:175], v[72:75], a[236:239], v[172:175]
  buffer_load_dwordx4 v11, s[16:19], s46 offen offset:1024 lds
  v_mfma_f32_16x16x32_bf16 v[176:179], v[76:79], a[224:227], v[176:179]
  ds_read_b64_tr_b16 v[108:109], v29 offset:57352
  v_mfma_f32_16x16x32_bf16 v[180:183], v[76:79], a[228:231], v[180:183]
  v_mfma_f32_16x16x32_bf16 v[184:187], v[76:79], a[232:235], v[184:187]
  ds_read_b64_tr_b16 v[110:111], v29 offset:61448
  v_mfma_f32_16x16x32_bf16 v[188:191], v[76:79], a[236:239], v[188:191]
  s_waitcnt lgkmcnt(3)
  v_mfma_f32_16x16x32_bf16 v[192:195], v[80:83], a[224:227], v[192:195]
  ds_read_b64_tr_b16 v[112:113], v30 offset:57344
  v_mfma_f32_16x16x32_bf16 v[196:199], v[80:83], a[228:231], v[196:199]
  v_mfma_f32_16x16x32_bf16 v[200:203], v[80:83], a[232:235], v[200:203]
  ds_read_b64_tr_b16 v[114:115], v30 offset:61440
  v_mfma_f32_16x16x32_bf16 v[204:207], v[80:83], a[236:239], v[204:207]
  v_mfma_f32_16x16x32_bf16 v[208:211], v[84:87], a[224:227], v[208:211]
  ds_read_b64_tr_b16 v[116:117], v30 offset:57352
  v_mfma_f32_16x16x32_bf16 v[212:215], v[84:87], a[228:231], v[212:215]
  v_mfma_f32_16x16x32_bf16 v[216:219], v[84:87], a[232:235], v[216:219]
  ds_read_b64_tr_b16 v[118:119], v30 offset:61448
  v_mfma_f32_16x16x32_bf16 v[220:223], v[84:87], a[236:239], v[220:223]
  v_mfma_f32_16x16x32_bf16 v[224:227], v[88:91], a[224:227], v[224:227]
  ds_read_b64_tr_b16 v[120:121], v31 offset:57344
  v_mfma_f32_16x16x32_bf16 v[228:231], v[88:91], a[228:231], v[228:231]
  v_mfma_f32_16x16x32_bf16 v[232:235], v[88:91], a[232:235], v[232:235]
  ds_read_b64_tr_b16 v[122:123], v31 offset:61440
  v_mfma_f32_16x16x32_bf16 v[236:239], v[88:91], a[236:239], v[236:239]
  v_mfma_f32_16x16x32_bf16 v[240:243], v[92:95], a[224:227], v[240:243]
  ds_read_b64_tr_b16 v[124:125], v31 offset:57352
  v_mfma_f32_16x16x32_bf16 v[244:247], v[92:95], a[228:231], v[244:247]
  v_mfma_f32_16x16x32_bf16 v[248:251], v[92:95], a[232:235], v[248:251]
  ds_read_b64_tr_b16 v[126:127], v31 offset:61448
  v_mfma_f32_16x16x32_bf16 v[252:255], v[92:95], a[236:239], v[252:255]
  s_waitcnt vmcnt(11)
  v_mfma_f32_16x16x32_bf16 v[128:131], v[96:99], a[240:243], v[128:131]
  s_waitcnt vmcnt(9)
  v_mfma_f32_16x16x32_bf16 v[132:135], v[96:99], a[244:247], v[132:135]
  s_waitcnt vmcnt(7)
  v_mfma_f32_16x16x32_bf16 v[136:139], v[96:99], a[248:251], v[136:139]
  s_waitcnt vmcnt(6)
  v_mfma_f32_16x16x32_bf16 v[140:143], v[96:99], a[252:255], v[140:143]
  buffer_load_dwordx4 v10, s[16:19], s46 offen offset:2048 lds
  v_mfma_f32_16x16x32_bf16 v[144:147], v[100:103], a[240:243], v[144:147]
  v_cvt_pk_bf16_f32 v64, v128, v129
  v_cvt_pk_bf16_f32 v65, v130, v131
  v_mfma_f32_16x16x32_bf16 v[148:151], v[100:103], a[244:247], v[148:151]
  v_cvt_pk_bf16_f32 v80, v132, v133
  v_cvt_pk_bf16_f32 v81, v134, v135
  v_mfma_f32_16x16x32_bf16 v[152:155], v[100:103], a[248:251], v[152:155]
  v_cvt_pk_bf16_f32 v96, v136, v137
  v_cvt_pk_bf16_f32 v97, v138, v139
  v_mfma_f32_16x16x32_bf16 v[156:159], v[100:103], a[252:255], v[156:159]
  buffer_load_dwordx4 v11, s[16:19], s46 offen offset:3072 lds
  s_waitcnt lgkmcnt(0)
  v_mfma_f32_16x16x32_bf16 v[160:163], v[104:107], a[240:243], v[160:163]
  v_cvt_pk_bf16_f32 v66, v144, v145
  v_cvt_pk_bf16_f32 v67, v146, v147
  v_mfma_f32_16x16x32_bf16 v[164:167], v[104:107], a[244:247], v[164:167]
  v_cvt_pk_bf16_f32 v82, v148, v149
  v_cvt_pk_bf16_f32 v83, v150, v151
  v_mfma_f32_16x16x32_bf16 v[168:171], v[104:107], a[248:251], v[168:171]
  v_cvt_pk_bf16_f32 v98, v152, v153
  v_cvt_pk_bf16_f32 v99, v154, v155
  v_mfma_f32_16x16x32_bf16 v[172:175], v[104:107], a[252:255], v[172:175]
  v_mfma_f32_16x16x32_bf16 v[176:179], v[108:111], a[240:243], v[176:179]
  v_cvt_pk_bf16_f32 v68, v160, v161
  v_cvt_pk_bf16_f32 v69, v162, v163
  v_mfma_f32_16x16x32_bf16 v[180:183], v[108:111], a[244:247], v[180:183]
  v_cvt_pk_bf16_f32 v84, v164, v165
  v_cvt_pk_bf16_f32 v85, v166, v167
  v_mfma_f32_16x16x32_bf16 v[184:187], v[108:111], a[248:251], v[184:187]
  v_cvt_pk_bf16_f32 v100, v168, v169
  v_cvt_pk_bf16_f32 v101, v170, v171
  v_mfma_f32_16x16x32_bf16 v[188:191], v[108:111], a[252:255], v[188:191]
  v_mfma_f32_16x16x32_bf16 v[192:195], v[112:115], a[240:243], v[192:195]
  v_cvt_pk_bf16_f32 v70, v176, v177
  v_cvt_pk_bf16_f32 v71, v178, v179
  v_mfma_f32_16x16x32_bf16 v[196:199], v[112:115], a[244:247], v[196:199]
  v_cvt_pk_bf16_f32 v86, v180, v181
  v_cvt_pk_bf16_f32 v87, v182, v183
  v_mfma_f32_16x16x32_bf16 v[200:203], v[112:115], a[248:251], v[200:203]
  v_cvt_pk_bf16_f32 v102, v184, v185
  v_cvt_pk_bf16_f32 v103, v186, v187
  v_mfma_f32_16x16x32_bf16 v[204:207], v[112:115], a[252:255], v[204:207]
  v_mfma_f32_16x16x32_bf16 v[208:211], v[116:119], a[240:243], v[208:211]
  v_cvt_pk_bf16_f32 v72, v192, v193
  v_cvt_pk_bf16_f32 v73, v194, v195
  v_cvt_pk_bf16_f32 v112, v140, v141
  v_cvt_pk_bf16_f32 v113, v142, v143
  v_cvt_pk_bf16_f32 v114, v156, v157
  v_cvt_pk_bf16_f32 v115, v158, v159
  v_mfma_f32_16x16x32_bf16 v[212:215], v[116:119], a[244:247], v[212:215]
  v_cvt_pk_bf16_f32 v88, v196, v197
  v_cvt_pk_bf16_f32 v89, v198, v199
  v_mfma_f32_16x16x32_bf16 v[216:219], v[116:119], a[248:251], v[216:219]
  v_cvt_pk_bf16_f32 v104, v200, v201
  v_cvt_pk_bf16_f32 v105, v202, v203
  v_mfma_f32_16x16x32_bf16 v[220:223], v[116:119], a[252:255], v[220:223]
  v_mfma_f32_16x16x32_bf16 v[224:227], v[120:123], a[240:243], v[224:227]
  v_cvt_pk_bf16_f32 v74, v208, v209
  v_cvt_pk_bf16_f32 v75, v210, v211
  v_cvt_pk_bf16_f32 v116, v172, v173
  v_cvt_pk_bf16_f32 v117, v174, v175
  v_cvt_pk_bf16_f32 v118, v188, v189
  v_cvt_pk_bf16_f32 v119, v190, v191
  v_mfma_f32_16x16x32_bf16 v[228:231], v[120:123], a[244:247], v[228:231]
  v_cvt_pk_bf16_f32 v90, v212, v213
  v_cvt_pk_bf16_f32 v91, v214, v215
  v_mfma_f32_16x16x32_bf16 v[232:235], v[120:123], a[248:251], v[232:235]
  v_cvt_pk_bf16_f32 v106, v216, v217
  v_cvt_pk_bf16_f32 v107, v218, v219
  v_mfma_f32_16x16x32_bf16 v[236:239], v[120:123], a[252:255], v[236:239]
  v_mfma_f32_16x16x32_bf16 v[240:243], v[124:127], a[240:243], v[240:243]
  v_cvt_pk_bf16_f32 v76, v224, v225
  v_cvt_pk_bf16_f32 v77, v226, v227
  v_cvt_pk_bf16_f32 v120, v204, v205
  v_cvt_pk_bf16_f32 v121, v206, v207
  v_cvt_pk_bf16_f32 v122, v220, v221
  v_cvt_pk_bf16_f32 v123, v222, v223
  v_mfma_f32_16x16x32_bf16 v[244:247], v[124:127], a[244:247], v[244:247]
  v_cvt_pk_bf16_f32 v92, v228, v229
  v_cvt_pk_bf16_f32 v93, v230, v231
  v_mfma_f32_16x16x32_bf16 v[248:251], v[124:127], a[248:251], v[248:251]
  v_cvt_pk_bf16_f32 v108, v232, v233
  v_cvt_pk_bf16_f32 v109, v234, v235
  v_mfma_f32_16x16x32_bf16 v[252:255], v[124:127], a[252:255], v[252:255]
  v_cvt_pk_bf16_f32 v78, v240, v241
  v_cvt_pk_bf16_f32 v79, v242, v243
  v_cvt_pk_bf16_f32 v94, v244, v245
  v_cvt_pk_bf16_f32 v95, v246, v247
  s_nop 0
  v_cvt_pk_bf16_f32 v110, v248, v249
  v_cvt_pk_bf16_f32 v111, v250, v251
  v_cvt_pk_bf16_f32 v124, v236, v237
  v_cvt_pk_bf16_f32 v125, v238, v239
  v_cvt_pk_bf16_f32 v126, v252, v253
  v_cvt_pk_bf16_f32 v127, v254, v255
adaLN_cond__sliding_block_cached__glu_gated_bilinear__prompt_kernel_attn:
  v_add_u32 v24, 131072, v24
  v_add_u32 v25, 131072, v25
  v_add_u32 v26, 131072, v26
  v_add_u32 v27, 131072, v27
  v_add_u32 v16, 147456, v16
  v_add_u32 v17, 147456, v17
  v_add_u32 v18, 147456, v18
  v_add_u32 v19, 147456, v19
  v_add_u32 v20, 147456, v20
  v_add_u32 v21, 147456, v21
  v_add_u32 v22, 147456, v22
  v_add_u32 v23, 147456, v23
  v_mov_b32 v208, 0x3f803f80
  v_mov_b32 v209, 0x3f803f80
  v_mov_b32 v210, 0x3f803f80
  v_mov_b32 v211, 0x3f803f80
  s_barrier
  ds_read_b128 a[128:131], v24 offset:0
  ds_read_b128 a[132:135], v25 offset:0
  ds_read_b128 a[136:139], v26 offset:0
  ds_read_b128 a[140:143], v27 offset:0
  ds_read_b128 a[144:147], v24 offset:4096
  ds_read_b128 a[148:151], v25 offset:4096
  ds_read_b128 a[152:155], v26 offset:4096
  ds_read_b128 a[156:159], v27 offset:4096
  s_cmp_eq_u32 s44, 0
  s_cbranch_scc1 Lkv1217
  s_add_u32 m0, s29, 0
  s_nop 0
  s_add_u32 s46, s29, 16384
  buffer_load_dwordx4 v6, s[12:15], s46 offen offset:0 lds
  buffer_load_dwordx4 v7, s[12:15], s46 offen offset:1024 lds
  buffer_load_dwordx4 v8, s[12:15], s46 offen offset:2048 lds
  buffer_load_dwordx4 v9, s[12:15], s46 offen offset:3072 lds
  s_add_u32 m0, s29, 16384
  s_nop 0
  buffer_load_dwordx4 v10, s[16:19], s46 offen offset:0 lds
  buffer_load_dwordx4 v11, s[16:19], s46 offen offset:1024 lds
  buffer_load_dwordx4 v10, s[16:19], s46 offen offset:2048 lds
  buffer_load_dwordx4 v11, s[16:19], s46 offen offset:3072 lds
  s_add_u32 m0, s29, 32768
  s_nop 0
  s_add_u32 s46, s29, 32768
  buffer_load_dwordx4 v6, s[12:15], s46 offen offset:0 lds
  buffer_load_dwordx4 v7, s[12:15], s46 offen offset:1024 lds
  buffer_load_dwordx4 v8, s[12:15], s46 offen offset:2048 lds
  buffer_load_dwordx4 v9, s[12:15], s46 offen offset:3072 lds
  s_add_u32 m0, s29, 49152
  s_nop 0
  buffer_load_dwordx4 v10, s[16:19], s46 offen offset:0 lds
  buffer_load_dwordx4 v11, s[16:19], s46 offen offset:1024 lds
  buffer_load_dwordx4 v10, s[16:19], s46 offen offset:2048 lds
  buffer_load_dwordx4 v11, s[16:19], s46 offen offset:3072 lds
  s_waitcnt vmcnt(0)
Lkv1217:
  ds_read_b128 a[160:163], v24 offset:8192
  ds_read_b128 a[164:167], v25 offset:8192
  ds_read_b128 a[168:171], v26 offset:8192
  ds_read_b128 a[172:175], v27 offset:8192
  ds_read_b128 a[176:179], v24 offset:12288
  ds_read_b128 a[180:183], v25 offset:12288
  ds_read_b128 a[184:187], v26 offset:12288
  ds_read_b128 a[188:191], v27 offset:12288
  s_waitcnt lgkmcnt(8)
  v_mfma_f32_16x16x32_bf16 v[128:131], a[128:131], v[64:67], 0
  v_mfma_f32_16x16x32_bf16 v[128:131], a[132:135], v[68:71], v[128:131]
  v_mfma_f32_16x16x32_bf16 v[128:131], a[136:139], v[72:75], v[128:131]
  v_mfma_f32_16x16x32_bf16 v[128:131], a[140:143], v[76:79], v[128:131]
  v_mfma_f32_16x16x32_bf16 v[132:135], a[144:147], v[64:67], 0
  v_mfma_f32_16x16x32_bf16 v[132:135], a[148:151], v[68:71], v[132:135]
  v_mfma_f32_16x16x32_bf16 v[132:135], a[152:155], v[72:75], v[132:135]
  v_mfma_f32_16x16x32_bf16 v[132:135], a[156:159], v[76:79], v[132:135]
  ds_read_b64_tr_b16 a[192:193], v16 offset:0
  ds_read_b64_tr_b16 a[194:195], v16 offset:4096
  ds_read_b64_tr_b16 a[196:197], v17 offset:0
  ds_read_b64_tr_b16 a[198:199], v17 offset:4096
  ds_read_b64_tr_b16 a[200:201], v18 offset:0
  ds_read_b64_tr_b16 a[202:203], v18 offset:4096
  ds_read_b64_tr_b16 a[204:205], v19 offset:0
  ds_read_b64_tr_b16 a[206:207], v19 offset:4096
  v_mfma_f32_16x16x32_bf16 v[136:139], a[128:131], v[80:83], 0
  v_mfma_f32_16x16x32_bf16 v[136:139], a[132:135], v[84:87], v[136:139]
  v_mfma_f32_16x16x32_bf16 v[136:139], a[136:139], v[88:91], v[136:139]
  v_mfma_f32_16x16x32_bf16 v[136:139], a[140:143], v[92:95], v[136:139]
  v_mfma_f32_16x16x32_bf16 v[140:143], a[144:147], v[80:83], 0
  v_mfma_f32_16x16x32_bf16 v[140:143], a[148:151], v[84:87], v[140:143]
  v_mfma_f32_16x16x32_bf16 v[140:143], a[152:155], v[88:91], v[140:143]
  v_mfma_f32_16x16x32_bf16 v[140:143], a[156:159], v[92:95], v[140:143]
  ds_read_b64_tr_b16 a[208:209], v20 offset:0
  ds_read_b64_tr_b16 a[210:211], v20 offset:4096
  ds_read_b64_tr_b16 a[212:213], v21 offset:0
  ds_read_b64_tr_b16 a[214:215], v21 offset:4096
  ds_read_b64_tr_b16 a[216:217], v22 offset:0
  ds_read_b64_tr_b16 a[218:219], v22 offset:4096
  ds_read_b64_tr_b16 a[220:221], v23 offset:0
  ds_read_b64_tr_b16 a[222:223], v23 offset:4096
  v_mfma_f32_16x16x32_bf16 v[144:147], a[128:131], v[96:99], 0
  v_mfma_f32_16x16x32_bf16 v[144:147], a[132:135], v[100:103], v[144:147]
  v_mfma_f32_16x16x32_bf16 v[144:147], a[136:139], v[104:107], v[144:147]
  v_mfma_f32_16x16x32_bf16 v[144:147], a[140:143], v[108:111], v[144:147]
  v_mfma_f32_16x16x32_bf16 v[148:151], a[144:147], v[96:99], 0
  v_mfma_f32_16x16x32_bf16 v[148:151], a[148:151], v[100:103], v[148:151]
  v_mfma_f32_16x16x32_bf16 v[148:151], a[152:155], v[104:107], v[148:151]
  v_mfma_f32_16x16x32_bf16 v[148:151], a[156:159], v[108:111], v[148:151]
  v_mfma_f32_16x16x32_bf16 v[152:155], a[128:131], v[112:115], 0
  v_mfma_f32_16x16x32_bf16 v[152:155], a[132:135], v[116:119], v[152:155]
  v_mfma_f32_16x16x32_bf16 v[152:155], a[136:139], v[120:123], v[152:155]
  v_mfma_f32_16x16x32_bf16 v[152:155], a[140:143], v[124:127], v[152:155]
  v_mfma_f32_16x16x32_bf16 v[156:159], a[144:147], v[112:115], 0
  v_mfma_f32_16x16x32_bf16 v[156:159], a[148:151], v[116:119], v[156:159]
  v_mfma_f32_16x16x32_bf16 v[156:159], a[152:155], v[120:123], v[156:159]
  v_mfma_f32_16x16x32_bf16 v[156:159], a[156:159], v[124:127], v[156:159]
  v_add_u32 v24, 0xfffe0000, v24
  v_add_u32 v25, 0xfffe0000, v25
  v_add_u32 v26, 0xfffe0000, v26
  v_add_u32 v27, 0xfffe0000, v27
  s_cmp_lg_u32 s44, 0
  s_cbranch_scc1 adaLN_cond__sliding_block_cached__glu_gated_bilinear__prompt_kernel_havemax
  v_max3_f32 v212, v128, v129, v130
  v_max3_f32 v212, v212, v131, v132
  v_max3_f32 v212, v212, v133, v134
  v_max_f32 v212, v212, v135
  v_max3_f32 v213, v136, v137, v138
  v_max3_f32 v213, v213, v139, v140
  v_max3_f32 v213, v213, v141, v142
  v_max_f32 v213, v213, v143
  v_max3_f32 v214, v144, v145, v146
  v_max3_f32 v214, v214, v147, v148
  v_max3_f32 v214, v214, v149, v150
  v_max_f32 v214, v214, v151
  v_max3_f32 v215, v152, v153, v154
  v_max3_f32 v215, v215, v155, v156
  v_max3_f32 v215, v215, v157, v158
  v_max_f32 v215, v215, v159
  v_mov_b32 v40, v212
  s_nop 1
  v_permlane16_swap_b32 v212, v40
  v_max_f32 v212, v212, v40
  v_mov_b32 v40, v212
  s_nop 1
  v_permlane32_swap_b32 v212, v40
  v_max_f32 v212, v212, v40
  v_add_f32 v212, 0x41c00000, v212
  v_mov_b32 v41, v213
  s_nop 1
  v_permlane16_swap_b32 v213, v41
  v_max_f32 v213, v213, v41
  v_mov_b32 v41, v213
  s_nop 1
  v_permlane32_swap_b32 v213, v41
  v_max_f32 v213, v213, v41
  v_add_f32 v213, 0x41c00000, v213
  v_mov_b32 v42, v214
  s_nop 1
  v_permlane16_swap_b32 v214, v42
  v_max_f32 v214, v214, v42
  v_mov_b32 v42, v214
  s_nop 1
  v_permlane32_swap_b32 v214, v42
  v_max_f32 v214, v214, v42
  v_add_f32 v214, 0x41c00000, v214
  v_mov_b32 v43, v215
  s_nop 1
  v_permlane16_swap_b32 v215, v43
  v_max_f32 v215, v215, v43
  v_mov_b32 v43, v215
  s_nop 1
  v_permlane32_swap_b32 v215, v43
  v_max_f32 v215, v215, v43
  v_add_f32 v215, 0x41c00000, v215
adaLN_cond__sliding_block_cached__glu_gated_bilinear__prompt_kernel_havemax:
  s_nop 7
  v_sub_f32 v160, 0, v212
  v_sub_f32 v161, 0, v212
  v_sub_f32 v162, 0, v212
  v_sub_f32 v163, 0, v212
  v_sub_f32 v128, v128, v212
  v_sub_f32 v129, v129, v212
  v_sub_f32 v130, v130, v212
  v_sub_f32 v131, v131, v212
  v_sub_f32 v132, v132, v212
  v_sub_f32 v133, v133, v212
  v_sub_f32 v134, v134, v212
  v_sub_f32 v135, v135, v212
  v_sub_f32 v164, 0, v213
  v_sub_f32 v165, 0, v213
  v_sub_f32 v166, 0, v213
  v_sub_f32 v167, 0, v213
  v_sub_f32 v136, v136, v213
  v_sub_f32 v137, v137, v213
  v_sub_f32 v138, v138, v213
  v_sub_f32 v139, v139, v213
  v_sub_f32 v140, v140, v213
  v_sub_f32 v141, v141, v213
  v_sub_f32 v142, v142, v213
  v_sub_f32 v143, v143, v213
  v_sub_f32 v168, 0, v214
  v_sub_f32 v169, 0, v214
  v_sub_f32 v170, 0, v214
  v_sub_f32 v171, 0, v214
  v_sub_f32 v144, v144, v214
  v_sub_f32 v145, v145, v214
  v_sub_f32 v146, v146, v214
  v_sub_f32 v147, v147, v214
  v_sub_f32 v148, v148, v214
  v_sub_f32 v149, v149, v214
  v_sub_f32 v150, v150, v214
  v_sub_f32 v151, v151, v214
  v_sub_f32 v172, 0, v215
  v_sub_f32 v173, 0, v215
  v_sub_f32 v174, 0, v215
  v_sub_f32 v175, 0, v215
  v_sub_f32 v152, v152, v215
  v_sub_f32 v153, v153, v215
  v_sub_f32 v154, v154, v215
  v_sub_f32 v155, v155, v215
  v_sub_f32 v156, v156, v215
  v_sub_f32 v157, v157, v215
  v_sub_f32 v158, v158, v215
  v_sub_f32 v159, v159, v215
  v_exp_f32 v128, v128
  v_exp_f32 v129, v129
  v_exp_f32 v130, v130
  v_exp_f32 v131, v131
  v_exp_f32 v132, v132
  v_exp_f32 v133, v133
  v_exp_f32 v134, v134
  v_exp_f32 v135, v135
  v_cvt_pk_bf16_f32 v176, v128, v129
  v_cvt_pk_bf16_f32 v177, v130, v131
  v_cvt_pk_bf16_f32 v178, v132, v133
  v_cvt_pk_bf16_f32 v179, v134, v135
  v_exp_f32 v136, v136
  v_exp_f32 v137, v137
  v_exp_f32 v138, v138
  v_exp_f32 v139, v139
  v_exp_f32 v140, v140
  v_exp_f32 v141, v141
  v_exp_f32 v142, v142
  v_exp_f32 v143, v143
  v_cvt_pk_bf16_f32 v180, v136, v137
  v_cvt_pk_bf16_f32 v181, v138, v139
  v_cvt_pk_bf16_f32 v182, v140, v141
  v_cvt_pk_bf16_f32 v183, v142, v143
  v_exp_f32 v144, v144
  v_exp_f32 v145, v145
  v_exp_f32 v146, v146
  v_exp_f32 v147, v147
  v_exp_f32 v148, v148
  v_exp_f32 v149, v149
  v_exp_f32 v150, v150
  v_exp_f32 v151, v151
  v_cvt_pk_bf16_f32 v184, v144, v145
  v_cvt_pk_bf16_f32 v185, v146, v147
  v_cvt_pk_bf16_f32 v186, v148, v149
  v_cvt_pk_bf16_f32 v187, v150, v151
  s_waitcnt lgkmcnt(0)
  v_mfma_f32_16x16x32_bf16 a[0:3], a[192:195], v[176:179], 0
  s_barrier
  v_mfma_f32_16x16x32_bf16 a[16:19], a[196:199], v[176:179], 0
  ds_read_b64_tr_b16 a[224:225], v16 offset:8192
  v_mfma_f32_16x16x32_bf16 a[32:35], a[200:203], v[176:179], 0
  v_exp_f32 v152, v152
  v_mfma_f32_16x16x32_bf16 a[48:51], a[204:207], v[176:179], 0
  ds_read_b64_tr_b16 a[226:227], v16 offset:12288
  s_add_u32 m0, s29, 65536
  v_mfma_f32_16x16x32_bf16 a[64:67], a[208:211], v[176:179], 0
  v_exp_f32 v153, v153
  v_mfma_f32_16x16x32_bf16 a[80:83], a[212:215], v[176:179], 0
  ds_read_b64_tr_b16 a[228:229], v17 offset:8192
  v_cvt_pk_bf16_f32 v188, v152, v153
  v_mfma_f32_16x16x32_bf16 a[96:99], a[216:219], v[176:179], 0
  v_exp_f32 v154, v154
  v_mfma_f32_16x16x32_bf16 a[112:115], a[220:223], v[176:179], 0
  ds_read_b64_tr_b16 a[230:231], v17 offset:12288
  v_mfma_f32_16x16x32_bf16 v[192:195], v[208:211], v[176:179], 0
  v_exp_f32 v155, v155
  v_mfma_f32_16x16x32_bf16 v[128:131], a[160:163], v[64:67], v[160:163]
  ds_read_b64_tr_b16 a[232:233], v18 offset:8192
  v_cvt_pk_bf16_f32 v189, v154, v155
  v_mfma_f32_16x16x32_bf16 v[128:131], a[164:167], v[68:71], v[128:131]
  v_exp_f32 v156, v156
  v_mfma_f32_16x16x32_bf16 v[128:131], a[168:171], v[72:75], v[128:131]
  ds_read_b64_tr_b16 a[234:235], v18 offset:12288
  s_add_u32 s46, s29, 49152
  v_mfma_f32_16x16x32_bf16 v[128:131], a[172:175], v[76:79], v[128:131]
  v_exp_f32 v157, v157
  v_mfma_f32_16x16x32_bf16 v[132:135], a[176:179], v[64:67], v[160:163]
  ds_read_b64_tr_b16 a[236:237], v19 offset:8192
  v_cvt_pk_bf16_f32 v190, v156, v157
  v_mfma_f32_16x16x32_bf16 v[132:135], a[180:183], v[68:71], v[132:135]
  v_exp_f32 v158, v158
  v_mfma_f32_16x16x32_bf16 v[132:135], a[184:187], v[72:75], v[132:135]
  ds_read_b64_tr_b16 a[238:239], v19 offset:12288
  buffer_load_dwordx4 v6, s[12:15], s46 offen offset:0 lds
  v_mfma_f32_16x16x32_bf16 v[132:135], a[188:191], v[76:79], v[132:135]
  v_exp_f32 v159, v159
  v_mfma_f32_16x16x32_bf16 a[4:7], a[192:195], v[180:183], 0
  buffer_load_dwordx4 v7, s[12:15], s46 offen offset:1024 lds
  v_cvt_pk_bf16_f32 v191, v158, v159
  v_mfma_f32_16x16x32_bf16 a[20:23], a[196:199], v[180:183], 0
  ds_read_b64_tr_b16 a[240:241], v20 offset:8192
  v_mfma_f32_16x16x32_bf16 a[36:39], a[200:203], v[180:183], 0
  v_exp_f32 v128, v128
  v_mfma_f32_16x16x32_bf16 a[52:55], a[204:207], v[180:183], 0
  ds_read_b64_tr_b16 a[242:243], v20 offset:12288
  buffer_load_dwordx4 v8, s[12:15], s46 offen offset:2048 lds
  v_mfma_f32_16x16x32_bf16 a[68:71], a[208:211], v[180:183], 0
  v_exp_f32 v129, v129
  v_mfma_f32_16x16x32_bf16 a[84:87], a[212:215], v[180:183], 0
  ds_read_b64_tr_b16 a[244:245], v21 offset:8192
  v_cvt_pk_bf16_f32 v176, v128, v129
  v_mfma_f32_16x16x32_bf16 a[100:103], a[216:219], v[180:183], 0
  v_exp_f32 v130, v130
  v_mfma_f32_16x16x32_bf16 a[116:119], a[220:223], v[180:183], 0
  ds_read_b64_tr_b16 a[246:247], v21 offset:12288
  v_mfma_f32_16x16x32_bf16 v[196:199], v[208:211], v[180:183], 0
  v_exp_f32 v131, v131
  v_mfma_f32_16x16x32_bf16 v[136:139], a[160:163], v[80:83], v[164:167]
  ds_read_b64_tr_b16 a[248:249], v22 offset:8192
  v_cvt_pk_bf16_f32 v177, v130, v131
  v_mfma_f32_16x16x32_bf16 v[136:139], a[164:167], v[84:87], v[136:139]
  v_exp_f32 v132, v132
  v_mfma_f32_16x16x32_bf16 v[136:139], a[168:171], v[88:91], v[136:139]
  ds_read_b64_tr_b16 a[250:251], v22 offset:12288
  buffer_load_dwordx4 v9, s[12:15], s46 offen offset:3072 lds
  v_mfma_f32_16x16x32_bf16 v[136:139], a[172:175], v[92:95], v[136:139]
  v_exp_f32 v133, v133
  v_mfma_f32_16x16x32_bf16 v[140:143], a[176:179], v[80:83], v[164:167]
  ds_read_b64_tr_b16 a[252:253], v23 offset:8192
  v_cvt_pk_bf16_f32 v178, v132, v133
  v_mfma_f32_16x16x32_bf16 v[140:143], a[180:183], v[84:87], v[140:143]
  v_exp_f32 v134, v134
  v_mfma_f32_16x16x32_bf16 v[140:143], a[184:187], v[88:91], v[140:143]
  ds_read_b64_tr_b16 a[254:255], v23 offset:12288
  v_mfma_f32_16x16x32_bf16 v[140:143], a[188:191], v[92:95], v[140:143]
  v_exp_f32 v135, v135
  v_mfma_f32_16x16x32_bf16 a[8:11], a[192:195], v[184:187], 0
  s_add_u32 m0, s29, 81920
  v_cvt_pk_bf16_f32 v179, v134, v135
  v_mfma_f32_16x16x32_bf16 a[24:27], a[196:199], v[184:187], 0
  ds_read_b128 a[128:131], v24 offset:0
  v_add_u32 v16, 0xfffe0000, v16
  v_mfma_f32_16x16x32_bf16 a[40:43], a[200:203], v[184:187], 0
  v_exp_f32 v136, v136
  v_mfma_f32_16x16x32_bf16 a[56:59], a[204:207], v[184:187], 0
  buffer_load_dwordx4 v10, s[16:19], s46 offen offset:0 lds
  v_add_u32 v17, 0xfffe0000, v17
  v_mfma_f32_16x16x32_bf16 a[72:75], a[208:211], v[184:187], 0
  v_exp_f32 v137, v137
  v_mfma_f32_16x16x32_bf16 a[88:91], a[212:215], v[184:187], 0
  ds_read_b128 a[132:135], v25 offset:0
  v_cvt_pk_bf16_f32 v180, v136, v137
  v_mfma_f32_16x16x32_bf16 a[104:107], a[216:219], v[184:187], 0
  v_exp_f32 v138, v138
  v_mfma_f32_16x16x32_bf16 a[120:123], a[220:223], v[184:187], 0
  v_add_u32 v18, 0xfffe0000, v18
  v_mfma_f32_16x16x32_bf16 v[200:203], v[208:211], v[184:187], 0
  v_exp_f32 v139, v139
  v_mfma_f32_16x16x32_bf16 v[144:147], a[160:163], v[96:99], v[168:171]
  ds_read_b128 a[136:139], v26 offset:0
  v_cvt_pk_bf16_f32 v181, v138, v139
  v_mfma_f32_16x16x32_bf16 v[144:147], a[164:167], v[100:103], v[144:147]
  v_exp_f32 v140, v140
  v_mfma_f32_16x16x32_bf16 v[144:147], a[168:171], v[104:107], v[144:147]
  buffer_load_dwordx4 v11, s[16:19], s46 offen offset:1024 lds
  v_add_u32 v19, 0xfffe0000, v19
  v_mfma_f32_16x16x32_bf16 v[144:147], a[172:175], v[108:111], v[144:147]
  v_exp_f32 v141, v141
  v_mfma_f32_16x16x32_bf16 v[148:151], a[176:179], v[96:99], v[168:171]
  ds_read_b128 a[140:143], v27 offset:0
  v_cvt_pk_bf16_f32 v182, v140, v141
  v_mfma_f32_16x16x32_bf16 v[148:151], a[180:183], v[100:103], v[148:151]
  v_exp_f32 v142, v142
  v_mfma_f32_16x16x32_bf16 v[148:151], a[184:187], v[104:107], v[148:151]
  v_add_u32 v20, 0xfffe0000, v20
  v_mfma_f32_16x16x32_bf16 v[148:151], a[188:191], v[108:111], v[148:151]
  v_exp_f32 v143, v143
  v_mfma_f32_16x16x32_bf16 a[12:15], a[192:195], v[188:191], 0
  buffer_load_dwordx4 v10, s[16:19], s46 offen offset:2048 lds
  v_cvt_pk_bf16_f32 v183, v142, v143
  v_add_u32 v21, 0xfffe0000, v21
  v_mfma_f32_16x16x32_bf16 a[28:31], a[196:199], v[188:191], 0
  ds_read_b128 a[144:147], v24 offset:4096
  v_add_u32 v22, 0xfffe0000, v22
  v_mfma_f32_16x16x32_bf16 a[44:47], a[200:203], v[188:191], 0
  v_exp_f32 v144, v144
  v_mfma_f32_16x16x32_bf16 a[60:63], a[204:207], v[188:191], 0
  buffer_load_dwordx4 v11, s[16:19], s46 offen offset:3072 lds
  v_add_u32 v23, 0xfffe0000, v23
  v_mfma_f32_16x16x32_bf16 a[76:79], a[208:211], v[188:191], 0
  v_exp_f32 v145, v145
  v_mfma_f32_16x16x32_bf16 a[92:95], a[212:215], v[188:191], 0
  ds_read_b128 a[148:151], v25 offset:4096
  v_cvt_pk_bf16_f32 v184, v144, v145
  v_mfma_f32_16x16x32_bf16 a[108:111], a[216:219], v[188:191], 0
  v_exp_f32 v146, v146
  v_mfma_f32_16x16x32_bf16 a[124:127], a[220:223], v[188:191], 0
  v_mfma_f32_16x16x32_bf16 v[204:207], v[208:211], v[188:191], 0
  v_exp_f32 v147, v147
  v_mfma_f32_16x16x32_bf16 v[152:155], a[160:163], v[112:115], v[172:175]
  ds_read_b128 a[152:155], v26 offset:4096
  v_cvt_pk_bf16_f32 v185, v146, v147
  v_mfma_f32_16x16x32_bf16 v[152:155], a[164:167], v[116:119], v[152:155]
  v_exp_f32 v148, v148
  v_mfma_f32_16x16x32_bf16 v[152:155], a[168:171], v[120:123], v[152:155]
  v_mfma_f32_16x16x32_bf16 v[152:155], a[172:175], v[124:127], v[152:155]
  v_exp_f32 v149, v149
  v_mfma_f32_16x16x32_bf16 v[156:159], a[176:179], v[112:115], v[172:175]
  ds_read_b128 a[156:159], v27 offset:4096
  v_cvt_pk_bf16_f32 v186, v148, v149
  v_mfma_f32_16x16x32_bf16 v[156:159], a[180:183], v[116:119], v[156:159]
  v_exp_f32 v150, v150
  v_mfma_f32_16x16x32_bf16 v[156:159], a[184:187], v[120:123], v[156:159]
  v_mfma_f32_16x16x32_bf16 v[156:159], a[188:191], v[124:127], v[156:159]
  v_exp_f32 v151, v151
  s_waitcnt lgkmcnt(1)
  v_mfma_f32_16x16x32_bf16 a[0:3], a[224:227], v[176:179], a[0:3]
  v_cvt_pk_bf16_f32 v187, v150, v151
  v_mfma_f32_16x16x32_bf16 a[16:19], a[228:231], v[176:179], a[16:19]
  ds_read_b64_tr_b16 a[192:193], v16 offset:0
  s_add_u32 m0, s29, 98304
  v_mfma_f32_16x16x32_bf16 a[32:35], a[232:235], v[176:179], a[32:35]
  v_exp_f32 v152, v152
  v_mfma_f32_16x16x32_bf16 a[48:51], a[236:239], v[176:179], a[48:51]
  ds_read_b64_tr_b16 a[194:195], v16 offset:4096
  v_mfma_f32_16x16x32_bf16 a[64:67], a[240:243], v[176:179], a[64:67]
  v_exp_f32 v153, v153
  v_mfma_f32_16x16x32_bf16 a[80:83], a[244:247], v[176:179], a[80:83]
  ds_read_b64_tr_b16 a[196:197], v17 offset:0
  v_cvt_pk_bf16_f32 v188, v152, v153
  v_mfma_f32_16x16x32_bf16 a[96:99], a[248:251], v[176:179], a[96:99]
  v_exp_f32 v154, v154
  v_mfma_f32_16x16x32_bf16 a[112:115], a[252:255], v[176:179], a[112:115]
  ds_read_b64_tr_b16 a[198:199], v17 offset:4096
  s_add_u32 s46, s29, 65536
  v_mfma_f32_16x16x32_bf16 v[192:195], v[208:211], v[176:179], v[192:195]
  v_exp_f32 v155, v155
  v_mfma_f32_16x16x32_bf16 v[128:131], a[128:131], v[64:67], v[160:163]
  ds_read_b64_tr_b16 a[200:201], v18 offset:0
  v_cvt_pk_bf16_f32 v189, v154, v155
  v_mfma_f32_16x16x32_bf16 v[128:131], a[132:135], v[68:71], v[128:131]
  v_exp_f32 v156, v156
  v_mfma_f32_16x16x32_bf16 v[128:131], a[136:139], v[72:75], v[128:131]
  ds_read_b64_tr_b16 a[202:203], v18 offset:4096
  v_mfma_f32_16x16x32_bf16 v[128:131], a[140:143], v[76:79], v[128:131]
  v_exp_f32 v157, v157
  v_mfma_f32_16x16x32_bf16 v[132:135], a[144:147], v[64:67], v[160:163]
  ds_read_b64_tr_b16 a[204:205], v19 offset:0
  v_cvt_pk_bf16_f32 v190, v156, v157
  v_mfma_f32_16x16x32_bf16 v[132:135], a[148:151], v[68:71], v[132:135]
  v_exp_f32 v158, v158
  v_mfma_f32_16x16x32_bf16 v[132:135], a[152:155], v[72:75], v[132:135]
  ds_read_b64_tr_b16 a[206:207], v19 offset:4096
  buffer_load_dwordx4 v6, s[12:15], s46 offen offset:0 lds
  s_waitcnt lgkmcnt(3)
  v_mfma_f32_16x16x32_bf16 v[132:135], a[156:159], v[76:79], v[132:135]
  v_exp_f32 v159, v159
  v_mfma_f32_16x16x32_bf16 a[4:7], a[224:227], v[180:183], a[4:7]
  v_cvt_pk_bf16_f32 v191, v158, v159
  v_mfma_f32_16x16x32_bf16 a[20:23], a[228:231], v[180:183], a[20:23]
  ds_read_b64_tr_b16 a[208:209], v20 offset:0
  buffer_load_dwordx4 v7, s[12:15], s46 offen offset:1024 lds
  v_mfma_f32_16x16x32_bf16 a[36:39], a[232:235], v[180:183], a[36:39]
  v_exp_f32 v128, v128
  v_mfma_f32_16x16x32_bf16 a[52:55], a[236:239], v[180:183], a[52:55]
  ds_read_b64_tr_b16 a[210:211], v20 offset:4096
  v_mfma_f32_16x16x32_bf16 a[68:71], a[240:243], v[180:183], a[68:71]
  v_exp_f32 v129, v129
  v_mfma_f32_16x16x32_bf16 a[84:87], a[244:247], v[180:183], a[84:87]
  ds_read_b64_tr_b16 a[212:213], v21 offset:0
  v_cvt_pk_bf16_f32 v176, v128, v129
  v_mfma_f32_16x16x32_bf16 a[100:103], a[248:251], v[180:183], a[100:103]
  v_exp_f32 v130, v130
  v_mfma_f32_16x16x32_bf16 a[116:119], a[252:255], v[180:183], a[116:119]
  ds_read_b64_tr_b16 a[214:215], v21 offset:4096
  buffer_load_dwordx4 v8, s[12:15], s46 offen offset:2048 lds
  v_mfma_f32_16x16x32_bf16 v[196:199], v[208:211], v[180:183], v[196:199]
  v_exp_f32 v131, v131
  v_mfma_f32_16x16x32_bf16 v[136:139], a[128:131], v[80:83], v[164:167]
  ds_read_b64_tr_b16 a[216:217], v22 offset:0
  v_cvt_pk_bf16_f32 v177, v130, v131
  v_mfma_f32_16x16x32_bf16 v[136:139], a[132:135], v[84:87], v[136:139]
  v_exp_f32 v132, v132
  v_mfma_f32_16x16x32_bf16 v[136:139], a[136:139], v[88:91], v[136:139]
  ds_read_b64_tr_b16 a[218:219], v22 offset:4096
  v_mfma_f32_16x16x32_bf16 v[136:139], a[140:143], v[92:95], v[136:139]
  v_exp_f32 v133, v133
  v_mfma_f32_16x16x32_bf16 v[140:143], a[144:147], v[80:83], v[164:167]
  ds_read_b64_tr_b16 a[220:221], v23 offset:0
  v_cvt_pk_bf16_f32 v178, v132, v133
  v_mfma_f32_16x16x32_bf16 v[140:143], a[148:151], v[84:87], v[140:143]
  v_exp_f32 v134, v134
  v_mfma_f32_16x16x32_bf16 v[140:143], a[152:155], v[88:91], v[140:143]
  ds_read_b64_tr_b16 a[222:223], v23 offset:4096
  buffer_load_dwordx4 v9, s[12:15], s46 offen offset:3072 lds
  v_mfma_f32_16x16x32_bf16 v[140:143], a[156:159], v[92:95], v[140:143]
  v_exp_f32 v135, v135
  v_mfma_f32_16x16x32_bf16 a[8:11], a[224:227], v[184:187], a[8:11]
  v_cvt_pk_bf16_f32 v179, v134, v135
  v_mfma_f32_16x16x32_bf16 a[24:27], a[228:231], v[184:187], a[24:27]
  ds_read_b128 a[160:163], v24 offset:8192
  s_add_u32 m0, s29, 114688
  v_mfma_f32_16x16x32_bf16 a[40:43], a[232:235], v[184:187], a[40:43]
  v_exp_f32 v136, v136
  v_mfma_f32_16x16x32_bf16 a[56:59], a[236:239], v[184:187], a[56:59]
  v_mfma_f32_16x16x32_bf16 a[72:75], a[240:243], v[184:187], a[72:75]
  v_exp_f32 v137, v137
  v_mfma_f32_16x16x32_bf16 a[88:91], a[244:247], v[184:187], a[88:91]
  ds_read_b128 a[164:167], v25 offset:8192
  v_cvt_pk_bf16_f32 v180, v136, v137
  v_mfma_f32_16x16x32_bf16 a[104:107], a[248:251], v[184:187], a[104:107]
  v_exp_f32 v138, v138
  v_mfma_f32_16x16x32_bf16 a[120:123], a[252:255], v[184:187], a[120:123]
  buffer_load_dwordx4 v10, s[16:19], s46 offen offset:0 lds
  v_mfma_f32_16x16x32_bf16 v[200:203], v[208:211], v[184:187], v[200:203]
  v_exp_f32 v139, v139
  v_mfma_f32_16x16x32_bf16 v[144:147], a[128:131], v[96:99], v[168:171]
  ds_read_b128 a[168:171], v26 offset:8192
  v_cvt_pk_bf16_f32 v181, v138, v139
  v_mfma_f32_16x16x32_bf16 v[144:147], a[132:135], v[100:103], v[144:147]
  v_exp_f32 v140, v140
  v_mfma_f32_16x16x32_bf16 v[144:147], a[136:139], v[104:107], v[144:147]
  v_mfma_f32_16x16x32_bf16 v[144:147], a[140:143], v[108:111], v[144:147]
  v_exp_f32 v141, v141
  v_mfma_f32_16x16x32_bf16 v[148:151], a[144:147], v[96:99], v[168:171]
  ds_read_b128 a[172:175], v27 offset:8192
  v_cvt_pk_bf16_f32 v182, v140, v141
  v_mfma_f32_16x16x32_bf16 v[148:151], a[148:151], v[100:103], v[148:151]
  v_exp_f32 v142, v142
  v_mfma_f32_16x16x32_bf16 v[148:151], a[152:155], v[104:107], v[148:151]
  buffer_load_dwordx4 v11, s[16:19], s46 offen offset:1024 lds
  v_mfma_f32_16x16x32_bf16 v[148:151], a[156:159], v[108:111], v[148:151]
  v_exp_f32 v143, v143
  v_mfma_f32_16x16x32_bf16 a[12:15], a[224:227], v[188:191], a[12:15]
  v_cvt_pk_bf16_f32 v183, v142, v143
  v_mfma_f32_16x16x32_bf16 a[28:31], a[228:231], v[188:191], a[28:31]
  ds_read_b128 a[176:179], v24 offset:12288
  buffer_load_dwordx4 v10, s[16:19], s46 offen offset:2048 lds
  v_mfma_f32_16x16x32_bf16 a[44:47], a[232:235], v[188:191], a[44:47]
  v_exp_f32 v144, v144
  v_mfma_f32_16x16x32_bf16 a[60:63], a[236:239], v[188:191], a[60:63]
  v_mfma_f32_16x16x32_bf16 a[76:79], a[240:243], v[188:191], a[76:79]
  v_exp_f32 v145, v145
  v_mfma_f32_16x16x32_bf16 a[92:95], a[244:247], v[188:191], a[92:95]
  ds_read_b128 a[180:183], v25 offset:12288
  v_cvt_pk_bf16_f32 v184, v144, v145
  v_mfma_f32_16x16x32_bf16 a[108:111], a[248:251], v[188:191], a[108:111]
  v_exp_f32 v146, v146
  v_mfma_f32_16x16x32_bf16 a[124:127], a[252:255], v[188:191], a[124:127]
  buffer_load_dwordx4 v11, s[16:19], s46 offen offset:3072 lds
  v_mfma_f32_16x16x32_bf16 v[204:207], v[208:211], v[188:191], v[204:207]
  v_exp_f32 v147, v147
  v_mfma_f32_16x16x32_bf16 v[152:155], a[128:131], v[112:115], v[172:175]
  ds_read_b128 a[184:187], v26 offset:12288
  v_cvt_pk_bf16_f32 v185, v146, v147
  v_mfma_f32_16x16x32_bf16 v[152:155], a[132:135], v[116:119], v[152:155]
  v_exp_f32 v148, v148
  v_mfma_f32_16x16x32_bf16 v[152:155], a[136:139], v[120:123], v[152:155]
  v_mfma_f32_16x16x32_bf16 v[152:155], a[140:143], v[124:127], v[152:155]
  v_exp_f32 v149, v149
  v_mfma_f32_16x16x32_bf16 v[156:159], a[144:147], v[112:115], v[172:175]
  ds_read_b128 a[188:191], v27 offset:12288
  v_cvt_pk_bf16_f32 v186, v148, v149
  v_mfma_f32_16x16x32_bf16 v[156:159], a[148:151], v[116:119], v[156:159]
  v_exp_f32 v150, v150
  v_mfma_f32_16x16x32_bf16 v[156:159], a[152:155], v[120:123], v[156:159]
  v_mfma_f32_16x16x32_bf16 v[156:159], a[156:159], v[124:127], v[156:159]
  v_exp_f32 v151, v151
  s_mov_b32 s34, 1
  s_mov_b32 s38, 32768
  s_mov_b32 s35, 32768
  s_add_u32 s36, s29, 131072
  s_add_u32 s37, s29, 81920
adaLN_cond__sliding_block_cached__glu_gated_bilinear__prompt_kernel_kv_loop:
  v_mfma_f32_16x16x32_bf16 a[0:3], a[192:195], v[176:179], a[0:3]
  s_waitcnt vmcnt(16)
  s_barrier
  v_cvt_pk_bf16_f32 v187, v150, v151
  v_mfma_f32_16x16x32_bf16 a[16:19], a[196:199], v[176:179], a[16:19]
  ds_read_b64_tr_b16 a[224:225], v16 offset:8192
  v_add_u32 v24, s35, v24
  s_waitcnt lgkmcnt(1)
  v_mfma_f32_16x16x32_bf16 a[32:35], a[200:203], v[176:179], a[32:35]
  v_exp_f32 v152, v152
  v_mfma_f32_16x16x32_bf16 a[48:51], a[204:207], v[176:179], a[48:51]
  ds_read_b64_tr_b16 a[226:227], v16 offset:12288
  v_mfma_f32_16x16x32_bf16 a[64:67], a[208:211], v[176:179], a[64:67]
  v_exp_f32 v153, v153
  v_mfma_f32_16x16x32_bf16 a[80:83], a[212:215], v[176:179], a[80:83]
  ds_read_b64_tr_b16 a[228:229], v17 offset:8192
  v_cvt_pk_bf16_f32 v188, v152, v153
  v_mfma_f32_16x16x32_bf16 a[96:99], a[216:219], v[176:179], a[96:99]
  v_exp_f32 v154, v154
  v_mfma_f32_16x16x32_bf16 a[112:115], a[220:223], v[176:179], a[112:115]
  ds_read_b64_tr_b16 a[230:231], v17 offset:12288
  v_add_u32 v25, s35, v25
  v_mfma_f32_16x16x32_bf16 v[192:195], v[208:211], v[176:179], v[192:195]
  v_exp_f32 v155, v155
  v_mfma_f32_16x16x32_bf16 v[128:131], a[160:163], v[64:67], v[160:163]
  ds_read_b64_tr_b16 a[232:233], v18 offset:8192
  v_cvt_pk_bf16_f32 v189, v154, v155
  v_mfma_f32_16x16x32_bf16 v[128:131], a[164:167], v[68:71], v[128:131]
  v_exp_f32 v156, v156
  v_mfma_f32_16x16x32_bf16 v[128:131], a[168:171], v[72:75], v[128:131]
  ds_read_b64_tr_b16 a[234:235], v18 offset:12288
  v_mfma_f32_16x16x32_bf16 v[128:131], a[172:175], v[76:79], v[128:131]
  v_exp_f32 v157, v157
  v_mfma_f32_16x16x32_bf16 v[132:135], a[176:179], v[64:67], v[160:163]
  ds_read_b64_tr_b16 a[236:237], v19 offset:8192
  v_cvt_pk_bf16_f32 v190, v156, v157
  v_mfma_f32_16x16x32_bf16 v[132:135], a[180:183], v[68:71], v[132:135]
  v_exp_f32 v158, v158
  v_mfma_f32_16x16x32_bf16 v[132:135], a[184:187], v[72:75], v[132:135]
  ds_read_b64_tr_b16 a[238:239], v19 offset:12288
  v_add_u32 v26, s35, v26
  v_mfma_f32_16x16x32_bf16 v[132:135], a[188:191], v[76:79], v[132:135]
  v_exp_f32 v159, v159
  v_mfma_f32_16x16x32_bf16 a[4:7], a[192:195], v[180:183], a[4:7]
  v_cvt_pk_bf16_f32 v191, v158, v159
  v_mfma_f32_16x16x32_bf16 a[20:23], a[196:199], v[180:183], a[20:23]
  ds_read_b64_tr_b16 a[240:241], v20 offset:8192
  v_add_u32 v27, s35, v27
  v_mfma_f32_16x16x32_bf16 a[36:39], a[200:203], v[180:183], a[36:39]
  v_exp_f32 v128, v128
  v_mfma_f32_16x16x32_bf16 a[52:55], a[204:207], v[180:183], a[52:55]
  ds_read_b64_tr_b16 a[242:243], v20 offset:12288
  v_mfma_f32_16x16x32_bf16 a[68:71], a[208:211], v[180:183], a[68:71]
  v_exp_f32 v129, v129
  v_mfma_f32_16x16x32_bf16 a[84:87], a[212:215], v[180:183], a[84:87]
  ds_read_b64_tr_b16 a[244:245], v21 offset:8192
  v_cvt_pk_bf16_f32 v176, v128, v129
  v_mfma_f32_16x16x32_bf16 a[100:103], a[216:219], v[180:183], a[100:103]
  v_exp_f32 v130, v130
  v_mfma_f32_16x16x32_bf16 a[116:119], a[220:223], v[180:183], a[116:119]
  ds_read_b64_tr_b16 a[246:247], v21 offset:12288
  v_mfma_f32_16x16x32_bf16 v[196:199], v[208:211], v[180:183], v[196:199]
  v_exp_f32 v131, v131
  v_mfma_f32_16x16x32_bf16 v[136:139], a[160:163], v[80:83], v[164:167]
  ds_read_b64_tr_b16 a[248:249], v22 offset:8192
  v_cvt_pk_bf16_f32 v177, v130, v131
  v_mfma_f32_16x16x32_bf16 v[136:139], a[164:167], v[84:87], v[136:139]
  v_exp_f32 v132, v132
  v_mfma_f32_16x16x32_bf16 v[136:139], a[168:171], v[88:91], v[136:139]
  ds_read_b64_tr_b16 a[250:251], v22 offset:12288
  v_mfma_f32_16x16x32_bf16 v[136:139], a[172:175], v[92:95], v[136:139]
  v_exp_f32 v133, v133
  v_mfma_f32_16x16x32_bf16 v[140:143], a[176:179], v[80:83], v[164:167]
  ds_read_b64_tr_b16 a[252:253], v23 offset:8192
  v_cvt_pk_bf16_f32 v178, v132, v133
  v_mfma_f32_16x16x32_bf16 v[140:143], a[180:183], v[84:87], v[140:143]
  v_exp_f32 v134, v134
  v_mfma_f32_16x16x32_bf16 v[140:143], a[184:187], v[88:91], v[140:143]
  ds_read_b64_tr_b16 a[254:255], v23 offset:12288
  v_mfma_f32_16x16x32_bf16 v[140:143], a[188:191], v[92:95], v[140:143]
  v_exp_f32 v135, v135
  v_mfma_f32_16x16x32_bf16 a[8:11], a[192:195], v[184:187], a[8:11]
  v_cvt_pk_bf16_f32 v179, v134, v135
  v_mfma_f32_16x16x32_bf16 a[24:27], a[196:199], v[184:187], a[24:27]
  ds_read_b128 a[128:131], v24 offset:0
  v_add_u32 v16, s35, v16
  v_mfma_f32_16x16x32_bf16 a[40:43], a[200:203], v[184:187], a[40:43]
  v_exp_f32 v136, v136
  v_mfma_f32_16x16x32_bf16 a[56:59], a[204:207], v[184:187], a[56:59]
  v_add_u32 v17, s35, v17
  v_mfma_f32_16x16x32_bf16 a[72:75], a[208:211], v[184:187], a[72:75]
  v_exp_f32 v137, v137
  v_mfma_f32_16x16x32_bf16 a[88:91], a[212:215], v[184:187], a[88:91]
  ds_read_b128 a[132:135], v25 offset:0
  v_cvt_pk_bf16_f32 v180, v136, v137
  v_mfma_f32_16x16x32_bf16 a[104:107], a[216:219], v[184:187], a[104:107]
  v_exp_f32 v138, v138
  v_mfma_f32_16x16x32_bf16 a[120:123], a[220:223], v[184:187], a[120:123]
  v_add_u32 v18, s35, v18
  v_mfma_f32_16x16x32_bf16 v[200:203], v[208:211], v[184:187], v[200:203]
  v_exp_f32 v139, v139
  v_mfma_f32_16x16x32_bf16 v[144:147], a[160:163], v[96:99], v[168:171]
  ds_read_b128 a[136:139], v26 offset:0
  v_cvt_pk_bf16_f32 v181, v138, v139
  v_mfma_f32_16x16x32_bf16 v[144:147], a[164:167], v[100:103], v[144:147]
  v_exp_f32 v140, v140
  v_mfma_f32_16x16x32_bf16 v[144:147], a[168:171], v[104:107], v[144:147]
  v_add_u32 v19, s35, v19
  v_mfma_f32_16x16x32_bf16 v[144:147], a[172:175], v[108:111], v[144:147]
  v_exp_f32 v141, v141
  v_mfma_f32_16x16x32_bf16 v[148:151], a[176:179], v[96:99], v[168:171]
  ds_read_b128 a[140:143], v27 offset:0
  v_cvt_pk_bf16_f32 v182, v140, v141
  v_mfma_f32_16x16x32_bf16 v[148:151], a[180:183], v[100:103], v[148:151]
  v_exp_f32 v142, v142
  v_mfma_f32_16x16x32_bf16 v[148:151], a[184:187], v[104:107], v[148:151]
  v_add_u32 v20, s35, v20
  v_mfma_f32_16x16x32_bf16 v[148:151], a[188:191], v[108:111], v[148:151]
  v_exp_f32 v143, v143
  v_mfma_f32_16x16x32_bf16 a[12:15], a[192:195], v[188:191], a[12:15]
  v_cvt_pk_bf16_f32 v183, v142, v143
  v_add_u32 v21, s35, v21
  v_mfma_f32_16x16x32_bf16 a[28:31], a[196:199], v[188:191], a[28:31]
  ds_read_b128 a[144:147], v24 offset:4096
  v_add_u32 v22, s35, v22
  v_mfma_f32_16x16x32_bf16 a[44:47], a[200:203], v[188:191], a[44:47]
  v_exp_f32 v144, v144
  v_mfma_f32_16x16x32_bf16 a[60:63], a[204:207], v[188:191], a[60:63]
  v_add_u32 v23, s35, v23
  v_mfma_f32_16x16x32_bf16 a[76:79], a[208:211], v[188:191], a[76:79]
  v_exp_f32 v145, v145
  v_mfma_f32_16x16x32_bf16 a[92:95], a[212:215], v[188:191], a[92:95]
  ds_read_b128 a[148:151], v25 offset:4096
  v_cvt_pk_bf16_f32 v184, v144, v145
  v_mfma_f32_16x16x32_bf16 a[108:111], a[216:219], v[188:191], a[108:111]
  v_exp_f32 v146, v146
  v_mfma_f32_16x16x32_bf16 a[124:127], a[220:223], v[188:191], a[124:127]
  v_mfma_f32_16x16x32_bf16 v[204:207], v[208:211], v[188:191], v[204:207]
  v_exp_f32 v147, v147
  v_mfma_f32_16x16x32_bf16 v[152:155], a[160:163], v[112:115], v[172:175]
  ds_read_b128 a[152:155], v26 offset:4096
  v_cvt_pk_bf16_f32 v185, v146, v147
  v_mfma_f32_16x16x32_bf16 v[152:155], a[164:167], v[116:119], v[152:155]
  v_exp_f32 v148, v148
  v_mfma_f32_16x16x32_bf16 v[152:155], a[168:171], v[120:123], v[152:155]
  v_mfma_f32_16x16x32_bf16 v[152:155], a[172:175], v[124:127], v[152:155]
  v_exp_f32 v149, v149
  v_mfma_f32_16x16x32_bf16 v[156:159], a[176:179], v[112:115], v[172:175]
  ds_read_b128 a[156:159], v27 offset:4096
  v_cvt_pk_bf16_f32 v186, v148, v149
  v_mfma_f32_16x16x32_bf16 v[156:159], a[180:183], v[116:119], v[156:159]
  v_exp_f32 v150, v150
  v_mfma_f32_16x16x32_bf16 v[156:159], a[184:187], v[120:123], v[156:159]
  v_mfma_f32_16x16x32_bf16 v[156:159], a[188:191], v[124:127], v[156:159]
  v_exp_f32 v151, v151
  s_waitcnt lgkmcnt(1)
  v_mfma_f32_16x16x32_bf16 a[0:3], a[224:227], v[176:179], a[0:3]
  v_cvt_pk_bf16_f32 v187, v150, v151
  v_mfma_f32_16x16x32_bf16 a[16:19], a[228:231], v[176:179], a[16:19]
  ds_read_b64_tr_b16 a[192:193], v16 offset:0
  s_mov_b32 m0, s36
  v_mfma_f32_16x16x32_bf16 a[32:35], a[232:235], v[176:179], a[32:35]
  v_exp_f32 v152, v152
  v_mfma_f32_16x16x32_bf16 a[48:51], a[236:239], v[176:179], a[48:51]
  ds_read_b64_tr_b16 a[194:195], v16 offset:4096
  v_mfma_f32_16x16x32_bf16 a[64:67], a[240:243], v[176:179], a[64:67]
  v_exp_f32 v153, v153
  v_mfma_f32_16x16x32_bf16 a[80:83], a[244:247], v[176:179], a[80:83]
  ds_read_b64_tr_b16 a[196:197], v17 offset:0
  v_cvt_pk_bf16_f32 v188, v152, v153
  v_mfma_f32_16x16x32_bf16 a[96:99], a[248:251], v[176:179], a[96:99]
  v_exp_f32 v154, v154
  v_mfma_f32_16x16x32_bf16 a[112:115], a[252:255], v[176:179], a[112:115]
  ds_read_b64_tr_b16 a[198:199], v17 offset:4096
  s_nop 0
  v_mfma_f32_16x16x32_bf16 v[192:195], v[208:211], v[176:179], v[192:195]
  v_exp_f32 v155, v155
  v_mfma_f32_16x16x32_bf16 v[128:131], a[128:131], v[64:67], v[160:163]
  ds_read_b64_tr_b16 a[200:201], v18 offset:0
  v_cvt_pk_bf16_f32 v189, v154, v155
  v_mfma_f32_16x16x32_bf16 v[128:131], a[132:135], v[68:71], v[128:131]
  v_exp_f32 v156, v156
  v_mfma_f32_16x16x32_bf16 v[128:131], a[136:139], v[72:75], v[128:131]
  ds_read_b64_tr_b16 a[202:203], v18 offset:4096
  v_mfma_f32_16x16x32_bf16 v[128:131], a[140:143], v[76:79], v[128:131]
  v_exp_f32 v157, v157
  v_mfma_f32_16x16x32_bf16 v[132:135], a[144:147], v[64:67], v[160:163]
  ds_read_b64_tr_b16 a[204:205], v19 offset:0
  v_cvt_pk_bf16_f32 v190, v156, v157
  v_mfma_f32_16x16x32_bf16 v[132:135], a[148:151], v[68:71], v[132:135]
  v_exp_f32 v158, v158
  v_mfma_f32_16x16x32_bf16 v[132:135], a[152:155], v[72:75], v[132:135]
  ds_read_b64_tr_b16 a[206:207], v19 offset:4096
  buffer_load_dwordx4 v6, s[12:15], s37 offen offset:0 lds
  s_waitcnt lgkmcnt(3)
  v_mfma_f32_16x16x32_bf16 v[132:135], a[156:159], v[76:79], v[132:135]
  v_exp_f32 v159, v159
  v_mfma_f32_16x16x32_bf16 a[4:7], a[224:227], v[180:183], a[4:7]
  v_cvt_pk_bf16_f32 v191, v158, v159
  v_mfma_f32_16x16x32_bf16 a[20:23], a[228:231], v[180:183], a[20:23]
  ds_read_b64_tr_b16 a[208:209], v20 offset:0
  buffer_load_dwordx4 v7, s[12:15], s37 offen offset:1024 lds
  v_mfma_f32_16x16x32_bf16 a[36:39], a[232:235], v[180:183], a[36:39]
  v_exp_f32 v128, v128
  v_mfma_f32_16x16x32_bf16 a[52:55], a[236:239], v[180:183], a[52:55]
  ds_read_b64_tr_b16 a[210:211], v20 offset:4096
  v_mfma_f32_16x16x32_bf16 a[68:71], a[240:243], v[180:183], a[68:71]
  v_exp_f32 v129, v129
  v_mfma_f32_16x16x32_bf16 a[84:87], a[244:247], v[180:183], a[84:87]
  ds_read_b64_tr_b16 a[212:213], v21 offset:0
  v_cvt_pk_bf16_f32 v176, v128, v129
  v_mfma_f32_16x16x32_bf16 a[100:103], a[248:251], v[180:183], a[100:103]
  v_exp_f32 v130, v130
  v_mfma_f32_16x16x32_bf16 a[116:119], a[252:255], v[180:183], a[116:119]
  ds_read_b64_tr_b16 a[214:215], v21 offset:4096
  buffer_load_dwordx4 v8, s[12:15], s37 offen offset:2048 lds
  v_mfma_f32_16x16x32_bf16 v[196:199], v[208:211], v[180:183], v[196:199]
  v_exp_f32 v131, v131
  v_mfma_f32_16x16x32_bf16 v[136:139], a[128:131], v[80:83], v[164:167]
  ds_read_b64_tr_b16 a[216:217], v22 offset:0
  v_cvt_pk_bf16_f32 v177, v130, v131
  v_mfma_f32_16x16x32_bf16 v[136:139], a[132:135], v[84:87], v[136:139]
  v_exp_f32 v132, v132
  v_mfma_f32_16x16x32_bf16 v[136:139], a[136:139], v[88:91], v[136:139]
  ds_read_b64_tr_b16 a[218:219], v22 offset:4096
  v_mfma_f32_16x16x32_bf16 v[136:139], a[140:143], v[92:95], v[136:139]
  v_exp_f32 v133, v133
  v_mfma_f32_16x16x32_bf16 v[140:143], a[144:147], v[80:83], v[164:167]
  ds_read_b64_tr_b16 a[220:221], v23 offset:0
  v_cvt_pk_bf16_f32 v178, v132, v133
  v_mfma_f32_16x16x32_bf16 v[140:143], a[148:151], v[84:87], v[140:143]
  v_exp_f32 v134, v134
  v_mfma_f32_16x16x32_bf16 v[140:143], a[152:155], v[88:91], v[140:143]
  ds_read_b64_tr_b16 a[222:223], v23 offset:4096
  buffer_load_dwordx4 v9, s[12:15], s37 offen offset:3072 lds
  v_mfma_f32_16x16x32_bf16 v[140:143], a[156:159], v[92:95], v[140:143]
  v_exp_f32 v135, v135
  v_mfma_f32_16x16x32_bf16 a[8:11], a[224:227], v[184:187], a[8:11]
  v_cvt_pk_bf16_f32 v179, v134, v135
  v_mfma_f32_16x16x32_bf16 a[24:27], a[228:231], v[184:187], a[24:27]
  ds_read_b128 a[160:163], v24 offset:8192
  s_add_u32 m0, s36, 16384
  v_mfma_f32_16x16x32_bf16 a[40:43], a[232:235], v[184:187], a[40:43]
  v_exp_f32 v136, v136
  v_mfma_f32_16x16x32_bf16 a[56:59], a[236:239], v[184:187], a[56:59]
  v_mfma_f32_16x16x32_bf16 a[72:75], a[240:243], v[184:187], a[72:75]
  v_exp_f32 v137, v137
  v_mfma_f32_16x16x32_bf16 a[88:91], a[244:247], v[184:187], a[88:91]
  ds_read_b128 a[164:167], v25 offset:8192
  v_cvt_pk_bf16_f32 v180, v136, v137
  v_mfma_f32_16x16x32_bf16 a[104:107], a[248:251], v[184:187], a[104:107]
  v_exp_f32 v138, v138
  v_mfma_f32_16x16x32_bf16 a[120:123], a[252:255], v[184:187], a[120:123]
  buffer_load_dwordx4 v10, s[16:19], s37 offen offset:0 lds
  v_mfma_f32_16x16x32_bf16 v[200:203], v[208:211], v[184:187], v[200:203]
  v_exp_f32 v139, v139
  v_mfma_f32_16x16x32_bf16 v[144:147], a[128:131], v[96:99], v[168:171]
  ds_read_b128 a[168:171], v26 offset:8192
  v_cvt_pk_bf16_f32 v181, v138, v139
  v_mfma_f32_16x16x32_bf16 v[144:147], a[132:135], v[100:103], v[144:147]
  v_exp_f32 v140, v140
  v_mfma_f32_16x16x32_bf16 v[144:147], a[136:139], v[104:107], v[144:147]
  v_mfma_f32_16x16x32_bf16 v[144:147], a[140:143], v[108:111], v[144:147]
  v_exp_f32 v141, v141
  v_mfma_f32_16x16x32_bf16 v[148:151], a[144:147], v[96:99], v[168:171]
  ds_read_b128 a[172:175], v27 offset:8192
  v_cvt_pk_bf16_f32 v182, v140, v141
  v_mfma_f32_16x16x32_bf16 v[148:151], a[148:151], v[100:103], v[148:151]
  v_exp_f32 v142, v142
  v_mfma_f32_16x16x32_bf16 v[148:151], a[152:155], v[104:107], v[148:151]
  buffer_load_dwordx4 v11, s[16:19], s37 offen offset:1024 lds
  v_mfma_f32_16x16x32_bf16 v[148:151], a[156:159], v[108:111], v[148:151]
  v_exp_f32 v143, v143
  v_mfma_f32_16x16x32_bf16 a[12:15], a[224:227], v[188:191], a[12:15]
  v_cvt_pk_bf16_f32 v183, v142, v143
  v_mfma_f32_16x16x32_bf16 a[28:31], a[228:231], v[188:191], a[28:31]
  ds_read_b128 a[176:179], v24 offset:12288
  buffer_load_dwordx4 v10, s[16:19], s37 offen offset:2048 lds
  v_mfma_f32_16x16x32_bf16 a[44:47], a[232:235], v[188:191], a[44:47]
  v_exp_f32 v144, v144
  v_mfma_f32_16x16x32_bf16 a[60:63], a[236:239], v[188:191], a[60:63]
  v_mfma_f32_16x16x32_bf16 a[76:79], a[240:243], v[188:191], a[76:79]
  v_exp_f32 v145, v145
  v_mfma_f32_16x16x32_bf16 a[92:95], a[244:247], v[188:191], a[92:95]
  ds_read_b128 a[180:183], v25 offset:12288
  v_cvt_pk_bf16_f32 v184, v144, v145
  v_mfma_f32_16x16x32_bf16 a[108:111], a[248:251], v[188:191], a[108:111]
  v_exp_f32 v146, v146
  v_mfma_f32_16x16x32_bf16 a[124:127], a[252:255], v[188:191], a[124:127]
  buffer_load_dwordx4 v11, s[16:19], s37 offen offset:3072 lds
  v_mfma_f32_16x16x32_bf16 v[204:207], v[208:211], v[188:191], v[204:207]
  v_exp_f32 v147, v147
  v_mfma_f32_16x16x32_bf16 v[152:155], a[128:131], v[112:115], v[172:175]
  ds_read_b128 a[184:187], v26 offset:12288
  v_cvt_pk_bf16_f32 v185, v146, v147
  v_mfma_f32_16x16x32_bf16 v[152:155], a[132:135], v[116:119], v[152:155]
  v_exp_f32 v148, v148
  v_mfma_f32_16x16x32_bf16 v[152:155], a[136:139], v[120:123], v[152:155]
  s_add_u32 s34, s34, 1
  v_mfma_f32_16x16x32_bf16 v[152:155], a[140:143], v[124:127], v[152:155]
  s_add_u32 s37, s37, 16384
  v_exp_f32 v149, v149
  v_mfma_f32_16x16x32_bf16 v[156:159], a[144:147], v[112:115], v[172:175]
  ds_read_b128 a[188:191], v27 offset:12288
  s_add_u32 s36, s36, 32768
  v_cvt_pk_bf16_f32 v186, v148, v149
  v_mfma_f32_16x16x32_bf16 v[156:159], a[148:151], v[116:119], v[156:159]
  s_cmp_ge_u32 s36, 163840
  s_cselect_b32 s36, s29, s36
  v_exp_f32 v150, v150
  v_mfma_f32_16x16x32_bf16 v[156:159], a[152:155], v[120:123], v[156:159]
  s_cmp_eq_u32 s34, 5
  s_cselect_b32 s35, 0xfffe0000, s38
  v_mfma_f32_16x16x32_bf16 v[156:159], a[156:159], v[124:127], v[156:159]
  v_exp_f32 v151, v151
  s_cmp_lg_u32 s34, 5
  s_cbranch_scc1 Lnopf18
  v_lshlrev_b32 v248, 7, v0
  v_min_u32 v249, 10, v0
  s_lshl_b32 s41, s2, 2
  s_add_u32 s41, s41, s26
  s_mul_i32 s41, s41, 11
  v_add_u32 v249, s41, v249
  v_lshlrev_b32 v249, 7, v249
  buffer_load_dword v250, v248, s[20:23], s30 offen
  buffer_load_dword v250, v249, s[48:51], 0 offen
  buffer_load_dword v250, v249, s[52:55], 0 offen
  buffer_load_dword v250, v249, s[56:59], 0 offen
Lnopf18:
  s_cmp_lt_u32 s34, 7
  s_cbranch_scc1 adaLN_cond__sliding_block_cached__glu_gated_bilinear__prompt_kernel_kv_loop
  v_mfma_f32_16x16x32_bf16 a[0:3], a[192:195], v[176:179], a[0:3]
  v_cvt_pk_bf16_f32 v187, v150, v151
  v_mfma_f32_16x16x32_bf16 a[16:19], a[196:199], v[176:179], a[16:19]
  ds_read_b64_tr_b16 a[224:225], v16 offset:8192
  s_waitcnt lgkmcnt(1)
  v_mfma_f32_16x16x32_bf16 a[32:35], a[200:203], v[176:179], a[32:35]
  v_exp_f32 v152, v152
  v_mfma_f32_16x16x32_bf16 a[48:51], a[204:207], v[176:179], a[48:51]
  ds_read_b64_tr_b16 a[226:227], v16 offset:12288
  v_mfma_f32_16x16x32_bf16 a[64:67], a[208:211], v[176:179], a[64:67]
  v_exp_f32 v153, v153
  v_mfma_f32_16x16x32_bf16 a[80:83], a[212:215], v[176:179], a[80:83]
  ds_read_b64_tr_b16 a[228:229], v17 offset:8192
  v_cvt_pk_bf16_f32 v188, v152, v153
  v_mfma_f32_16x16x32_bf16 a[96:99], a[216:219], v[176:179], a[96:99]
  v_exp_f32 v154, v154
  v_mfma_f32_16x16x32_bf16 a[112:115], a[220:223], v[176:179], a[112:115]
  ds_read_b64_tr_b16 a[230:231], v17 offset:12288
  v_mfma_f32_16x16x32_bf16 v[192:195], v[208:211], v[176:179], v[192:195]
  v_exp_f32 v155, v155
  v_mfma_f32_16x16x32_bf16 v[128:131], a[160:163], v[64:67], v[160:163]
  ds_read_b64_tr_b16 a[232:233], v18 offset:8192
  v_cvt_pk_bf16_f32 v189, v154, v155
  v_mfma_f32_16x16x32_bf16 v[128:131], a[164:167], v[68:71], v[128:131]
  v_exp_f32 v156, v156
  v_mfma_f32_16x16x32_bf16 v[128:131], a[168:171], v[72:75], v[128:131]
  ds_read_b64_tr_b16 a[234:235], v18 offset:12288
  v_mfma_f32_16x16x32_bf16 v[128:131], a[172:175], v[76:79], v[128:131]
  v_exp_f32 v157, v157
  v_mfma_f32_16x16x32_bf16 v[132:135], a[176:179], v[64:67], v[160:163]
  ds_read_b64_tr_b16 a[236:237], v19 offset:8192
  v_cvt_pk_bf16_f32 v190, v156, v157
  v_mfma_f32_16x16x32_bf16 v[132:135], a[180:183], v[68:71], v[132:135]
  v_exp_f32 v158, v158
  v_mfma_f32_16x16x32_bf16 v[132:135], a[184:187], v[72:75], v[132:135]
  ds_read_b64_tr_b16 a[238:239], v19 offset:12288
  v_mfma_f32_16x16x32_bf16 v[132:135], a[188:191], v[76:79], v[132:135]
  v_exp_f32 v159, v159
  v_mfma_f32_16x16x32_bf16 a[4:7], a[192:195], v[180:183], a[4:7]
  v_cvt_pk_bf16_f32 v191, v158, v159
  v_mfma_f32_16x16x32_bf16 a[20:23], a[196:199], v[180:183], a[20:23]
  ds_read_b64_tr_b16 a[240:241], v20 offset:8192
  v_mfma_f32_16x16x32_bf16 a[36:39], a[200:203], v[180:183], a[36:39]
  v_exp_f32 v128, v128
  v_mfma_f32_16x16x32_bf16 a[52:55], a[204:207], v[180:183], a[52:55]
  ds_read_b64_tr_b16 a[242:243], v20 offset:12288
  v_mfma_f32_16x16x32_bf16 a[68:71], a[208:211], v[180:183], a[68:71]
  v_exp_f32 v129, v129
  v_mfma_f32_16x16x32_bf16 a[84:87], a[212:215], v[180:183], a[84:87]
  ds_read_b64_tr_b16 a[244:245], v21 offset:8192
  v_cvt_pk_bf16_f32 v176, v128, v129
  v_mfma_f32_16x16x32_bf16 a[100:103], a[216:219], v[180:183], a[100:103]
  v_exp_f32 v130, v130
  v_mfma_f32_16x16x32_bf16 a[116:119], a[220:223], v[180:183], a[116:119]
  ds_read_b64_tr_b16 a[246:247], v21 offset:12288
  v_mfma_f32_16x16x32_bf16 v[196:199], v[208:211], v[180:183], v[196:199]
  v_exp_f32 v131, v131
  v_mfma_f32_16x16x32_bf16 v[136:139], a[160:163], v[80:83], v[164:167]
  ds_read_b64_tr_b16 a[248:249], v22 offset:8192
  v_cvt_pk_bf16_f32 v177, v130, v131
  v_mfma_f32_16x16x32_bf16 v[136:139], a[164:167], v[84:87], v[136:139]
  v_exp_f32 v132, v132
  v_mfma_f32_16x16x32_bf16 v[136:139], a[168:171], v[88:91], v[136:139]
  ds_read_b64_tr_b16 a[250:251], v22 offset:12288
  v_mfma_f32_16x16x32_bf16 v[136:139], a[172:175], v[92:95], v[136:139]
  v_exp_f32 v133, v133
  v_mfma_f32_16x16x32_bf16 v[140:143], a[176:179], v[80:83], v[164:167]
  ds_read_b64_tr_b16 a[252:253], v23 offset:8192
  v_cvt_pk_bf16_f32 v178, v132, v133
  v_mfma_f32_16x16x32_bf16 v[140:143], a[180:183], v[84:87], v[140:143]
  v_exp_f32 v134, v134
  v_mfma_f32_16x16x32_bf16 v[140:143], a[184:187], v[88:91], v[140:143]
  ds_read_b64_tr_b16 a[254:255], v23 offset:12288
  v_mfma_f32_16x16x32_bf16 v[140:143], a[188:191], v[92:95], v[140:143]
  v_exp_f32 v135, v135
  v_mfma_f32_16x16x32_bf16 a[8:11], a[192:195], v[184:187], a[8:11]
  v_cvt_pk_bf16_f32 v179, v134, v135
  v_mfma_f32_16x16x32_bf16 a[24:27], a[196:199], v[184:187], a[24:27]
  v_mfma_f32_16x16x32_bf16 a[40:43], a[200:203], v[184:187], a[40:43]
  v_exp_f32 v136, v136
  v_mfma_f32_16x16x32_bf16 a[56:59], a[204:207], v[184:187], a[56:59]
  v_mfma_f32_16x16x32_bf16 a[72:75], a[208:211], v[184:187], a[72:75]
  v_exp_f32 v137, v137
  v_mfma_f32_16x16x32_bf16 a[88:91], a[212:215], v[184:187], a[88:91]
  v_cvt_pk_bf16_f32 v180, v136, v137
  v_mfma_f32_16x16x32_bf16 a[104:107], a[216:219], v[184:187], a[104:107]
  v_exp_f32 v138, v138
  v_mfma_f32_16x16x32_bf16 a[120:123], a[220:223], v[184:187], a[120:123]
  v_mfma_f32_16x16x32_bf16 v[200:203], v[208:211], v[184:187], v[200:203]
  v_exp_f32 v139, v139
  v_mfma_f32_16x16x32_bf16 v[144:147], a[160:163], v[96:99], v[168:171]
  v_cvt_pk_bf16_f32 v181, v138, v139
  v_mfma_f32_16x16x32_bf16 v[144:147], a[164:167], v[100:103], v[144:147]
  v_exp_f32 v140, v140
  v_mfma_f32_16x16x32_bf16 v[144:147], a[168:171], v[104:107], v[144:147]
  v_mfma_f32_16x16x32_bf16 v[144:147], a[172:175], v[108:111], v[144:147]
  v_exp_f32 v141, v141
  v_mfma_f32_16x16x32_bf16 v[148:151], a[176:179], v[96:99], v[168:171]
  v_cvt_pk_bf16_f32 v182, v140, v141
  v_mfma_f32_16x16x32_bf16 v[148:151], a[180:183], v[100:103], v[148:151]
  v_exp_f32 v142, v142
  v_mfma_f32_16x16x32_bf16 v[148:151], a[184:187], v[104:107], v[148:151]
  v_mfma_f32_16x16x32_bf16 v[148:151], a[188:191], v[108:111], v[148:151]
  v_exp_f32 v143, v143
  v_mfma_f32_16x16x32_bf16 a[12:15], a[192:195], v[188:191], a[12:15]
  v_cvt_pk_bf16_f32 v183, v142, v143
  v_mfma_f32_16x16x32_bf16 a[28:31], a[196:199], v[188:191], a[28:31]
  v_mfma_f32_16x16x32_bf16 a[44:47], a[200:203], v[188:191], a[44:47]
  v_exp_f32 v144, v144
  v_mfma_f32_16x16x32_bf16 a[60:63], a[204:207], v[188:191], a[60:63]
  v_mfma_f32_16x16x32_bf16 a[76:79], a[208:211], v[188:191], a[76:79]
  v_exp_f32 v145, v145
  v_mfma_f32_16x16x32_bf16 a[92:95], a[212:215], v[188:191], a[92:95]
  v_cvt_pk_bf16_f32 v184, v144, v145
  v_mfma_f32_16x16x32_bf16 a[108:111], a[216:219], v[188:191], a[108:111]
  v_exp_f32 v146, v146
  v_mfma_f32_16x16x32_bf16 a[124:127], a[220:223], v[188:191], a[124:127]
  v_mfma_f32_16x16x32_bf16 v[204:207], v[208:211], v[188:191], v[204:207]
  v_exp_f32 v147, v147
  v_mfma_f32_16x16x32_bf16 v[152:155], a[160:163], v[112:115], v[172:175]
  v_cvt_pk_bf16_f32 v185, v146, v147
  v_mfma_f32_16x16x32_bf16 v[152:155], a[164:167], v[116:119], v[152:155]
  v_exp_f32 v148, v148
  v_mfma_f32_16x16x32_bf16 v[152:155], a[168:171], v[120:123], v[152:155]
  v_mfma_f32_16x16x32_bf16 v[152:155], a[172:175], v[124:127], v[152:155]
  v_exp_f32 v149, v149
  v_mfma_f32_16x16x32_bf16 v[156:159], a[176:179], v[112:115], v[172:175]
  v_cvt_pk_bf16_f32 v186, v148, v149
  v_mfma_f32_16x16x32_bf16 v[156:159], a[180:183], v[116:119], v[156:159]
  v_exp_f32 v150, v150
  v_mfma_f32_16x16x32_bf16 v[156:159], a[184:187], v[120:123], v[156:159]
  v_mfma_f32_16x16x32_bf16 v[156:159], a[188:191], v[124:127], v[156:159]
  v_exp_f32 v151, v151
  s_waitcnt lgkmcnt(0)
  v_mfma_f32_16x16x32_bf16 a[0:3], a[224:227], v[176:179], a[0:3]
  v_cvt_pk_bf16_f32 v187, v150, v151
  v_mfma_f32_16x16x32_bf16 a[16:19], a[228:231], v[176:179], a[16:19]
  v_mfma_f32_16x16x32_bf16 a[32:35], a[232:235], v[176:179], a[32:35]
  v_exp_f32 v152, v152
  v_mfma_f32_16x16x32_bf16 a[48:51], a[236:239], v[176:179], a[48:51]
  v_mfma_f32_16x16x32_bf16 a[64:67], a[240:243], v[176:179], a[64:67]
  v_exp_f32 v153, v153
  v_mfma_f32_16x16x32_bf16 a[80:83], a[244:247], v[176:179], a[80:83]
  v_cvt_pk_bf16_f32 v188, v152, v153
  v_mfma_f32_16x16x32_bf16 a[96:99], a[248:251], v[176:179], a[96:99]
  v_exp_f32 v154, v154
  v_mfma_f32_16x16x32_bf16 a[112:115], a[252:255], v[176:179], a[112:115]
  v_mfma_f32_16x16x32_bf16 v[192:195], v[208:211], v[176:179], v[192:195]
  v_exp_f32 v155, v155
  v_mfma_f32_16x16x32_bf16 a[4:7], a[224:227], v[180:183], a[4:7]
  v_cvt_pk_bf16_f32 v189, v154, v155
  v_mfma_f32_16x16x32_bf16 a[20:23], a[228:231], v[180:183], a[20:23]
  v_exp_f32 v156, v156
  v_mfma_f32_16x16x32_bf16 a[36:39], a[232:235], v[180:183], a[36:39]
  s_add_u32 s42, s43, 0
  s_nop 0
  v_rcp_f32 v216, v192
  v_mfma_f32_16x16x32_bf16 a[52:55], a[236:239], v[180:183], a[52:55]
  v_exp_f32 v157, v157
  v_accvgpr_read_b32 v220, a0
  v_accvgpr_read_b32 v221, a1
  v_accvgpr_read_b32 v222, a2
  v_accvgpr_read_b32 v223, a3
  v_accvgpr_read_b32 v224, a16
  v_accvgpr_read_b32 v225, a17
  v_accvgpr_read_b32 v226, a18
  v_accvgpr_read_b32 v227, a19
  v_mul_f32 v220, v220, v216
  v_mul_f32 v221, v221, v216
  v_mul_f32 v222, v222, v216
  v_mul_f32 v223, v223, v216
  v_mul_f32 v224, v224, v216
  v_mul_f32 v225, v225, v216
  v_mul_f32 v226, v226, v216
  v_mul_f32 v227, v227, v216
  v_cvt_pk_bf16_f32 v228, v220, v221
  v_cvt_pk_bf16_f32 v229, v222, v223
  v_cvt_pk_bf16_f32 v230, v224, v225
  v_cvt_pk_bf16_f32 v231, v226, v227
  v_mfma_f32_16x16x32_bf16 a[68:71], a[240:243], v[180:183], a[68:71]
  buffer_store_dwordx4 v[228:231], v32, s[4:7], s42 offen offset:0 sc1
  v_cvt_pk_bf16_f32 v190, v156, v157
  v_mfma_f32_16x16x32_bf16 a[84:87], a[244:247], v[180:183], a[84:87]
  v_exp_f32 v158, v158
  v_accvgpr_read_b32 v232, a32
  v_accvgpr_read_b32 v233, a33
  v_accvgpr_read_b32 v234, a34
  v_accvgpr_read_b32 v235, a35
  v_accvgpr_read_b32 v236, a48
  v_accvgpr_read_b32 v237, a49
  v_accvgpr_read_b32 v238, a50
  v_accvgpr_read_b32 v239, a51
  v_mul_f32 v232, v232, v216
  v_mul_f32 v233, v233, v216
  v_mul_f32 v234, v234, v216
  v_mul_f32 v235, v235, v216
  v_mul_f32 v236, v236, v216
  v_mul_f32 v237, v237, v216
  v_mul_f32 v238, v238, v216
  v_mul_f32 v239, v239, v216
  v_cvt_pk_bf16_f32 v240, v232, v233
  v_cvt_pk_bf16_f32 v241, v234, v235
  v_cvt_pk_bf16_f32 v242, v236, v237
  v_cvt_pk_bf16_f32 v243, v238, v239
  v_mfma_f32_16x16x32_bf16 a[100:103], a[248:251], v[180:183], a[100:103]
  buffer_store_dwordx4 v[240:243], v32, s[4:7], s42 offen offset:1024 sc1
  v_mfma_f32_16x16x32_bf16 a[116:119], a[252:255], v[180:183], a[116:119]
  v_exp_f32 v159, v159
  v_accvgpr_read_b32 v220, a64
  v_accvgpr_read_b32 v221, a65
  v_accvgpr_read_b32 v222, a66
  v_accvgpr_read_b32 v223, a67
  v_accvgpr_read_b32 v224, a80
  v_accvgpr_read_b32 v225, a81
  v_accvgpr_read_b32 v226, a82
  v_accvgpr_read_b32 v227, a83
  v_mul_f32 v220, v220, v216
  v_mul_f32 v221, v221, v216
  v_mul_f32 v222, v222, v216
  v_mul_f32 v223, v223, v216
  v_mul_f32 v224, v224, v216
  v_mul_f32 v225, v225, v216
  v_mul_f32 v226, v226, v216
  v_mul_f32 v227, v227, v216
  v_cvt_pk_bf16_f32 v228, v220, v221
  v_cvt_pk_bf16_f32 v229, v222, v223
  v_cvt_pk_bf16_f32 v230, v224, v225
  v_cvt_pk_bf16_f32 v231, v226, v227
  v_mfma_f32_16x16x32_bf16 v[196:199], v[208:211], v[180:183], v[196:199]
  buffer_store_dwordx4 v[228:231], v32, s[4:7], s42 offen offset:2048 sc1
  v_cvt_pk_bf16_f32 v191, v158, v159
  v_accvgpr_read_b32 v232, a96
  v_accvgpr_read_b32 v233, a97
  v_accvgpr_read_b32 v234, a98
  v_accvgpr_read_b32 v235, a99
  v_accvgpr_read_b32 v236, a112
  v_accvgpr_read_b32 v237, a113
  v_accvgpr_read_b32 v238, a114
  v_accvgpr_read_b32 v239, a115
  v_mul_f32 v232, v232, v216
  v_mul_f32 v233, v233, v216
  v_mul_f32 v234, v234, v216
  v_mul_f32 v235, v235, v216
  v_mul_f32 v236, v236, v216
  v_mul_f32 v237, v237, v216
  v_mul_f32 v238, v238, v216
  v_mul_f32 v239, v239, v216
  v_cvt_pk_bf16_f32 v240, v232, v233
  v_cvt_pk_bf16_f32 v241, v234, v235
  v_cvt_pk_bf16_f32 v242, v236, v237
  v_cvt_pk_bf16_f32 v243, v238, v239
  v_mfma_f32_16x16x32_bf16 a[8:11], a[224:227], v[184:187], a[8:11]
  buffer_store_dwordx4 v[240:243], v32, s[4:7], s42 offen offset:3072 sc1
  v_mfma_f32_16x16x32_bf16 a[24:27], a[228:231], v[184:187], a[24:27]
  v_mfma_f32_16x16x32_bf16 a[40:43], a[232:235], v[184:187], a[40:43]
  s_add_u32 s42, s43, 131072
  v_rcp_f32 v217, v196
  v_mfma_f32_16x16x32_bf16 a[56:59], a[236:239], v[184:187], a[56:59]
  v_accvgpr_read_b32 v220, a4
  v_accvgpr_read_b32 v221, a5
  v_accvgpr_read_b32 v222, a6
  v_accvgpr_read_b32 v223, a7
  v_accvgpr_read_b32 v224, a20
  v_accvgpr_read_b32 v225, a21
  v_accvgpr_read_b32 v226, a22
  v_accvgpr_read_b32 v227, a23
  v_mul_f32 v220, v220, v217
  v_mul_f32 v221, v221, v217
  v_mul_f32 v222, v222, v217
  v_mul_f32 v223, v223, v217
  v_mul_f32 v224, v224, v217
  v_mul_f32 v225, v225, v217
  v_mul_f32 v226, v226, v217
  v_mul_f32 v227, v227, v217
  v_cvt_pk_bf16_f32 v228, v220, v221
  v_cvt_pk_bf16_f32 v229, v222, v223
  v_cvt_pk_bf16_f32 v230, v224, v225
  v_cvt_pk_bf16_f32 v231, v226, v227
  v_mfma_f32_16x16x32_bf16 a[72:75], a[240:243], v[184:187], a[72:75]
  buffer_store_dwordx4 v[228:231], v32, s[4:7], s42 offen offset:0 sc1
  v_mfma_f32_16x16x32_bf16 a[88:91], a[244:247], v[184:187], a[88:91]
  v_accvgpr_read_b32 v232, a36
  v_accvgpr_read_b32 v233, a37
  v_accvgpr_read_b32 v234, a38
  v_accvgpr_read_b32 v235, a39
  v_accvgpr_read_b32 v236, a52
  v_accvgpr_read_b32 v237, a53
  v_accvgpr_read_b32 v238, a54
  v_accvgpr_read_b32 v239, a55
  v_mul_f32 v232, v232, v217
  v_mul_f32 v233, v233, v217
  v_mul_f32 v234, v234, v217
  v_mul_f32 v235, v235, v217
  v_mul_f32 v236, v236, v217
  v_mul_f32 v237, v237, v217
  v_mul_f32 v238, v238, v217
  v_mul_f32 v239, v239, v217
  v_cvt_pk_bf16_f32 v240, v232, v233
  v_cvt_pk_bf16_f32 v241, v234, v235
  v_cvt_pk_bf16_f32 v242, v236, v237
  v_cvt_pk_bf16_f32 v243, v238, v239
  v_mfma_f32_16x16x32_bf16 a[104:107], a[248:251], v[184:187], a[104:107]
  buffer_store_dwordx4 v[240:243], v32, s[4:7], s42 offen offset:1024 sc1
  v_mfma_f32_16x16x32_bf16 a[120:123], a[252:255], v[184:187], a[120:123]
  v_accvgpr_read_b32 v220, a68
  v_accvgpr_read_b32 v221, a69
  v_accvgpr_read_b32 v222, a70
  v_accvgpr_read_b32 v223, a71
  v_accvgpr_read_b32 v224, a84
  v_accvgpr_read_b32 v225, a85
  v_accvgpr_read_b32 v226, a86
  v_accvgpr_read_b32 v227, a87
  v_mul_f32 v220, v220, v217
  v_mul_f32 v221, v221, v217
  v_mul_f32 v222, v222, v217
  v_mul_f32 v223, v223, v217
  v_mul_f32 v224, v224, v217
  v_mul_f32 v225, v225, v217
  v_mul_f32 v226, v226, v217
  v_mul_f32 v227, v227, v217
  v_cvt_pk_bf16_f32 v228, v220, v221
  v_cvt_pk_bf16_f32 v229, v222, v223
  v_cvt_pk_bf16_f32 v230, v224, v225
  v_cvt_pk_bf16_f32 v231, v226, v227
  v_mfma_f32_16x16x32_bf16 v[200:203], v[208:211], v[184:187], v[200:203]
  buffer_store_dwordx4 v[228:231], v32, s[4:7], s42 offen offset:2048 sc1
  v_accvgpr_read_b32 v232, a100
  v_accvgpr_read_b32 v233, a101
  v_accvgpr_read_b32 v234, a102
  v_accvgpr_read_b32 v235, a103
  v_accvgpr_read_b32 v236, a116
  v_accvgpr_read_b32 v237, a117
  v_accvgpr_read_b32 v238, a118
  v_accvgpr_read_b32 v239, a119
  v_mul_f32 v232, v232, v217
  v_mul_f32 v233, v233, v217
  v_mul_f32 v234, v234, v217
  v_mul_f32 v235, v235, v217
  v_mul_f32 v236, v236, v217
  v_mul_f32 v237, v237, v217
  v_mul_f32 v238, v238, v217
  v_mul_f32 v239, v239, v217
  v_cvt_pk_bf16_f32 v240, v232, v233
  v_cvt_pk_bf16_f32 v241, v234, v235
  v_cvt_pk_bf16_f32 v242, v236, v237
  v_cvt_pk_bf16_f32 v243, v238, v239
  v_mfma_f32_16x16x32_bf16 a[12:15], a[224:227], v[188:191], a[12:15]
  buffer_store_dwordx4 v[240:243], v32, s[4:7], s42 offen offset:3072 sc1
  v_mfma_f32_16x16x32_bf16 a[28:31], a[228:231], v[188:191], a[28:31]
  v_mfma_f32_16x16x32_bf16 a[44:47], a[232:235], v[188:191], a[44:47]
  s_add_u32 s42, s43, 262144
  v_rcp_f32 v218, v200
  v_mfma_f32_16x16x32_bf16 a[60:63], a[236:239], v[188:191], a[60:63]
  v_accvgpr_read_b32 v220, a8
  v_accvgpr_read_b32 v221, a9
  v_accvgpr_read_b32 v222, a10
  v_accvgpr_read_b32 v223, a11
  v_accvgpr_read_b32 v224, a24
  v_accvgpr_read_b32 v225, a25
  v_accvgpr_read_b32 v226, a26
  v_accvgpr_read_b32 v227, a27
  v_mul_f32 v220, v220, v218
  v_mul_f32 v221, v221, v218
  v_mul_f32 v222, v222, v218
  v_mul_f32 v223, v223, v218
  v_mul_f32 v224, v224, v218
  v_mul_f32 v225, v225, v218
  v_mul_f32 v226, v226, v218
  v_mul_f32 v227, v227, v218
  v_cvt_pk_bf16_f32 v228, v220, v221
  v_cvt_pk_bf16_f32 v229, v222, v223
  v_cvt_pk_bf16_f32 v230, v224, v225
  v_cvt_pk_bf16_f32 v231, v226, v227
  v_mfma_f32_16x16x32_bf16 a[76:79], a[240:243], v[188:191], a[76:79]
  buffer_store_dwordx4 v[228:231], v32, s[4:7], s42 offen offset:0 sc1
  v_mfma_f32_16x16x32_bf16 a[92:95], a[244:247], v[188:191], a[92:95]
  v_accvgpr_read_b32 v232, a40
  v_accvgpr_read_b32 v233, a41
  v_accvgpr_read_b32 v234, a42
  v_accvgpr_read_b32 v235, a43
  v_accvgpr_read_b32 v236, a56
  v_accvgpr_read_b32 v237, a57
  v_accvgpr_read_b32 v238, a58
  v_accvgpr_read_b32 v239, a59
  v_mul_f32 v232, v232, v218
  v_mul_f32 v233, v233, v218
  v_mul_f32 v234, v234, v218
  v_mul_f32 v235, v235, v218
  v_mul_f32 v236, v236, v218
  v_mul_f32 v237, v237, v218
  v_mul_f32 v238, v238, v218
  v_mul_f32 v239, v239, v218
  v_cvt_pk_bf16_f32 v240, v232, v233
  v_cvt_pk_bf16_f32 v241, v234, v235
  v_cvt_pk_bf16_f32 v242, v236, v237
  v_cvt_pk_bf16_f32 v243, v238, v239
  v_mfma_f32_16x16x32_bf16 a[108:111], a[248:251], v[188:191], a[108:111]
  buffer_store_dwordx4 v[240:243], v32, s[4:7], s42 offen offset:1024 sc1
  v_mfma_f32_16x16x32_bf16 a[124:127], a[252:255], v[188:191], a[124:127]
  v_accvgpr_read_b32 v220, a72
  v_accvgpr_read_b32 v221, a73
  v_accvgpr_read_b32 v222, a74
  v_accvgpr_read_b32 v223, a75
  v_accvgpr_read_b32 v224, a88
  v_accvgpr_read_b32 v225, a89
  v_accvgpr_read_b32 v226, a90
  v_accvgpr_read_b32 v227, a91
  v_mul_f32 v220, v220, v218
  v_mul_f32 v221, v221, v218
  v_mul_f32 v222, v222, v218
  v_mul_f32 v223, v223, v218
  v_mul_f32 v224, v224, v218
  v_mul_f32 v225, v225, v218
  v_mul_f32 v226, v226, v218
  v_mul_f32 v227, v227, v218
  v_cvt_pk_bf16_f32 v228, v220, v221
  v_cvt_pk_bf16_f32 v229, v222, v223
  v_cvt_pk_bf16_f32 v230, v224, v225
  v_cvt_pk_bf16_f32 v231, v226, v227
  v_mfma_f32_16x16x32_bf16 v[204:207], v[208:211], v[188:191], v[204:207]
  buffer_store_dwordx4 v[228:231], v32, s[4:7], s42 offen offset:2048 sc1
  v_accvgpr_read_b32 v232, a104
  v_accvgpr_read_b32 v233, a105
  v_accvgpr_read_b32 v234, a106
  v_accvgpr_read_b32 v235, a107
  v_accvgpr_read_b32 v236, a120
  v_accvgpr_read_b32 v237, a121
  v_accvgpr_read_b32 v238, a122
  v_accvgpr_read_b32 v239, a123
  v_mul_f32 v232, v232, v218
  v_mul_f32 v233, v233, v218
  v_mul_f32 v234, v234, v218
  v_mul_f32 v235, v235, v218
  v_mul_f32 v236, v236, v218
  v_mul_f32 v237, v237, v218
  v_mul_f32 v238, v238, v218
  v_mul_f32 v239, v239, v218
  v_cvt_pk_bf16_f32 v240, v232, v233
  v_cvt_pk_bf16_f32 v241, v234, v235
  v_cvt_pk_bf16_f32 v242, v236, v237
  v_cvt_pk_bf16_f32 v243, v238, v239
  buffer_store_dwordx4 v[240:243], v32, s[4:7], s42 offen offset:3072 sc1
  s_cmp_lg_u32 s44, 0
  s_cbranch_scc1 adaLN_cond__sliding_block_cached__glu_gated_bilinear__prompt_kernel_noguard
  v_add_f32 v41, v192, v196
  v_add_f32 v42, v200, v204
  v_add_f32 v41, v41, v42
  v_mov_b32 v42, 0x67800000
  v_cmp_nle_f32 vcc, v41, v42
  s_nop 2
  s_cmp_lg_u64 vcc, 0
  s_cselect_b32 s40, 1, 0
  v_mov_b32 v43, s40
  s_lshl_b32 s41, s26, 2
  s_add_u32 s41, s41, 65536
  v_mov_b32 v44, s41
  ds_write_b32 v44, v43
  s_waitcnt lgkmcnt(0)
  s_barrier
  v_mov_b32 v44, 65536
  ds_read_b128 v[48:51], v44
  s_waitcnt lgkmcnt(0)
  v_or_b32 v48, v48, v49
  v_or_b32 v50, v50, v51
  v_or_b32 v48, v48, v50
  s_nop 0
  v_readfirstlane_b32 s40, v48
  s_nop 2
  s_cmp_lg_u32 s40, 0
  s_cbranch_scc1 adaLN_cond__sliding_block_cached__glu_gated_bilinear__prompt_kernel_fallback
adaLN_cond__sliding_block_cached__glu_gated_bilinear__prompt_kernel_noguard:
  s_barrier
  v_rcp_f32 v219, v204
  s_add_u32 s42, s43, 393216
  v_accvgpr_read_b32 v220, a12
  v_accvgpr_read_b32 v221, a13
  v_accvgpr_read_b32 v222, a14
  v_accvgpr_read_b32 v223, a15
  v_accvgpr_read_b32 v224, a28
  v_accvgpr_read_b32 v225, a29
  v_accvgpr_read_b32 v226, a30
  v_accvgpr_read_b32 v227, a31
  v_mul_f32 v220, v220, v219
  v_mul_f32 v221, v221, v219
  v_mul_f32 v222, v222, v219
  v_mul_f32 v223, v223, v219
  v_mul_f32 v224, v224, v219
  v_mul_f32 v225, v225, v219
  v_mul_f32 v226, v226, v219
  v_mul_f32 v227, v227, v219
  v_cvt_pk_bf16_f32 v228, v220, v221
  v_cvt_pk_bf16_f32 v229, v222, v223
  v_cvt_pk_bf16_f32 v230, v224, v225
  v_cvt_pk_bf16_f32 v231, v226, v227
  buffer_store_dwordx4 v[228:231], v32, s[4:7], s42 offen offset:0 sc1
  v_accvgpr_read_b32 v232, a44
  v_accvgpr_read_b32 v233, a45
  v_accvgpr_read_b32 v234, a46
  v_accvgpr_read_b32 v235, a47
  v_accvgpr_read_b32 v236, a60
  v_accvgpr_read_b32 v237, a61
  v_accvgpr_read_b32 v238, a62
  v_accvgpr_read_b32 v239, a63
  v_mul_f32 v232, v232, v219
  v_mul_f32 v233, v233, v219
  v_mul_f32 v234, v234, v219
  v_mul_f32 v235, v235, v219
  v_mul_f32 v236, v236, v219
  v_mul_f32 v237, v237, v219
  v_mul_f32 v238, v238, v219
  v_mul_f32 v239, v239, v219
  v_cvt_pk_bf16_f32 v240, v232, v233
  v_cvt_pk_bf16_f32 v241, v234, v235
  v_cvt_pk_bf16_f32 v242, v236, v237
  v_cvt_pk_bf16_f32 v243, v238, v239
  buffer_store_dwordx4 v[240:243], v32, s[4:7], s42 offen offset:1024 sc1
  v_accvgpr_read_b32 v220, a76
  v_accvgpr_read_b32 v221, a77
  v_accvgpr_read_b32 v222, a78
  v_accvgpr_read_b32 v223, a79
  v_accvgpr_read_b32 v224, a92
  v_accvgpr_read_b32 v225, a93
  v_accvgpr_read_b32 v226, a94
  v_accvgpr_read_b32 v227, a95
  v_mul_f32 v220, v220, v219
  v_mul_f32 v221, v221, v219
  v_mul_f32 v222, v222, v219
  v_mul_f32 v223, v223, v219
  v_mul_f32 v224, v224, v219
  v_mul_f32 v225, v225, v219
  v_mul_f32 v226, v226, v219
  v_mul_f32 v227, v227, v219
  v_cvt_pk_bf16_f32 v228, v220, v221
  v_cvt_pk_bf16_f32 v229, v222, v223
  v_cvt_pk_bf16_f32 v230, v224, v225
  v_cvt_pk_bf16_f32 v231, v226, v227
  buffer_store_dwordx4 v[228:231], v32, s[4:7], s42 offen offset:2048 sc1
  v_accvgpr_read_b32 v232, a108
  v_accvgpr_read_b32 v233, a109
  v_accvgpr_read_b32 v234, a110
  v_accvgpr_read_b32 v235, a111
  v_accvgpr_read_b32 v236, a124
  v_accvgpr_read_b32 v237, a125
  v_accvgpr_read_b32 v238, a126
  v_accvgpr_read_b32 v239, a127
  v_mul_f32 v232, v232, v219
  v_mul_f32 v233, v233, v219
  v_mul_f32 v234, v234, v219
  v_mul_f32 v235, v235, v219
  v_mul_f32 v236, v236, v219
  v_mul_f32 v237, v237, v219
  v_mul_f32 v238, v238, v219
  v_mul_f32 v239, v239, v219
  v_cvt_pk_bf16_f32 v240, v232, v233
  v_cvt_pk_bf16_f32 v241, v234, v235
  v_cvt_pk_bf16_f32 v242, v236, v237
  v_cvt_pk_bf16_f32 v243, v238, v239
  buffer_store_dwordx4 v[240:243], v32, s[4:7], s42 offen offset:3072 sc1
  s_lshl_b32 s60, s25, 2
  s_lshr_b32 s40, s24, 3
  s_add_u32 s60, s60, s40
  s_lshl_b32 s60, s60, 7
  s_add_u32 s60, s60, 0x10400
  s_and_b32 s24, s2, 7
  s_lshr_b32 s25, s2, 3
  s_lshr_b32 s17, s24, 1
  s_mov_b32 s16, s3
  s_and_b32 s24, s24, 1
  s_lshl_b32 s24, s24, 3
  s_lshr_b32 s18, s25, 2
  s_and_b32 s19, s25, 3
  s_add_u32 s18, s18, s24
  v_lshrrev_b32 v20, 4, v0
  v_and_b32 v21, 15, v0
  v_lshlrev_b32 v22, 1, v20
  v_xor_b32 v22, v22, v21
  v_lshlrev_b32 v22, 4, v22
  v_lshl_add_u32 v2, v20, 10, v22
  v_xor_b32 v23, 128, v2
  v_add_u32 v3, 3072, v23
  v_add_u32 v4, 6144, v2
  v_add_u32 v5, 9216, v23
  v_add_u32 v6, 16384, v2
  v_add_u32 v7, 19456, v23
  v_add_u32 v8, 22528, v2
  v_add_u32 v9, 25600, v23
  v_lshlrev_b32 v10, 4, v0
  s_lshl_b32 s21, s16, 13
  s_lshl_b32 s24, s17, 20
  s_add_u32 s8, s72, s24
  s_addc_u32 s9, s73, 0
  s_mov_b32 s10, 0x100000
  s_mov_b32 s11, 0x20000
  s_lshl_b32 s31, s16, 15
  s_lshl_b32 s24, s19, 8
  s_add_u32 s31, s31, s24
  s_lshl_b32 s24, s18, 3
  s_lshl_b32 s25, s16, 1
  s_add_u32 s24, s24, s25
  s_lshl_b32 s23, s24, 17
  s_lshl_b32 s25, s17, 15
  s_add_u32 s23, s23, s25
  s_add_u32 s23, s23, 0x400000
  s_add_u32 s12, s90, s23
  s_addc_u32 s13, s91, 0
  s_mov_b32 s14, 0x8000
  s_mov_b32 s15, 0x20000
  s_add_u32 s23, s23, 131072
  s_add_u32 s40, s90, s23
  s_addc_u32 s41, s91, 0
  s_mov_b32 s42, 0x8000
  s_mov_b32 s43, 0x20000
  s_mov_b32 s32, s21
  v_bfe_u32 v20, v0, 2, 2
  v_lshrrev_b32 v21, 4, v0
  v_lshl_add_u32 v23, v21, 2, v20
  v_and_b32 v21, 7, v23
  v_lshlrev_b32 v23, 8, v23
  v_and_b32 v24, 3, v0
  v_lshl_add_u32 v23, v24, 3, v23
  v_xor_b32 v24, 0, v21
  v_lshl_add_u32 v12, v24, 5, v23
  v_xor_b32 v24, 1, v21
  v_lshl_add_u32 v13, v24, 5, v23
  v_xor_b32 v24, 2, v21
  v_lshl_add_u32 v14, v24, 5, v23
  v_xor_b32 v24, 3, v21
  v_lshl_add_u32 v15, v24, 5, v23
  v_xor_b32 v24, 4, v21
  v_lshl_add_u32 v16, v24, 5, v23
  v_xor_b32 v24, 5, v21
  v_lshl_add_u32 v17, v24, 5, v23
  v_xor_b32 v24, 6, v21
  v_lshl_add_u32 v18, v24, 5, v23
  v_xor_b32 v24, 7, v21
  v_lshl_add_u32 v19, v24, 5, v23
  v_mov_b32 v128, 0
  v_mov_b32 v129, 0
  v_mov_b32 v130, 0
  v_mov_b32 v131, 0
  v_mov_b32 v132, 0
  v_mov_b32 v133, 0
  v_mov_b32 v134, 0
  v_mov_b32 v135, 0
  v_mov_b32 v136, 0
  v_mov_b32 v137, 0
  v_mov_b32 v138, 0
  v_mov_b32 v139, 0
  v_mov_b32 v140, 0
  v_mov_b32 v141, 0
  v_mov_b32 v142, 0
  v_mov_b32 v143, 0
  v_mov_b32 v144, 0
  v_mov_b32 v145, 0
  v_mov_b32 v146, 0
  v_mov_b32 v147, 0
  v_mov_b32 v148, 0
  v_mov_b32 v149, 0
  v_mov_b32 v150, 0
  v_mov_b32 v151, 0
  v_mov_b32 v152, 0
  v_mov_b32 v153, 0
  v_mov_b32 v154, 0
  v_mov_b32 v155, 0
  v_mov_b32 v156, 0
  v_mov_b32 v157, 0
  v_mov_b32 v158, 0
  v_mov_b32 v159, 0
  v_mov_b32 v160, 0
  v_mov_b32 v161, 0
  v_mov_b32 v162, 0
  v_mov_b32 v163, 0
  v_mov_b32 v164, 0
  v_mov_b32 v165, 0
  v_mov_b32 v166, 0
  v_mov_b32 v167, 0
  v_mov_b32 v168, 0
  v_mov_b32 v169, 0
  v_mov_b32 v170, 0
  v_mov_b32 v171, 0
  v_mov_b32 v172, 0
  v_mov_b32 v173, 0
  v_mov_b32 v174, 0
  v_mov_b32 v175, 0
  v_mov_b32 v176, 0
  v_mov_b32 v177, 0
  v_mov_b32 v178, 0
  v_mov_b32 v179, 0
  v_mov_b32 v180, 0
  v_mov_b32 v181, 0
  v_mov_b32 v182, 0
  v_mov_b32 v183, 0
  v_mov_b32 v184, 0
  v_mov_b32 v185, 0
  v_mov_b32 v186, 0
  v_mov_b32 v187, 0
  v_mov_b32 v188, 0
  v_mov_b32 v189, 0
  v_mov_b32 v190, 0
  v_mov_b32 v191, 0
  s_lshl_b32 s27, s17, 7
  s_add_u32 s27, s27, s24
  s_lshl_b32 s27, s27, 14
  s_lshl_b32 s25, s19, 12
  s_add_u32 s27, s27, s25
  s_add_u32 s27, s27, 0x1400000
  s_mov_b32 s28, 0
  s_mov_b32 s33, 32768
  s_mov_b32 s36, 32768
  s_lshr_b32 s25, s18, 1
  s_lshl_b32 s25, s25, 2
  s_add_u32 s25, s25, s17
  s_lshl_b32 s63, s25, 7
  s_add_u32 s63, s63, 0x10400
  s_waitcnt vmcnt(0)
  s_barrier
  s_cmp_lg_u32 s3, 0
  s_cbranch_scc1 Lsig19
  s_mov_b64 exec, 1
  v_mov_b32 v255, 1
  buffer_atomic_add v255, off, s[4:7], s60
  s_mov_b64 exec, -1
Lsig19:
  s_mov_b32 s48, s64
  s_mov_b32 s49, s65
  s_mov_b32 s50, 0x200000
  s_mov_b32 s51, 0x20000
  s_lshl_b32 s45, s3, 6
  v_add_u32 v32, s45, v0
  v_lshrrev_b32 v32, 3, v32
  v_and_b32 v33, 3, v32
  v_lshrrev_b32 v34, 2, v32
  v_and_b32 v35, 7, v0
  v_lshlrev_b32 v35, 10, v35
  v_lshl_add_u32 v35, v34, 7, v35
  v_lshl_add_u32 v35, v33, 3, v35
  v_lshlrev_b32 v36, 8, v34
  v_lshl_add_u32 v36, v33, 4, v36
  s_and_b32 s47, s2, 7
  s_lshl_b32 s47, s47, 5
  s_lshr_b32 s46, s2, 3
  s_add_u32 s47, s47, s46
  s_lshl_b32 s46, s47, 13
  buffer_load_dwordx2 v[240:241], v35, s[48:51], s46 offen offset:0
  buffer_load_dwordx2 v[242:243], v35, s[48:51], s46 offen offset:32
  buffer_load_dwordx2 v[244:245], v35, s[48:51], s46 offen offset:64
  buffer_load_dwordx2 v[246:247], v35, s[48:51], s46 offen offset:96
  s_mov_b32 s45, 4096
  buffer_load_dwordx4 v[192:195], v36, s[4:7], s45 offen offset:0 sc1
  buffer_load_dwordx4 v[196:199], v36, s[4:7], s45 offen offset:64 sc1
  buffer_load_dwordx4 v[200:203], v36, s[4:7], s45 offen offset:128 sc1
  buffer_load_dwordx4 v[204:207], v36, s[4:7], s45 offen offset:192 sc1
  s_mov_b32 s45, 6144
  buffer_load_dwordx4 v[208:211], v36, s[4:7], s45 offen offset:0 sc1
  buffer_load_dwordx4 v[212:215], v36, s[4:7], s45 offen offset:64 sc1
  buffer_load_dwordx4 v[216:219], v36, s[4:7], s45 offen offset:128 sc1
  buffer_load_dwordx4 v[220:223], v36, s[4:7], s45 offen offset:192 sc1
  s_mov_b32 s45, 8192
  buffer_load_dwordx4 v[224:227], v36, s[4:7], s45 offen offset:0 sc1
  buffer_load_dwordx4 v[228:231], v36, s[4:7], s45 offen offset:64 sc1
  buffer_load_dwordx4 v[232:235], v36, s[4:7], s45 offen offset:128 sc1
  buffer_load_dwordx4 v[236:239], v36, s[4:7], s45 offen offset:192 sc1
  s_add_u32 m0, s32, 0
  s_nop 0
  buffer_load_dwordx4 v2, s[8:11], s31 offen offset:0 lds
  buffer_load_dwordx4 v3, s[8:11], s31 offen offset:1024 lds
  buffer_load_dwordx4 v4, s[8:11], s31 offen offset:2048 lds
  buffer_load_dwordx4 v5, s[8:11], s31 offen offset:3072 lds
  s_add_u32 m0, s32, 4096
  s_nop 0
  buffer_load_dwordx4 v6, s[8:11], s31 offen offset:0 lds
  buffer_load_dwordx4 v7, s[8:11], s31 offen offset:1024 lds
  buffer_load_dwordx4 v8, s[8:11], s31 offen offset:2048 lds
  buffer_load_dwordx4 v9, s[8:11], s31 offen offset:3072 lds
  s_add_u32 s31, s31, 0x20000
  s_add_u32 s32, s32, 32768
  s_cmp_ge_u32 s32, 163840
  s_cselect_b32 s32, s21, s32
  s_add_u32 m0, s32, 0
  s_nop 0
  buffer_load_dwordx4 v2, s[8:11], s31 offen offset:0 lds
  buffer_load_dwordx4 v3, s[8:11], s31 offen offset:1024 lds
  buffer_load_dwordx4 v4, s[8:11], s31 offen offset:2048 lds
  buffer_load_dwordx4 v5, s[8:11], s31 offen offset:3072 lds
  s_add_u32 m0, s32, 4096
  s_nop 0
  buffer_load_dwordx4 v6, s[8:11], s31 offen offset:0 lds
  buffer_load_dwordx4 v7, s[8:11], s31 offen offset:1024 lds
  buffer_load_dwordx4 v8, s[8:11], s31 offen offset:2048 lds
  buffer_load_dwordx4 v9, s[8:11], s31 offen offset:3072 lds
  s_add_u32 s31, s31, 0x20000
  s_add_u32 s32, s32, 32768
  s_cmp_ge_u32 s32, 163840
  s_cselect_b32 s32, s21, s32
  s_add_u32 m0, s32, 0
  s_nop 0
  buffer_load_dwordx4 v2, s[8:11], s31 offen offset:0 lds
  buffer_load_dwordx4 v3, s[8:11], s31 offen offset:1024 lds
  buffer_load_dwordx4 v4, s[8:11], s31 offen offset:2048 lds
  buffer_load_dwordx4 v5, s[8:11], s31 offen offset:3072 lds
  s_add_u32 m0, s32, 4096
  s_nop 0
  buffer_load_dwordx4 v6, s[8:11], s31 offen offset:0 lds
  buffer_load_dwordx4 v7, s[8:11], s31 offen offset:1024 lds
  buffer_load_dwordx4 v8, s[8:11], s31 offen offset:2048 lds
  buffer_load_dwordx4 v9, s[8:11], s31 offen offset:3072 lds
  s_add_u32 s31, s31, 0x20000
  s_add_u32 s32, s32, 32768
  s_cmp_ge_u32 s32, 163840
  s_cselect_b32 s32, s21, s32
  s_cmp_lg_u32 s3, 0
  s_cbranch_scc1 Lgot21
  s_mov_b32 s61, 100000
Lpoll20:
  buffer_load_dword v255, off, s[4:7], s63 sc1
  s_waitcnt vmcnt(0)
  v_readfirstlane_b32 s62, v255
  s_nop 3
  s_cmp_ge_u32 s62, 8
  s_cbranch_scc1 Lgot21
  s_sub_u32 s61, s61, 1
  s_cmp_lg_u32 s61, 0
  s_cbranch_scc1 Lpoll20
Lgot21:
  s_barrier
  s_mov_b32 s29, 4096
  s_mov_b32 s30, 8192
  s_mov_b32 s34, 12288
  buffer_load_dwordx4 a[0:3], v10, s[12:15], 0 offen offset:0 sc1
  buffer_load_dwordx4 a[4:7], v10, s[40:43], 0 offen offset:0 sc1
  buffer_load_dwordx4 a[8:11], v10, s[12:15], 0 offen offset:1024 sc1
  buffer_load_dwordx4 a[12:15], v10, s[40:43], 0 offen offset:1024 sc1
  buffer_load_dwordx4 a[16:19], v10, s[12:15], 0 offen offset:2048 sc1
  buffer_load_dwordx4 a[20:23], v10, s[40:43], 0 offen offset:2048 sc1
  buffer_load_dwordx4 a[24:27], v10, s[12:15], 0 offen offset:3072 sc1
  buffer_load_dwordx4 a[28:31], v10, s[40:43], 0 offen offset:3072 sc1
  buffer_load_dwordx4 a[32:35], v10, s[12:15], s29 offen offset:0 sc1
  buffer_load_dwordx4 a[36:39], v10, s[40:43], s29 offen offset:0 sc1
  buffer_load_dwordx4 a[40:43], v10, s[12:15], s29 offen offset:1024 sc1
  buffer_load_dwordx4 a[44:47], v10, s[40:43], s29 offen offset:1024 sc1
  buffer_load_dwordx4 a[48:51], v10, s[12:15], s29 offen offset:2048 sc1
  buffer_load_dwordx4 a[52:55], v10, s[40:43], s29 offen offset:2048 sc1
  s_waitcnt vmcnt(30)
  s_barrier
  ds_read_b64_tr_b16 v[32:33], v12 offset:0
  ds_read_b64_tr_b16 v[34:35], v12 offset:4096
  ds_read_b64_tr_b16 v[36:37], v13 offset:0
  ds_read_b64_tr_b16 v[38:39], v13 offset:4096
  ds_read_b64_tr_b16 v[40:41], v14 offset:0
  ds_read_b64_tr_b16 v[42:43], v14 offset:4096
  ds_read_b64_tr_b16 v[44:45], v15 offset:0
  ds_read_b64_tr_b16 v[46:47], v15 offset:4096
  ds_read_b64_tr_b16 v[48:49], v16 offset:0
  ds_read_b64_tr_b16 v[50:51], v16 offset:4096
  ds_read_b64_tr_b16 v[52:53], v17 offset:0
  ds_read_b64_tr_b16 v[54:55], v17 offset:4096
  ds_read_b64_tr_b16 v[56:57], v18 offset:0
  ds_read_b64_tr_b16 v[58:59], v18 offset:4096
  ds_read_b64_tr_b16 v[60:61], v19 offset:0
  ds_read_b64_tr_b16 v[62:63], v19 offset:4096
adaLN_cond__sliding_block_cached__glu_gated_bilinear__prompt_kernel_p3_loop:
  s_waitcnt vmcnt(13) lgkmcnt(10)
  v_mfma_f32_16x16x32_bf16 v[128:131], v[32:35], a[0:3], v[128:131]
  ds_read_b64_tr_b16 v[64:65], v12 offset:8192
  s_waitcnt vmcnt(12)
  v_mfma_f32_16x16x32_bf16 v[132:135], v[32:35], a[4:7], v[132:135]
  ds_read_b64_tr_b16 v[66:67], v12 offset:12288
  s_add_u32 m0, s32, 0
  v_mfma_f32_16x16x32_bf16 v[136:139], v[36:39], a[0:3], v[136:139]
  ds_read_b64_tr_b16 v[68:69], v13 offset:8192
  v_mfma_f32_16x16x32_bf16 v[140:143], v[36:39], a[4:7], v[140:143]
  ds_read_b64_tr_b16 v[70:71], v13 offset:12288
  buffer_load_dwordx4 a[56:59], v10, s[12:15], s29 offen offset:3072 sc1
  v_mfma_f32_16x16x32_bf16 v[144:147], v[40:43], a[0:3], v[144:147]
  ds_read_b64_tr_b16 v[72:73], v14 offset:8192
  v_mfma_f32_16x16x32_bf16 v[148:151], v[40:43], a[4:7], v[148:151]
  ds_read_b64_tr_b16 v[74:75], v14 offset:12288
  s_waitcnt lgkmcnt(5)
  v_mfma_f32_16x16x32_bf16 v[152:155], v[44:47], a[0:3], v[152:155]
  ds_read_b64_tr_b16 v[76:77], v15 offset:8192
  buffer_load_dwordx4 v2, s[8:11], s31 offen offset:0 lds
  v_mfma_f32_16x16x32_bf16 v[156:159], v[44:47], a[4:7], v[156:159]
  ds_read_b64_tr_b16 v[78:79], v15 offset:12288
  v_mfma_f32_16x16x32_bf16 v[160:163], v[48:51], a[0:3], v[160:163]
  ds_read_b64_tr_b16 v[80:81], v16 offset:8192
  v_mfma_f32_16x16x32_bf16 v[164:167], v[48:51], a[4:7], v[164:167]
  ds_read_b64_tr_b16 v[82:83], v16 offset:12288
  buffer_load_dwordx4 a[60:63], v10, s[40:43], s29 offen offset:3072 sc1
  v_mfma_f32_16x16x32_bf16 v[168:171], v[52:55], a[0:3], v[168:171]
  ds_read_b64_tr_b16 v[84:85], v17 offset:8192
  v_mfma_f32_16x16x32_bf16 v[172:175], v[52:55], a[4:7], v[172:175]
  ds_read_b64_tr_b16 v[86:87], v17 offset:12288
  v_mfma_f32_16x16x32_bf16 v[176:179], v[56:59], a[0:3], v[176:179]
  ds_read_b64_tr_b16 v[88:89], v18 offset:8192
  buffer_load_dwordx4 v3, s[8:11], s31 offen offset:1024 lds
  v_mfma_f32_16x16x32_bf16 v[180:183], v[56:59], a[4:7], v[180:183]
  ds_read_b64_tr_b16 v[90:91], v18 offset:12288
  v_mfma_f32_16x16x32_bf16 v[184:187], v[60:63], a[0:3], v[184:187]
  ds_read_b64_tr_b16 v[92:93], v19 offset:8192
  v_mfma_f32_16x16x32_bf16 v[188:191], v[60:63], a[4:7], v[188:191]
  ds_read_b64_tr_b16 v[94:95], v19 offset:12288
  s_waitcnt vmcnt(15) lgkmcnt(5)
  v_mfma_f32_16x16x32_bf16 v[128:131], v[64:67], a[8:11], v[128:131]
  ds_read_b64_tr_b16 v[32:33], v12 offset:16384
  s_waitcnt vmcnt(14)
  v_mfma_f32_16x16x32_bf16 v[132:135], v[64:67], a[12:15], v[132:135]
  ds_read_b64_tr_b16 v[34:35], v12 offset:20480
  v_mfma_f32_16x16x32_bf16 v[136:139], v[68:71], a[8:11], v[136:139]
  ds_read_b64_tr_b16 v[36:37], v13 offset:16384
  v_mfma_f32_16x16x32_bf16 v[140:143], v[68:71], a[12:15], v[140:143]
  ds_read_b64_tr_b16 v[38:39], v13 offset:20480
  buffer_load_dwordx4 a[0:3], v10, s[12:15], s30 offen offset:0 sc1
  v_mfma_f32_16x16x32_bf16 v[144:147], v[72:75], a[8:11], v[144:147]
  ds_read_b64_tr_b16 v[40:41], v14 offset:16384
  s_add_u32 s29, s29, 8192
  v_mfma_f32_16x16x32_bf16 v[148:151], v[72:75], a[12:15], v[148:151]
  ds_read_b64_tr_b16 v[42:43], v14 offset:20480
  v_mfma_f32_16x16x32_bf16 v[152:155], v[76:79], a[8:11], v[152:155]
  ds_read_b64_tr_b16 v[44:45], v15 offset:16384
  buffer_load_dwordx4 v4, s[8:11], s31 offen offset:2048 lds
  v_mfma_f32_16x16x32_bf16 v[156:159], v[76:79], a[12:15], v[156:159]
  ds_read_b64_tr_b16 v[46:47], v15 offset:20480
  v_mfma_f32_16x16x32_bf16 v[160:163], v[80:83], a[8:11], v[160:163]
  ds_read_b64_tr_b16 v[48:49], v16 offset:16384
  v_mfma_f32_16x16x32_bf16 v[164:167], v[80:83], a[12:15], v[164:167]
  ds_read_b64_tr_b16 v[50:51], v16 offset:20480
  buffer_load_dwordx4 a[4:7], v10, s[40:43], s30 offen offset:0 sc1
  s_waitcnt lgkmcnt(5)
  v_mfma_f32_16x16x32_bf16 v[168:171], v[84:87], a[8:11], v[168:171]
  ds_read_b64_tr_b16 v[52:53], v17 offset:16384
  v_mfma_f32_16x16x32_bf16 v[172:175], v[84:87], a[12:15], v[172:175]
  ds_read_b64_tr_b16 v[54:55], v17 offset:20480
  v_mfma_f32_16x16x32_bf16 v[176:179], v[88:91], a[8:11], v[176:179]
  ds_read_b64_tr_b16 v[56:57], v18 offset:16384
  buffer_load_dwordx4 v5, s[8:11], s31 offen offset:3072 lds
  v_mfma_f32_16x16x32_bf16 v[180:183], v[88:91], a[12:15], v[180:183]
  ds_read_b64_tr_b16 v[58:59], v18 offset:20480
  v_mfma_f32_16x16x32_bf16 v[184:187], v[92:95], a[8:11], v[184:187]
  ds_read_b64_tr_b16 v[60:61], v19 offset:16384
  v_mfma_f32_16x16x32_bf16 v[188:191], v[92:95], a[12:15], v[188:191]
  ds_read_b64_tr_b16 v[62:63], v19 offset:20480
  s_waitcnt vmcnt(17)
  v_mfma_f32_16x16x32_bf16 v[128:131], v[32:35], a[16:19], v[128:131]
  ds_read_b64_tr_b16 v[64:65], v12 offset:24576
  s_waitcnt vmcnt(16)
  v_mfma_f32_16x16x32_bf16 v[132:135], v[32:35], a[20:23], v[132:135]
  ds_read_b64_tr_b16 v[66:67], v12 offset:28672
  s_add_u32 m0, s32, 4096
  v_mfma_f32_16x16x32_bf16 v[136:139], v[36:39], a[16:19], v[136:139]
  ds_read_b64_tr_b16 v[68:69], v13 offset:24576
  v_mfma_f32_16x16x32_bf16 v[140:143], v[36:39], a[20:23], v[140:143]
  ds_read_b64_tr_b16 v[70:71], v13 offset:28672
  buffer_load_dwordx4 a[8:11], v10, s[12:15], s30 offen offset:1024 sc1
  s_waitcnt lgkmcnt(5)
  v_mfma_f32_16x16x32_bf16 v[144:147], v[40:43], a[16:19], v[144:147]
  ds_read_b64_tr_b16 v[72:73], v14 offset:24576
  v_mfma_f32_16x16x32_bf16 v[148:151], v[40:43], a[20:23], v[148:151]
  ds_read_b64_tr_b16 v[74:75], v14 offset:28672
  v_mfma_f32_16x16x32_bf16 v[152:155], v[44:47], a[16:19], v[152:155]
  ds_read_b64_tr_b16 v[76:77], v15 offset:24576
  buffer_load_dwordx4 v6, s[8:11], s31 offen offset:0 lds
  v_mfma_f32_16x16x32_bf16 v[156:159], v[44:47], a[20:23], v[156:159]
  ds_read_b64_tr_b16 v[78:79], v15 offset:28672
  v_mfma_f32_16x16x32_bf16 v[160:163], v[48:51], a[16:19], v[160:163]
  ds_read_b64_tr_b16 v[80:81], v16 offset:24576
  v_mfma_f32_16x16x32_bf16 v[164:167], v[48:51], a[20:23], v[164:167]
  ds_read_b64_tr_b16 v[82:83], v16 offset:28672
  buffer_load_dwordx4 a[12:15], v10, s[40:43], s30 offen offset:1024 sc1
  v_mfma_f32_16x16x32_bf16 v[168:171], v[52:55], a[16:19], v[168:171]
  ds_read_b64_tr_b16 v[84:85], v17 offset:24576
  v_mfma_f32_16x16x32_bf16 v[172:175], v[52:55], a[20:23], v[172:175]
  ds_read_b64_tr_b16 v[86:87], v17 offset:28672
  v_mfma_f32_16x16x32_bf16 v[176:179], v[56:59], a[16:19], v[176:179]
  ds_read_b64_tr_b16 v[88:89], v18 offset:24576
  buffer_load_dwordx4 v7, s[8:11], s31 offen offset:1024 lds
  v_mfma_f32_16x16x32_bf16 v[180:183], v[56:59], a[20:23], v[180:183]
  ds_read_b64_tr_b16 v[90:91], v18 offset:28672
  s_waitcnt lgkmcnt(5)
  v_mfma_f32_16x16x32_bf16 v[184:187], v[60:63], a[16:19], v[184:187]
  ds_read_b64_tr_b16 v[92:93], v19 offset:24576
  v_mfma_f32_16x16x32_bf16 v[188:191], v[60:63], a[20:23], v[188:191]
  ds_read_b64_tr_b16 v[94:95], v19 offset:28672
  s_waitcnt vmcnt(19)
  v_mfma_f32_16x16x32_bf16 v[128:131], v[64:67], a[24:27], v[128:131]
  s_barrier
  v_add_u32 v12, s33, v12
  s_waitcnt vmcnt(18)
  v_mfma_f32_16x16x32_bf16 v[132:135], v[64:67], a[28:31], v[132:135]
  v_add_u32 v13, s33, v13
  v_add_u32 v14, s33, v14
  ds_read_b64_tr_b16 v[32:33], v12 offset:0
  ds_read_b64_tr_b16 v[34:35], v12 offset:4096
  v_mfma_f32_16x16x32_bf16 v[136:139], v[68:71], a[24:27], v[136:139]
  v_add_u32 v15, s33, v15
  v_add_u32 v16, s33, v16
  ds_read_b64_tr_b16 v[36:37], v13 offset:0
  v_mfma_f32_16x16x32_bf16 v[140:143], v[68:71], a[28:31], v[140:143]
  v_add_u32 v17, s33, v17
  v_add_u32 v18, s33, v18
  ds_read_b64_tr_b16 v[38:39], v13 offset:4096
  buffer_load_dwordx4 a[16:19], v10, s[12:15], s30 offen offset:2048 sc1
  v_mfma_f32_16x16x32_bf16 v[144:147], v[72:75], a[24:27], v[144:147]
  v_add_u32 v19, s33, v19
  ds_read_b64_tr_b16 v[40:41], v14 offset:0
  v_mfma_f32_16x16x32_bf16 v[148:151], v[72:75], a[28:31], v[148:151]
  ds_read_b64_tr_b16 v[42:43], v14 offset:4096
  v_mfma_f32_16x16x32_bf16 v[152:155], v[76:79], a[24:27], v[152:155]
  ds_read_b64_tr_b16 v[44:45], v15 offset:0
  buffer_load_dwordx4 v8, s[8:11], s31 offen offset:2048 lds
  v_mfma_f32_16x16x32_bf16 v[156:159], v[76:79], a[28:31], v[156:159]
  ds_read_b64_tr_b16 v[46:47], v15 offset:4096
  s_waitcnt lgkmcnt(4)
  v_mfma_f32_16x16x32_bf16 v[160:163], v[80:83], a[24:27], v[160:163]
  ds_read_b64_tr_b16 v[48:49], v16 offset:0
  v_mfma_f32_16x16x32_bf16 v[164:167], v[80:83], a[28:31], v[164:167]
  ds_read_b64_tr_b16 v[50:51], v16 offset:4096
  buffer_load_dwordx4 a[20:23], v10, s[40:43], s30 offen offset:2048 sc1
  v_mfma_f32_16x16x32_bf16 v[168:171], v[84:87], a[24:27], v[168:171]
  ds_read_b64_tr_b16 v[52:53], v17 offset:0
  v_mfma_f32_16x16x32_bf16 v[172:175], v[84:87], a[28:31], v[172:175]
  ds_read_b64_tr_b16 v[54:55], v17 offset:4096
  v_mfma_f32_16x16x32_bf16 v[176:179], v[88:91], a[24:27], v[176:179]
  ds_read_b64_tr_b16 v[56:57], v18 offset:0
  buffer_load_dwordx4 v9, s[8:11], s31 offen offset:3072 lds
  v_mfma_f32_16x16x32_bf16 v[180:183], v[88:91], a[28:31], v[180:183]
  ds_read_b64_tr_b16 v[58:59], v18 offset:4096
  s_add_u32 s31, s31, 0x20000
  v_mfma_f32_16x16x32_bf16 v[184:187], v[92:95], a[24:27], v[184:187]
  ds_read_b64_tr_b16 v[60:61], v19 offset:0
  s_add_u32 s32, s32, 32768
  v_mfma_f32_16x16x32_bf16 v[188:191], v[92:95], a[28:31], v[188:191]
  ds_read_b64_tr_b16 v[62:63], v19 offset:4096
  s_cmp_ge_u32 s32, 163840
  s_cselect_b32 s32, s21, s32
  s_waitcnt vmcnt(21)
  v_mfma_f32_16x16x32_bf16 v[128:131], v[32:35], a[32:35], v[128:131]
  ds_read_b64_tr_b16 v[64:65], v12 offset:8192
  s_waitcnt vmcnt(20)
  v_mfma_f32_16x16x32_bf16 v[132:135], v[32:35], a[36:39], v[132:135]
  ds_read_b64_tr_b16 v[66:67], v12 offset:12288
  s_add_u32 m0, s32, 0
  v_mfma_f32_16x16x32_bf16 v[136:139], v[36:39], a[32:35], v[136:139]
  ds_read_b64_tr_b16 v[68:69], v13 offset:8192
  v_mfma_f32_16x16x32_bf16 v[140:143], v[36:39], a[36:39], v[140:143]
  ds_read_b64_tr_b16 v[70:71], v13 offset:12288
  buffer_load_dwordx4 a[24:27], v10, s[12:15], s30 offen offset:3072 sc1
  s_waitcnt lgkmcnt(4)
  v_mfma_f32_16x16x32_bf16 v[144:147], v[40:43], a[32:35], v[144:147]
  ds_read_b64_tr_b16 v[72:73], v14 offset:8192
  v_mfma_f32_16x16x32_bf16 v[148:151], v[40:43], a[36:39], v[148:151]
  ds_read_b64_tr_b16 v[74:75], v14 offset:12288
  v_mfma_f32_16x16x32_bf16 v[152:155], v[44:47], a[32:35], v[152:155]
  ds_read_b64_tr_b16 v[76:77], v15 offset:8192
  buffer_load_dwordx4 v2, s[8:11], s31 offen offset:0 lds
  s_add_u32 s28, s28, 1
  v_mfma_f32_16x16x32_bf16 v[156:159], v[44:47], a[36:39], v[156:159]
  ds_read_b64_tr_b16 v[78:79], v15 offset:12288
  v_mfma_f32_16x16x32_bf16 v[160:163], v[48:51], a[32:35], v[160:163]
  ds_read_b64_tr_b16 v[80:81], v16 offset:8192
  s_cmp_eq_u32 s28, 2
  s_cselect_b32 s33, 0xfffe0000, s36
  v_mfma_f32_16x16x32_bf16 v[164:167], v[48:51], a[36:39], v[164:167]
  ds_read_b64_tr_b16 v[82:83], v16 offset:12288
  buffer_load_dwordx4 a[28:31], v10, s[40:43], s30 offen offset:3072 sc1
  v_mfma_f32_16x16x32_bf16 v[168:171], v[52:55], a[32:35], v[168:171]
  ds_read_b64_tr_b16 v[84:85], v17 offset:8192
  v_mfma_f32_16x16x32_bf16 v[172:175], v[52:55], a[36:39], v[172:175]
  ds_read_b64_tr_b16 v[86:87], v17 offset:12288
  v_mfma_f32_16x16x32_bf16 v[176:179], v[56:59], a[32:35], v[176:179]
  ds_read_b64_tr_b16 v[88:89], v18 offset:8192
  buffer_load_dwordx4 v3, s[8:11], s31 offen offset:1024 lds
  v_mfma_f32_16x16x32_bf16 v[180:183], v[56:59], a[36:39], v[180:183]
  ds_read_b64_tr_b16 v[90:91], v18 offset:12288
  v_mfma_f32_16x16x32_bf16 v[184:187], v[60:63], a[32:35], v[184:187]
  ds_read_b64_tr_b16 v[92:93], v19 offset:8192
  v_mfma_f32_16x16x32_bf16 v[188:191], v[60:63], a[36:39], v[188:191]
  ds_read_b64_tr_b16 v[94:95], v19 offset:12288
  s_waitcnt vmcnt(23) lgkmcnt(5)
  v_mfma_f32_16x16x32_bf16 v[128:131], v[64:67], a[40:43], v[128:131]
  ds_read_b64_tr_b16 v[32:33], v12 offset:16384
  s_waitcnt vmcnt(22)
  v_mfma_f32_16x16x32_bf16 v[132:135], v[64:67], a[44:47], v[132:135]
  ds_read_b64_tr_b16 v[34:35], v12 offset:20480
  v_mfma_f32_16x16x32_bf16 v[136:139], v[68:71], a[40:43], v[136:139]
  ds_read_b64_tr_b16 v[36:37], v13 offset:16384
  v_mfma_f32_16x16x32_bf16 v[140:143], v[68:71], a[44:47], v[140:143]
  ds_read_b64_tr_b16 v[38:39], v13 offset:20480
  buffer_load_dwordx4 a[32:35], v10, s[12:15], s34 offen offset:0 sc1
  v_mfma_f32_16x16x32_bf16 v[144:147], v[72:75], a[40:43], v[144:147]
  ds_read_b64_tr_b16 v[40:41], v14 offset:16384
  s_add_u32 s30, s30, 8192
  v_mfma_f32_16x16x32_bf16 v[148:151], v[72:75], a[44:47], v[148:151]
  ds_read_b64_tr_b16 v[42:43], v14 offset:20480
  v_mfma_f32_16x16x32_bf16 v[152:155], v[76:79], a[40:43], v[152:155]
  ds_read_b64_tr_b16 v[44:45], v15 offset:16384
  buffer_load_dwordx4 v4, s[8:11], s31 offen offset:2048 lds
  v_mfma_f32_16x16x32_bf16 v[156:159], v[76:79], a[44:47], v[156:159]
  ds_read_b64_tr_b16 v[46:47], v15 offset:20480
  v_mfma_f32_16x16x32_bf16 v[160:163], v[80:83], a[40:43], v[160:163]
  ds_read_b64_tr_b16 v[48:49], v16 offset:16384
  v_mfma_f32_16x16x32_bf16 v[164:167], v[80:83], a[44:47], v[164:167]
  ds_read_b64_tr_b16 v[50:51], v16 offset:20480
  buffer_load_dwordx4 a[36:39], v10, s[40:43], s34 offen offset:0 sc1
  s_waitcnt lgkmcnt(5)
  v_mfma_f32_16x16x32_bf16 v[168:171], v[84:87], a[40:43], v[168:171]
  ds_read_b64_tr_b16 v[52:53], v17 offset:16384
  v_mfma_f32_16x16x32_bf16 v[172:175], v[84:87], a[44:47], v[172:175]
  ds_read_b64_tr_b16 v[54:55], v17 offset:20480
  v_mfma_f32_16x16x32_bf16 v[176:179], v[88:91], a[40:43], v[176:179]
  ds_read_b64_tr_b16 v[56:57], v18 offset:16384
  buffer_load_dwordx4 v5, s[8:11], s31 offen offset:3072 lds
  v_mfma_f32_16x16x32_bf16 v[180:183], v[88:91], a[44:47], v[180:183]
  ds_read_b64_tr_b16 v[58:59], v18 offset:20480
  v_mfma_f32_16x16x32_bf16 v[184:187], v[92:95], a[40:43], v[184:187]
  ds_read_b64_tr_b16 v[60:61], v19 offset:16384
  v_mfma_f32_16x16x32_bf16 v[188:191], v[92:95], a[44:47], v[188:191]
  ds_read_b64_tr_b16 v[62:63], v19 offset:20480
  s_waitcnt vmcnt(25)
  v_mfma_f32_16x16x32_bf16 v[128:131], v[32:35], a[48:51], v[128:131]
  ds_read_b64_tr_b16 v[64:65], v12 offset:24576
  s_waitcnt vmcnt(24)
  v_mfma_f32_16x16x32_bf16 v[132:135], v[32:35], a[52:55], v[132:135]
  ds_read_b64_tr_b16 v[66:67], v12 offset:28672
  s_add_u32 m0, s32, 4096
  v_mfma_f32_16x16x32_bf16 v[136:139], v[36:39], a[48:51], v[136:139]
  ds_read_b64_tr_b16 v[68:69], v13 offset:24576
  v_mfma_f32_16x16x32_bf16 v[140:143], v[36:39], a[52:55], v[140:143]
  ds_read_b64_tr_b16 v[70:71], v13 offset:28672
  buffer_load_dwordx4 a[40:43], v10, s[12:15], s34 offen offset:1024 sc1
  s_waitcnt lgkmcnt(5)
  v_mfma_f32_16x16x32_bf16 v[144:147], v[40:43], a[48:51], v[144:147]
  ds_read_b64_tr_b16 v[72:73], v14 offset:24576
  v_mfma_f32_16x16x32_bf16 v[148:151], v[40:43], a[52:55], v[148:151]
  ds_read_b64_tr_b16 v[74:75], v14 offset:28672
  v_mfma_f32_16x16x32_bf16 v[152:155], v[44:47], a[48:51], v[152:155]
  ds_read_b64_tr_b16 v[76:77], v15 offset:24576
  buffer_load_dwordx4 v6, s[8:11], s31 offen offset:0 lds
  v_mfma_f32_16x16x32_bf16 v[156:159], v[44:47], a[52:55], v[156:159]
  ds_read_b64_tr_b16 v[78:79], v15 offset:28672
  v_mfma_f32_16x16x32_bf16 v[160:163], v[48:51], a[48:51], v[160:163]
  ds_read_b64_tr_b16 v[80:81], v16 offset:24576
  v_mfma_f32_16x16x32_bf16 v[164:167], v[48:51], a[52:55], v[164:167]
  ds_read_b64_tr_b16 v[82:83], v16 offset:28672
  buffer_load_dwordx4 a[44:47], v10, s[40:43], s34 offen offset:1024 sc1
  v_mfma_f32_16x16x32_bf16 v[168:171], v[52:55], a[48:51], v[168:171]
  ds_read_b64_tr_b16 v[84:85], v17 offset:24576
  v_mfma_f32_16x16x32_bf16 v[172:175], v[52:55], a[52:55], v[172:175]
  ds_read_b64_tr_b16 v[86:87], v17 offset:28672
  v_mfma_f32_16x16x32_bf16 v[176:179], v[56:59], a[48:51], v[176:179]
  ds_read_b64_tr_b16 v[88:89], v18 offset:24576
  buffer_load_dwordx4 v7, s[8:11], s31 offen offset:1024 lds
  v_mfma_f32_16x16x32_bf16 v[180:183], v[56:59], a[52:55], v[180:183]
  ds_read_b64_tr_b16 v[90:91], v18 offset:28672
  s_waitcnt lgkmcnt(5)
  v_mfma_f32_16x16x32_bf16 v[184:187], v[60:63], a[48:51], v[184:187]
  ds_read_b64_tr_b16 v[92:93], v19 offset:24576
  v_mfma_f32_16x16x32_bf16 v[188:191], v[60:63], a[52:55], v[188:191]
  ds_read_b64_tr_b16 v[94:95], v19 offset:28672
  s_waitcnt vmcnt(27)
  v_mfma_f32_16x16x32_bf16 v[128:131], v[64:67], a[56:59], v[128:131]
  s_barrier
  v_add_u32 v12, 0x8000, v12
  s_waitcnt vmcnt(25)
  v_mfma_f32_16x16x32_bf16 v[132:135], v[64:67], a[60:63], v[132:135]
  v_add_u32 v13, 0x8000, v13
  v_add_u32 v14, 0x8000, v14
  ds_read_b64_tr_b16 v[32:33], v12 offset:0
  ds_read_b64_tr_b16 v[34:35], v12 offset:4096
  v_mfma_f32_16x16x32_bf16 v[136:139], v[68:71], a[56:59], v[136:139]
  v_add_u32 v15, 0x8000, v15
  v_add_u32 v16, 0x8000, v16
  ds_read_b64_tr_b16 v[36:37], v13 offset:0
  v_mfma_f32_16x16x32_bf16 v[140:143], v[68:71], a[60:63], v[140:143]
  v_add_u32 v17, 0x8000, v17
  v_add_u32 v18, 0x8000, v18
  ds_read_b64_tr_b16 v[38:39], v13 offset:4096
  buffer_load_dwordx4 a[48:51], v10, s[12:15], s34 offen offset:2048 sc1
  v_mfma_f32_16x16x32_bf16 v[144:147], v[72:75], a[56:59], v[144:147]
  v_add_u32 v19, 0x8000, v19
  ds_read_b64_tr_b16 v[40:41], v14 offset:0
  v_mfma_f32_16x16x32_bf16 v[148:151], v[72:75], a[60:63], v[148:151]
  ds_read_b64_tr_b16 v[42:43], v14 offset:4096
  v_mfma_f32_16x16x32_bf16 v[152:155], v[76:79], a[56:59], v[152:155]
  ds_read_b64_tr_b16 v[44:45], v15 offset:0
  buffer_load_dwordx4 v8, s[8:11], s31 offen offset:2048 lds
  v_mfma_f32_16x16x32_bf16 v[156:159], v[76:79], a[60:63], v[156:159]
  ds_read_b64_tr_b16 v[46:47], v15 offset:4096
  s_waitcnt lgkmcnt(4)
  v_mfma_f32_16x16x32_bf16 v[160:163], v[80:83], a[56:59], v[160:163]
  ds_read_b64_tr_b16 v[48:49], v16 offset:0
  v_mfma_f32_16x16x32_bf16 v[164:167], v[80:83], a[60:63], v[164:167]
  ds_read_b64_tr_b16 v[50:51], v16 offset:4096
  buffer_load_dwordx4 a[52:55], v10, s[40:43], s34 offen offset:2048 sc1
  v_mfma_f32_16x16x32_bf16 v[168:171], v[84:87], a[56:59], v[168:171]
  ds_read_b64_tr_b16 v[52:53], v17 offset:0
  v_mfma_f32_16x16x32_bf16 v[172:175], v[84:87], a[60:63], v[172:175]
  ds_read_b64_tr_b16 v[54:55], v17 offset:4096
  v_mfma_f32_16x16x32_bf16 v[176:179], v[88:91], a[56:59], v[176:179]
  ds_read_b64_tr_b16 v[56:57], v18 offset:0
  buffer_load_dwordx4 v9, s[8:11], s31 offen offset:3072 lds
  v_mfma_f32_16x16x32_bf16 v[180:183], v[88:91], a[60:63], v[180:183]
  ds_read_b64_tr_b16 v[58:59], v18 offset:4096
  s_add_u32 s31, s31, 0x20000
  v_mfma_f32_16x16x32_bf16 v[184:187], v[92:95], a[56:59], v[184:187]
  ds_read_b64_tr_b16 v[60:61], v19 offset:0
  s_add_u32 s32, s32, 32768
  s_add_u32 s34, s34, 8192
  v_mfma_f32_16x16x32_bf16 v[188:191], v[92:95], a[60:63], v[188:191]
  ds_read_b64_tr_b16 v[62:63], v19 offset:4096
  s_cmp_ge_u32 s32, 163840
  s_cselect_b32 s32, s21, s32
  s_cmp_lt_u32 s28, 4
  s_cbranch_scc1 adaLN_cond__sliding_block_cached__glu_gated_bilinear__prompt_kernel_p3_loop
  v_lshlrev_b32 v20, 4, v0
  s_add_u32 s24, s27, 0
  v_cvt_pk_bf16_f32 v32, v128, v129
  v_cvt_pk_bf16_f32 v33, v130, v131
  v_cvt_pk_bf16_f32 v34, v136, v137
  v_cvt_pk_bf16_f32 v35, v138, v139
  buffer_store_dwordx4 v[32:35], v20, s[4:7], s24 offen offset:0 sc1
  v_cvt_pk_bf16_f32 v36, v144, v145
  v_cvt_pk_bf16_f32 v37, v146, v147
  v_cvt_pk_bf16_f32 v38, v152, v153
  v_cvt_pk_bf16_f32 v39, v154, v155
  buffer_store_dwordx4 v[36:39], v20, s[4:7], s24 offen offset:1024 sc1
  s_waitcnt lgkmcnt(0)
  v_cvt_pk_bf16_f32 v40, v160, v161
  v_cvt_pk_bf16_f32 v41, v162, v163
  v_cvt_pk_bf16_f32 v42, v168, v169
  v_cvt_pk_bf16_f32 v43, v170, v171
  buffer_store_dwordx4 v[40:43], v20, s[4:7], s24 offen offset:2048 sc1
  v_cvt_pk_bf16_f32 v44, v176, v177
  v_cvt_pk_bf16_f32 v45, v178, v179
  v_cvt_pk_bf16_f32 v46, v184, v185
  v_cvt_pk_bf16_f32 v47, v186, v187
  buffer_store_dwordx4 v[44:47], v20, s[4:7], s24 offen offset:3072 sc1
  s_add_u32 s24, s27, 16384
  v_cvt_pk_bf16_f32 v48, v132, v133
  v_cvt_pk_bf16_f32 v49, v134, v135
  v_cvt_pk_bf16_f32 v50, v140, v141
  v_cvt_pk_bf16_f32 v51, v142, v143
  buffer_store_dwordx4 v[48:51], v20, s[4:7], s24 offen offset:0 sc1
  v_cvt_pk_bf16_f32 v52, v148, v149
  v_cvt_pk_bf16_f32 v53, v150, v151
  v_cvt_pk_bf16_f32 v54, v156, v157
  v_cvt_pk_bf16_f32 v55, v158, v159
  buffer_store_dwordx4 v[52:55], v20, s[4:7], s24 offen offset:1024 sc1
  v_cvt_pk_bf16_f32 v56, v164, v165
  v_cvt_pk_bf16_f32 v57, v166, v167
  v_cvt_pk_bf16_f32 v58, v172, v173
  v_cvt_pk_bf16_f32 v59, v174, v175
  buffer_store_dwordx4 v[56:59], v20, s[4:7], s24 offen offset:2048 sc1
  v_cvt_pk_bf16_f32 v60, v180, v181
  v_cvt_pk_bf16_f32 v61, v182, v183
  v_cvt_pk_bf16_f32 v62, v188, v189
  v_cvt_pk_bf16_f32 v63, v190, v191
  buffer_store_dwordx4 v[60:63], v20, s[4:7], s24 offen offset:3072 sc1
  s_lshl_b32 s60, s18, 7
  s_add_u32 s60, s60, 0x11400
  s_and_b32 s27, s2, 7
  s_lshr_b32 s28, s2, 3
  s_and_b32 s26, s27, 1
  s_lshl_b32 s26, s26, 3
  s_and_b32 s29, s28, 7
  s_add_u32 s26, s26, s29
  s_lshr_b32 s25, s27, 1
  s_mov_b32 s24, s3
  s_lshl_b32 s25, s25, 2
  s_lshr_b32 s28, s28, 3
  s_add_u32 s25, s25, s28
  s_mov_b32 s27, 0x15555556
  s_mov_b32 s28, 2752
  v_add_u32 v20, 0, v0
  v_mul_hi_u32 v21, v20, s27
  v_mul_u32_u24 v22, 12, v21
  v_sub_u32 v22, v20, v22
  v_bfe_u32 v23, v21, 2, 1
  v_lshlrev_b32 v23, 1, v23
  v_xor_b32 v22, v22, v23
  v_lshlrev_b32 v22, 4, v22
  v_mul_lo_u32 v21, v21, s28
  v_add_u32 v248, v21, v22
  v_add_u32 v20, 64, v0
  v_mul_hi_u32 v21, v20, s27
  v_mul_u32_u24 v22, 12, v21
  v_sub_u32 v22, v20, v22
  v_bfe_u32 v23, v21, 2, 1
  v_lshlrev_b32 v23, 1, v23
  v_xor_b32 v22, v22, v23
  v_lshlrev_b32 v22, 4, v22
  v_mul_lo_u32 v21, v21, s28
  v_add_u32 v249, v21, v22
  v_subrev_u32 v249, 1024, v249
  v_add_u32 v20, 128, v0
  v_mul_hi_u32 v21, v20, s27
  v_mul_u32_u24 v22, 12, v21
  v_sub_u32 v22, v20, v22
  v_bfe_u32 v23, v21, 2, 1
  v_lshlrev_b32 v23, 1, v23
  v_xor_b32 v22, v22, v23
  v_lshlrev_b32 v22, 4, v22
  v_mul_lo_u32 v21, v21, s28
  v_add_u32 v250, v21, v22
  v_subrev_u32 v250, 2048, v250
  s_and_b32 s27, s24, 1
  s_mul_i32 s30, s27, 88064
  s_mul_i32 s28, s26, 192
  s_add_u32 s30, s30, s28
  s_mul_i32 s44, s24, 6144
  s_mov_b32 s38, s30
  s_mov_b32 s39, s44
  s_cmp_ge_u32 s24, 2
  s_cselect_b32 s20, s78, s76
  s_cselect_b32 s21, s79, s77
  s_mov_b32 s22, 0x158000
  s_mov_b32 s23, 0x20000
  s_waitcnt vmcnt(0)
  s_barrier
  s_cmp_lg_u32 s3, 0
  s_cbranch_scc1 Lsig22
  s_mov_b64 exec, 1
  v_mov_b32 v255, 1
  buffer_atomic_add v255, off, s[4:7], s60
  s_mov_b64 exec, -1
Lsig22:
  s_lshl_b32 s45, s3, 6
  v_add_u32 v11, s45, v0
  v_and_b32 v1, 7, v0
  v_lshrrev_b32 v2, 3, v11
  v_and_b32 v3, 3, v2
  v_lshrrev_b32 v4, 2, v2
  s_and_b32 s47, s2, 7
  s_lshl_b32 s47, s47, 5
  s_lshr_b32 s48, s2, 3
  s_add_u32 s47, s47, s48
  s_lshr_b32 s16, s47, 1
  s_and_b32 s17, s47, 1
  s_lshl_b32 s17, s17, 3
  v_add_u32 v6, s17, v1
  v_lshlrev_b32 v6, 4, v6
  v_lshlrev_b32 v7, 11, v4
  v_lshlrev_b32 v9, 8, v3
  v_add3_u32 v7, v7, v9, v6
  v_lshlrev_b32 v9, 8, v4
  v_lshlrev_b32 v10, 4, v3
  v_add_u32 v9, v9, v10
  s_lshl_b32 s19, s16, 14
  s_add_u32 s19, s19, 0x1400000
  s_lshr_b32 s50, s47, 4
  s_lshl_b32 s63, s50, 7
  s_add_u32 s63, s63, 0x11400
  s_cmp_eq_u32 s24, 0
  s_cbranch_scc1 Lw023
  s_mov_b32 s52, s76
  s_mov_b32 s53, s77
  s_mov_b32 s54, 0x158000
  s_mov_b32 s55, 0x20000
  s_sub_u32 s56, s24, 1
  s_mul_i32 s57, s56, 24576
  s_mul_i32 s56, s56, 176128
  s_mul_i32 s58, s26, 192
  s_add_u32 s56, s56, s58
  s_add_u32 m0, s57, 0
  s_add_u32 s58, s56, 0
  buffer_load_dwordx4 v248, s[52:55], s58 offen offset:0 lds
  buffer_load_dwordx4 v249, s[52:55], s58 offen offset:1024 lds
  buffer_load_dwordx4 v250, s[52:55], s58 offen offset:2048 lds
  s_add_u32 m0, s57, 3072
  s_add_u32 s58, s56, 44032
  buffer_load_dwordx4 v248, s[52:55], s58 offen offset:0 lds
  buffer_load_dwordx4 v249, s[52:55], s58 offen offset:1024 lds
  buffer_load_dwordx4 v250, s[52:55], s58 offen offset:2048 lds
  s_add_u32 m0, s39, 0
  s_add_u32 s29, s38, 0
  buffer_load_dwordx4 v248, s[20:23], s29 offen offset:0 lds
  buffer_load_dwordx4 v249, s[20:23], s29 offen offset:1024 lds
  buffer_load_dwordx4 v250, s[20:23], s29 offen offset:2048 lds
  s_add_u32 m0, s39, 3072
  s_add_u32 s29, s38, 44032
  buffer_load_dwordx4 v248, s[20:23], s29 offen offset:0 lds
  buffer_load_dwordx4 v249, s[20:23], s29 offen offset:1024 lds
  buffer_load_dwordx4 v250, s[20:23], s29 offen offset:2048 lds
  s_add_u32 s38, s38, 176128
  s_add_u32 s39, s39, 24576
  s_add_u32 m0, s39, 0
  s_add_u32 s29, s38, 0
  buffer_load_dwordx4 v248, s[20:23], s29 offen offset:0 lds
  buffer_load_dwordx4 v249, s[20:23], s29 offen offset:1024 lds
  buffer_load_dwordx4 v250, s[20:23], s29 offen offset:2048 lds
  s_add_u32 m0, s39, 3072
  s_add_u32 s29, s38, 44032
  buffer_load_dwordx4 v248, s[20:23], s29 offen offset:0 lds
  buffer_load_dwordx4 v249, s[20:23], s29 offen offset:1024 lds
  buffer_load_dwordx4 v250, s[20:23], s29 offen offset:2048 lds
  s_add_u32 s38, s38, 176128
  s_add_u32 s39, s39, 24576
  s_add_u32 m0, s39, 0
  s_add_u32 s29, s38, 0
  buffer_load_dwordx4 v248, s[20:23], s29 offen offset:0 lds
  buffer_load_dwordx4 v249, s[20:23], s29 offen offset:1024 lds
  buffer_load_dwordx4 v250, s[20:23], s29 offen offset:2048 lds
  s_add_u32 m0, s39, 3072
  s_add_u32 s29, s38, 44032
  buffer_load_dwordx4 v248, s[20:23], s29 offen offset:0 lds
  buffer_load_dwordx4 v249, s[20:23], s29 offen offset:1024 lds
  buffer_load_dwordx4 v250, s[20:23], s29 offen offset:2048 lds
  s_add_u32 s38, s38, 176128
  s_add_u32 s39, s39, 24576
  s_branch Lw0d24
Lw023:
  s_add_u32 s38, s38, 176128
  s_add_u32 s39, s39, 24576
  s_add_u32 s38, s38, 176128
  s_add_u32 s39, s39, 24576
  s_add_u32 s38, s38, 176128
  s_add_u32 s39, s39, 24576
Lw0d24:
  s_cmp_lg_u32 s3, 0
  s_cbranch_scc1 Lgot26
  s_mov_b32 s61, 100000
Lpoll25:
  buffer_load_dword v255, off, s[4:7], s63 sc1
  s_waitcnt vmcnt(0)
  v_readfirstlane_b32 s62, v255
  s_nop 3
  s_cmp_ge_u32 s62, 16
  s_cbranch_scc1 Lgot26
  s_sub_u32 s61, s61, 1
  s_cmp_lg_u32 s61, 0
  s_cbranch_scc1 Lpoll25
Lgot26:
  s_barrier
  buffer_load_dwordx4 v[64:67], v7, s[4:7], s19 offen offset:0 sc1
  buffer_load_dwordx4 v[68:71], v7, s[4:7], s19 offen offset:1024 sc1
  s_add_u32 s19, s19, 0x200000
  buffer_load_dwordx4 v[72:75], v7, s[4:7], s19 offen offset:0 sc1
  buffer_load_dwordx4 v[76:79], v7, s[4:7], s19 offen offset:1024 sc1
  s_add_u32 s19, s19, 0x200000
  buffer_load_dwordx4 v[80:83], v7, s[4:7], s19 offen offset:0 sc1
  buffer_load_dwordx4 v[84:87], v7, s[4:7], s19 offen offset:1024 sc1
  s_add_u32 s19, s19, 0x200000
  buffer_load_dwordx4 v[88:91], v7, s[4:7], s19 offen offset:0 sc1
  buffer_load_dwordx4 v[92:95], v7, s[4:7], s19 offen offset:1024 sc1
  v_max3_u32 v40, v192, v193, v194
  v_max3_u32 v40, v40, v195, v196
  v_max3_u32 v40, v40, v197, v198
  v_max3_u32 v40, v40, v199, v200
  v_max3_u32 v40, v40, v201, v202
  v_max3_u32 v40, v40, v203, v204
  v_max3_u32 v40, v40, v205, v206
  v_max3_u32 v40, v40, v207, v208
  v_max3_u32 v40, v40, v209, v210
  v_max3_u32 v40, v40, v211, v212
  v_max3_u32 v40, v40, v213, v214
  v_max3_u32 v40, v40, v215, v216
  v_max3_u32 v40, v40, v217, v218
  v_max3_u32 v40, v40, v219, v220
  v_max3_u32 v40, v40, v221, v222
  v_max3_u32 v40, v40, v223, v224
  v_max3_u32 v40, v40, v225, v226
  v_max3_u32 v40, v40, v227, v228
  v_max3_u32 v40, v40, v229, v230
  v_max3_u32 v40, v40, v231, v232
  v_max3_u32 v40, v40, v233, v234
  v_max3_u32 v40, v40, v235, v236
  v_max3_u32 v40, v40, v237, v238
  v_max_u32 v40, v40, v239
  v_cmp_eq_u32 vcc, -1, v40
  s_nop 2
  s_cmp_eq_u64 vcc, 0
  s_cbranch_scc1 Lchk27
  s_mov_b32 s61, 100000
Lmod28:
  s_mov_b32 s45, 4096
  buffer_load_dwordx4 v[192:195], v9, s[4:7], s45 offen offset:0 sc1
  buffer_load_dwordx4 v[196:199], v9, s[4:7], s45 offen offset:64 sc1
  buffer_load_dwordx4 v[200:203], v9, s[4:7], s45 offen offset:128 sc1
  buffer_load_dwordx4 v[204:207], v9, s[4:7], s45 offen offset:192 sc1
  s_mov_b32 s45, 6144
  buffer_load_dwordx4 v[208:211], v9, s[4:7], s45 offen offset:0 sc1
  buffer_load_dwordx4 v[212:215], v9, s[4:7], s45 offen offset:64 sc1
  buffer_load_dwordx4 v[216:219], v9, s[4:7], s45 offen offset:128 sc1
  buffer_load_dwordx4 v[220:223], v9, s[4:7], s45 offen offset:192 sc1
  s_mov_b32 s45, 8192
  buffer_load_dwordx4 v[224:227], v9, s[4:7], s45 offen offset:0 sc1
  buffer_load_dwordx4 v[228:231], v9, s[4:7], s45 offen offset:64 sc1
  buffer_load_dwordx4 v[232:235], v9, s[4:7], s45 offen offset:128 sc1
  buffer_load_dwordx4 v[236:239], v9, s[4:7], s45 offen offset:192 sc1
  s_waitcnt vmcnt(0)
  v_max3_u32 v40, v192, v193, v194
  v_max3_u32 v40, v40, v195, v196
  v_max3_u32 v40, v40, v197, v198
  v_max3_u32 v40, v40, v199, v200
  v_max3_u32 v40, v40, v201, v202
  v_max3_u32 v40, v40, v203, v204
  v_max3_u32 v40, v40, v205, v206
  v_max3_u32 v40, v40, v207, v208
  v_max3_u32 v40, v40, v209, v210
  v_max3_u32 v40, v40, v211, v212
  v_max3_u32 v40, v40, v213, v214
  v_max3_u32 v40, v40, v215, v216
  v_max3_u32 v40, v40, v217, v218
  v_max3_u32 v40, v40, v219, v220
  v_max3_u32 v40, v40, v221, v222
  v_max3_u32 v40, v40, v223, v224
  v_max3_u32 v40, v40, v225, v226
  v_max3_u32 v40, v40, v227, v228
  v_max3_u32 v40, v40, v229, v230
  v_max3_u32 v40, v40, v231, v232
  v_max3_u32 v40, v40, v233, v234
  v_max3_u32 v40, v40, v235, v236
  v_max3_u32 v40, v40, v237, v238
  v_max_u32 v40, v40, v239
  v_cmp_eq_u32 vcc, -1, v40
  s_nop 4
  s_cmp_eq_u64 vcc, 0
  s_cbranch_scc1 Lmodok29
  s_sub_u32 s61, s61, 1
  s_cmp_lg_u32 s61, 0
  s_cbranch_scc1 Lmod28
Lmodok29:
Lchk27:
  s_waitcnt vmcnt(7)
  v_lshlrev_b32 v96, 16, v64
  v_and_b32 v97, s100, v64
  v_lshlrev_b32 v98, 16, v65
  v_and_b32 v99, s100, v65
  v_lshlrev_b32 v100, 16, v66
  v_and_b32 v101, s100, v66
  v_lshlrev_b32 v102, 16, v67
  v_and_b32 v103, s100, v67
  s_waitcnt vmcnt(6)
  v_lshlrev_b32 v104, 16, v68
  v_and_b32 v105, s100, v68
  v_lshlrev_b32 v106, 16, v69
  v_and_b32 v107, s100, v69
  v_lshlrev_b32 v108, 16, v70
  v_and_b32 v109, s100, v70
  v_lshlrev_b32 v110, 16, v71
  v_and_b32 v111, s100, v71
  s_waitcnt vmcnt(5)
  v_lshlrev_b32 v112, 16, v72
  v_and_b32 v113, s100, v72
  v_lshlrev_b32 v114, 16, v73
  v_and_b32 v115, s100, v73
  v_lshlrev_b32 v116, 16, v74
  v_and_b32 v117, s100, v74
  v_lshlrev_b32 v118, 16, v75
  v_and_b32 v119, s100, v75
  s_waitcnt vmcnt(4)
  v_lshlrev_b32 v120, 16, v76
  v_and_b32 v121, s100, v76
  v_lshlrev_b32 v122, 16, v77
  v_and_b32 v123, s100, v77
  v_lshlrev_b32 v124, 16, v78
  v_and_b32 v125, s100, v78
  v_lshlrev_b32 v126, 16, v79
  v_and_b32 v127, s100, v79
  v_add_f32 v96, v96, v112
  v_add_f32 v97, v97, v113
  v_add_f32 v98, v98, v114
  v_add_f32 v99, v99, v115
  v_add_f32 v100, v100, v116
  v_add_f32 v101, v101, v117
  v_add_f32 v102, v102, v118
  v_add_f32 v103, v103, v119
  v_add_f32 v104, v104, v120
  v_add_f32 v105, v105, v121
  v_add_f32 v106, v106, v122
  v_add_f32 v107, v107, v123
  v_add_f32 v108, v108, v124
  v_add_f32 v109, v109, v125
  v_add_f32 v110, v110, v126
  v_add_f32 v111, v111, v127
  s_waitcnt vmcnt(3)
  v_lshlrev_b32 v112, 16, v80
  v_and_b32 v113, s100, v80
  v_lshlrev_b32 v114, 16, v81
  v_and_b32 v115, s100, v81
  v_lshlrev_b32 v116, 16, v82
  v_and_b32 v117, s100, v82
  v_lshlrev_b32 v118, 16, v83
  v_and_b32 v119, s100, v83
  s_waitcnt vmcnt(2)
  v_lshlrev_b32 v120, 16, v84
  v_and_b32 v121, s100, v84
  v_lshlrev_b32 v122, 16, v85
  v_and_b32 v123, s100, v85
  v_lshlrev_b32 v124, 16, v86
  v_and_b32 v125, s100, v86
  v_lshlrev_b32 v126, 16, v87
  v_and_b32 v127, s100, v87
  v_add_f32 v96, v96, v112
  v_add_f32 v97, v97, v113
  v_add_f32 v98, v98, v114
  v_add_f32 v99, v99, v115
  v_add_f32 v100, v100, v116
  v_add_f32 v101, v101, v117
  v_add_f32 v102, v102, v118
  v_add_f32 v103, v103, v119
  v_add_f32 v104, v104, v120
  v_add_f32 v105, v105, v121
  v_add_f32 v106, v106, v122
  v_add_f32 v107, v107, v123
  v_add_f32 v108, v108, v124
  v_add_f32 v109, v109, v125
  v_add_f32 v110, v110, v126
  v_add_f32 v111, v111, v127
  s_waitcnt vmcnt(1)
  v_lshlrev_b32 v112, 16, v88
  v_and_b32 v113, s100, v88
  v_lshlrev_b32 v114, 16, v89
  v_and_b32 v115, s100, v89
  v_lshlrev_b32 v116, 16, v90
  v_and_b32 v117, s100, v90
  v_lshlrev_b32 v118, 16, v91
  v_and_b32 v119, s100, v91
  s_waitcnt vmcnt(0)
  v_lshlrev_b32 v120, 16, v92
  v_and_b32 v121, s100, v92
  v_lshlrev_b32 v122, 16, v93
  v_and_b32 v123, s100, v93
  v_lshlrev_b32 v124, 16, v94
  v_and_b32 v125, s100, v94
  v_lshlrev_b32 v126, 16, v95
  v_and_b32 v127, s100, v95
  v_add_f32 v96, v96, v112
  v_add_f32 v97, v97, v113
  v_add_f32 v98, v98, v114
  v_add_f32 v99, v99, v115
  v_add_f32 v100, v100, v116
  v_add_f32 v101, v101, v117
  v_add_f32 v102, v102, v118
  v_add_f32 v103, v103, v119
  v_add_f32 v104, v104, v120
  v_add_f32 v105, v105, v121
  v_add_f32 v106, v106, v122
  v_add_f32 v107, v107, v123
  v_add_f32 v108, v108, v124
  v_add_f32 v109, v109, v125
  v_add_f32 v110, v110, v126
  v_add_f32 v111, v111, v127
  v_lshlrev_b32 v20, 16, v240
  v_and_b32 v21, s100, v240
  v_lshlrev_b32 v22, 16, v241
  v_and_b32 v23, s100, v241
  v_lshlrev_b32 v24, 16, v242
  v_and_b32 v25, s100, v242
  v_lshlrev_b32 v26, 16, v243
  v_and_b32 v27, s100, v243
  v_lshlrev_b32 v28, 16, v244
  v_and_b32 v29, s100, v244
  v_lshlrev_b32 v30, 16, v245
  v_and_b32 v31, s100, v245
  v_lshlrev_b32 v32, 16, v246
  v_and_b32 v33, s100, v246
  v_lshlrev_b32 v34, 16, v247
  v_and_b32 v35, s100, v247
  v_fmac_f32 v20, v192, v96
  v_fmac_f32 v21, v193, v97
  v_fmac_f32 v22, v194, v98
  v_fmac_f32 v23, v195, v99
  v_fmac_f32 v24, v196, v100
  v_fmac_f32 v25, v197, v101
  v_fmac_f32 v26, v198, v102
  v_fmac_f32 v27, v199, v103
  v_fmac_f32 v28, v200, v104
  v_fmac_f32 v29, v201, v105
  v_fmac_f32 v30, v202, v106
  v_fmac_f32 v31, v203, v107
  v_fmac_f32 v32, v204, v108
  v_fmac_f32 v33, v205, v109
  v_fmac_f32 v34, v206, v110
  v_fmac_f32 v35, v207, v111
  v_cvt_pk_bf16_f32 v12, v20, v21
  v_cvt_pk_bf16_f32 v13, v22, v23
  v_cvt_pk_bf16_f32 v14, v24, v25
  v_cvt_pk_bf16_f32 v15, v26, v27
  v_cvt_pk_bf16_f32 v16, v28, v29
  v_cvt_pk_bf16_f32 v17, v30, v31
  v_cvt_pk_bf16_f32 v18, v32, v33
  v_cvt_pk_bf16_f32 v19, v34, v35
  s_lshl_b32 s18, s16, 14
  s_add_u32 s46, s18, 0x2400000
  buffer_store_dwordx4 v[12:15], v7, s[4:7], s46 offen sc1
  buffer_store_dwordx4 v[16:19], v7, s[4:7], s46 offen offset:1024 sc1
  v_lshlrev_b32 v20, 16, v12
  v_and_b32 v21, s100, v12
  v_lshlrev_b32 v22, 16, v13
  v_and_b32 v23, s100, v13
  v_lshlrev_b32 v24, 16, v14
  v_and_b32 v25, s100, v14
  v_lshlrev_b32 v26, 16, v15
  v_and_b32 v27, s100, v15
  v_lshlrev_b32 v28, 16, v16
  v_and_b32 v29, s100, v16
  v_lshlrev_b32 v30, 16, v17
  v_and_b32 v31, s100, v17
  v_lshlrev_b32 v32, 16, v18
  v_and_b32 v33, s100, v18
  v_lshlrev_b32 v34, 16, v19
  v_and_b32 v35, s100, v19
  v_lshlrev_b32 v47, 4, v1
  v_add_u32 v47, 163328, v47
  s_lshl_b32 s63, s3, 2
  v_add_u32 v46, s63, v47
  v_add_f32 v44, v20, v21
  v_add_f32 v44, v44, v22
  v_add_f32 v44, v44, v23
  v_add_f32 v44, v44, v24
  v_add_f32 v44, v44, v25
  v_add_f32 v44, v44, v26
  v_add_f32 v44, v44, v27
  v_add_f32 v44, v44, v28
  v_add_f32 v44, v44, v29
  v_add_f32 v44, v44, v30
  v_add_f32 v44, v44, v31
  v_add_f32 v44, v44, v32
  v_add_f32 v44, v44, v33
  v_add_f32 v44, v44, v34
  v_add_f32 v44, v44, v35
  s_nop 1
  v_add_f32_dpp v40, v44, v44 row_ror:8 row_mask:0xf bank_mask:0xf
  v_mov_b32 v44, v40
  v_mov_b32 v40, v44
  s_nop 1
  v_permlane16_swap_b32 v44, v40
  v_add_f32 v44, v44, v40
  v_mov_b32 v40, v44
  s_nop 1
  v_permlane32_swap_b32 v44, v40
  v_add_f32 v44, v44, v40
  ds_write_b32 v46, v44 offset:0
  s_waitcnt lgkmcnt(0)
  s_barrier
  ds_read_b128 v[40:43], v47 offset:0
  s_waitcnt lgkmcnt(0)
  v_add_f32 v40, v40, v41
  v_add_f32 v42, v42, v43
  v_add_f32 v44, v40, v42
  v_mul_f32 v44, 0x3b000000, v44
  v_sub_f32 v20, v20, v44
  v_sub_f32 v21, v21, v44
  v_sub_f32 v22, v22, v44
  v_sub_f32 v23, v23, v44
  v_sub_f32 v24, v24, v44
  v_sub_f32 v25, v25, v44
  v_sub_f32 v26, v26, v44
  v_sub_f32 v27, v27, v44
  v_sub_f32 v28, v28, v44
  v_sub_f32 v29, v29, v44
  v_sub_f32 v30, v30, v44
  v_sub_f32 v31, v31, v44
  v_sub_f32 v32, v32, v44
  v_sub_f32 v33, v33, v44
  v_sub_f32 v34, v34, v44
  v_sub_f32 v35, v35, v44
  v_mul_f32 v44, v20, v20
  v_fmac_f32 v44, v21, v21
  v_fmac_f32 v44, v22, v22
  v_fmac_f32 v44, v23, v23
  v_fmac_f32 v44, v24, v24
  v_fmac_f32 v44, v25, v25
  v_fmac_f32 v44, v26, v26
  v_fmac_f32 v44, v27, v27
  v_fmac_f32 v44, v28, v28
  v_fmac_f32 v44, v29, v29
  v_fmac_f32 v44, v30, v30
  v_fmac_f32 v44, v31, v31
  v_fmac_f32 v44, v32, v32
  v_fmac_f32 v44, v33, v33
  v_fmac_f32 v44, v34, v34
  v_fmac_f32 v44, v35, v35
  s_nop 1
  v_add_f32_dpp v40, v44, v44 row_ror:8 row_mask:0xf bank_mask:0xf
  v_mov_b32 v44, v40
  v_mov_b32 v40, v44
  s_nop 1
  v_permlane16_swap_b32 v44, v40
  v_add_f32 v44, v44, v40
  v_mov_b32 v40, v44
  s_nop 1
  v_permlane32_swap_b32 v44, v40
  v_add_f32 v44, v44, v40
  ds_write_b32 v46, v44 offset:128
  s_waitcnt lgkmcnt(0)
  s_barrier
  ds_read_b128 v[40:43], v47 offset:128
  s_waitcnt lgkmcnt(0)
  v_add_f32 v40, v40, v41
  v_add_f32 v42, v42, v43
  v_add_f32 v44, v40, v42
  v_mov_b32 v40, 0x3727c5ac
  v_fmac_f32 v40, 0x3b000000, v44
  v_rsq_f32 v40, v40
  s_nop 0
  v_mul_f32 v20, v20, v40
  v_mul_f32 v21, v21, v40
  v_mul_f32 v22, v22, v40
  v_mul_f32 v23, v23, v40
  v_mul_f32 v24, v24, v40
  v_mul_f32 v25, v25, v40
  v_mul_f32 v26, v26, v40
  v_mul_f32 v27, v27, v40
  v_mul_f32 v28, v28, v40
  v_mul_f32 v29, v29, v40
  v_mul_f32 v30, v30, v40
  v_mul_f32 v31, v31, v40
  v_mul_f32 v32, v32, v40
  v_mul_f32 v33, v33, v40
  v_mul_f32 v34, v34, v40
  v_mul_f32 v35, v35, v40
  v_fmac_f32 v208, v20, v224
  v_fmac_f32 v209, v21, v225
  v_fmac_f32 v210, v22, v226
  v_fmac_f32 v211, v23, v227
  v_fmac_f32 v212, v24, v228
  v_fmac_f32 v213, v25, v229
  v_fmac_f32 v214, v26, v230
  v_fmac_f32 v215, v27, v231
  v_fmac_f32 v216, v28, v232
  v_fmac_f32 v217, v29, v233
  v_fmac_f32 v218, v30, v234
  v_fmac_f32 v219, v31, v235
  v_fmac_f32 v220, v32, v236
  v_fmac_f32 v221, v33, v237
  v_fmac_f32 v222, v34, v238
  v_fmac_f32 v223, v35, v239
  v_cvt_pk_bf16_f32 v52, v208, v209
  v_cvt_pk_bf16_f32 v53, v210, v211
  v_cvt_pk_bf16_f32 v54, v212, v213
  v_cvt_pk_bf16_f32 v55, v214, v215
  v_cvt_pk_bf16_f32 v56, v216, v217
  v_cvt_pk_bf16_f32 v57, v218, v219
  v_cvt_pk_bf16_f32 v58, v220, v221
  v_cvt_pk_bf16_f32 v59, v222, v223
  s_add_u32 s46, s18, 0x2600000
  buffer_store_dwordx4 v[52:55], v7, s[4:7], s46 offen sc1
  buffer_store_dwordx4 v[56:59], v7, s[4:7], s46 offen offset:1024 sc1
  s_lshl_b32 s60, s50, 7
  s_add_u32 s60, s60, 0x11c00
  s_waitcnt vmcnt(0)
  s_barrier
  s_cmp_lg_u32 s3, 0
  s_cbranch_scc1 Lsig30
  s_mov_b64 exec, 1
  v_mov_b32 v255, 1
  buffer_atomic_add v255, off, s[4:7], s60
  s_mov_b64 exec, -1
Lsig30:
  s_cmp_ge_u32 s26, 15
  s_cbranch_scc1 adaLN_cond__sliding_block_cached__glu_gated_bilinear__prompt_kernel_p4_idle
  v_lshlrev_b32 v6, 4, v0
  s_lshl_b32 s27, s25, 3
  s_lshl_b32 s28, s24, 1
  s_add_u32 s27, s27, s28
  s_lshl_b32 s31, s27, 14
  s_add_u32 s31, s31, 0x2600000
  s_add_u32 s8, s90, s31
  s_addc_u32 s9, s91, 0
  s_mov_b32 s10, 0x4000
  s_mov_b32 s11, 0x20000
  s_add_u32 s31, s31, 16384
  s_add_u32 s12, s90, s31
  s_addc_u32 s13, s91, 0
  s_mov_b32 s14, 0x4000
  s_mov_b32 s15, 0x20000
  v_bfe_u32 v20, v0, 2, 2
  v_lshrrev_b32 v21, 4, v0
  v_lshl_add_u32 v22, v21, 2, v20
  v_mul_u32_u24 v22, 192, v22
  v_and_b32 v23, 3, v0
  v_lshl_add_u32 v22, v23, 3, v22
  v_and_b32 v21, 1, v21
  v_xor_b32 v23, 0, v21
  v_lshl_add_u32 v8, v23, 5, v22
  v_xor_b32 v23, 1, v21
  v_lshl_add_u32 v9, v23, 5, v22
  v_xor_b32 v23, 2, v21
  v_lshl_add_u32 v10, v23, 5, v22
  v_xor_b32 v23, 3, v21
  v_lshl_add_u32 v11, v23, 5, v22
  v_xor_b32 v23, 4, v21
  v_lshl_add_u32 v12, v23, 5, v22
  v_xor_b32 v23, 5, v21
  v_lshl_add_u32 v13, v23, 5, v22
  v_mov_b32 v128, 0
  v_mov_b32 v129, 0
  v_mov_b32 v130, 0
  v_mov_b32 v131, 0
  v_mov_b32 v132, 0
  v_mov_b32 v133, 0
  v_mov_b32 v134, 0
  v_mov_b32 v135, 0
  v_mov_b32 v136, 0
  v_mov_b32 v137, 0
  v_mov_b32 v138, 0
  v_mov_b32 v139, 0
  v_mov_b32 v140, 0
  v_mov_b32 v141, 0
  v_mov_b32 v142, 0
  v_mov_b32 v143, 0
  v_mov_b32 v144, 0
  v_mov_b32 v145, 0
  v_mov_b32 v146, 0
  v_mov_b32 v147, 0
  v_mov_b32 v148, 0
  v_mov_b32 v149, 0
  v_mov_b32 v150, 0
  v_mov_b32 v151, 0
  v_mov_b32 v152, 0
  v_mov_b32 v153, 0
  v_mov_b32 v154, 0
  v_mov_b32 v155, 0
  v_mov_b32 v156, 0
  v_mov_b32 v157, 0
  v_mov_b32 v158, 0
  v_mov_b32 v159, 0
  v_mov_b32 v160, 0
  v_mov_b32 v161, 0
  v_mov_b32 v162, 0
  v_mov_b32 v163, 0
  v_mov_b32 v164, 0
  v_mov_b32 v165, 0
  v_mov_b32 v166, 0
  v_mov_b32 v167, 0
  v_mov_b32 v168, 0
  v_mov_b32 v169, 0
  v_mov_b32 v170, 0
  v_mov_b32 v171, 0
  v_mov_b32 v172, 0
  v_mov_b32 v173, 0
  v_mov_b32 v174, 0
  v_mov_b32 v175, 0
  v_mov_b32 v176, 0
  v_mov_b32 v177, 0
  v_mov_b32 v178, 0
  v_mov_b32 v179, 0
  v_mov_b32 v180, 0
  v_mov_b32 v181, 0
  v_mov_b32 v182, 0
  v_mov_b32 v183, 0
  v_mov_b32 v184, 0
  v_mov_b32 v185, 0
  v_mov_b32 v186, 0
  v_mov_b32 v187, 0
  v_mov_b32 v188, 0
  v_mov_b32 v189, 0
  v_mov_b32 v190, 0
  v_mov_b32 v191, 0
  v_mov_b32 v192, 0
  v_mov_b32 v193, 0
  v_mov_b32 v194, 0
  v_mov_b32 v195, 0
  v_mov_b32 v196, 0
  v_mov_b32 v197, 0
  v_mov_b32 v198, 0
  v_mov_b32 v199, 0
  v_mov_b32 v200, 0
  v_mov_b32 v201, 0
  v_mov_b32 v202, 0
  v_mov_b32 v203, 0
  v_mov_b32 v204, 0
  v_mov_b32 v205, 0
  v_mov_b32 v206, 0
  v_mov_b32 v207, 0
  v_mov_b32 v208, 0
  v_mov_b32 v209, 0
  v_mov_b32 v210, 0
  v_mov_b32 v211, 0
  v_mov_b32 v212, 0
  v_mov_b32 v213, 0
  v_mov_b32 v214, 0
  v_mov_b32 v215, 0
  v_mov_b32 v216, 0
  v_mov_b32 v217, 0
  v_mov_b32 v218, 0
  v_mov_b32 v219, 0
  v_mov_b32 v220, 0
  v_mov_b32 v221, 0
  v_mov_b32 v222, 0
  v_mov_b32 v223, 0
  s_mul_i32 s33, s27, 44032
  s_mul_i32 s28, s26, 3072
  s_add_u32 s33, s33, s28
  s_add_u32 s33, s33, 0x2800000
  s_mov_b32 s35, 0
  s_mov_b32 s40, 24576
  s_lshl_b32 s63, s25, 7
  s_add_u32 s63, s63, 0x11c00
  s_cmp_lg_u32 s3, 0
  s_cbranch_scc1 Lgot32
  s_mov_b32 s61, 100000
Lpoll31:
  buffer_load_dword v255, off, s[4:7], s63 sc1
  s_waitcnt vmcnt(0)
  v_readfirstlane_b32 s62, v255
  s_nop 3
  s_cmp_ge_u32 s62, 16
  s_cbranch_scc1 Lgot32
  s_sub_u32 s61, s61, 1
  s_cmp_lg_u32 s61, 0
  s_cbranch_scc1 Lpoll31
Lgot32:
  s_barrier
  s_mov_b32 s36, 4096
  s_mov_b32 s37, 8192
  s_mov_b32 s41, 12288
  buffer_load_dwordx4 a[0:3], v6, s[8:11], 0 offen offset:0 sc1
  buffer_load_dwordx4 a[4:7], v6, s[12:15], 0 offen offset:0 sc1
  buffer_load_dwordx4 a[8:11], v6, s[8:11], 0 offen offset:1024 sc1
  buffer_load_dwordx4 a[12:15], v6, s[12:15], 0 offen offset:1024 sc1
  buffer_load_dwordx4 a[16:19], v6, s[8:11], 0 offen offset:2048 sc1
  buffer_load_dwordx4 a[20:23], v6, s[12:15], 0 offen offset:2048 sc1
  buffer_load_dwordx4 a[24:27], v6, s[8:11], 0 offen offset:3072 sc1
  buffer_load_dwordx4 a[28:31], v6, s[12:15], 0 offen offset:3072 sc1
  buffer_load_dwordx4 a[32:35], v6, s[8:11], s36 offen offset:0 sc1
  buffer_load_dwordx4 a[36:39], v6, s[12:15], s36 offen offset:0 sc1
  buffer_load_dwordx4 a[40:43], v6, s[8:11], s36 offen offset:1024 sc1
  buffer_load_dwordx4 a[44:47], v6, s[12:15], s36 offen offset:1024 sc1
  buffer_load_dwordx4 a[48:51], v6, s[8:11], s36 offen offset:2048 sc1
  buffer_load_dwordx4 a[52:55], v6, s[12:15], s36 offen offset:2048 sc1
  ds_read_b64_tr_b16 v[32:33], v8 offset:0
  ds_read_b64_tr_b16 v[34:35], v8 offset:3072
  ds_read_b64_tr_b16 v[56:57], v8 offset:12288
  ds_read_b64_tr_b16 v[58:59], v8 offset:15360
  ds_read_b64_tr_b16 v[36:37], v9 offset:0
  ds_read_b64_tr_b16 v[38:39], v9 offset:3072
  ds_read_b64_tr_b16 v[60:61], v9 offset:12288
  ds_read_b64_tr_b16 v[62:63], v9 offset:15360
  ds_read_b64_tr_b16 v[40:41], v10 offset:0
  ds_read_b64_tr_b16 v[42:43], v10 offset:3072
  ds_read_b64_tr_b16 v[64:65], v10 offset:12288
  ds_read_b64_tr_b16 v[66:67], v10 offset:15360
  ds_read_b64_tr_b16 v[44:45], v11 offset:0
  ds_read_b64_tr_b16 v[46:47], v11 offset:3072
  ds_read_b64_tr_b16 v[68:69], v11 offset:12288
  ds_read_b64_tr_b16 v[70:71], v11 offset:15360
  ds_read_b64_tr_b16 v[48:49], v12 offset:0
  ds_read_b64_tr_b16 v[50:51], v12 offset:3072
  ds_read_b64_tr_b16 v[72:73], v12 offset:12288
  ds_read_b64_tr_b16 v[74:75], v12 offset:15360
  ds_read_b64_tr_b16 v[52:53], v13 offset:0
  ds_read_b64_tr_b16 v[54:55], v13 offset:3072
  ds_read_b64_tr_b16 v[76:77], v13 offset:12288
  ds_read_b64_tr_b16 v[78:79], v13 offset:15360
adaLN_cond__sliding_block_cached__glu_gated_bilinear__prompt_kernel_p4_loop:
  s_waitcnt vmcnt(13) lgkmcnt(10)
  v_mfma_f32_16x16x32_bf16 v[128:131], v[32:35], a[0:3], v[128:131]
  ds_read_b64_tr_b16 v[80:81], v8 offset:6144
  s_waitcnt vmcnt(12)
  v_mfma_f32_16x16x32_bf16 v[132:135], v[32:35], a[4:7], v[132:135]
  ds_read_b64_tr_b16 v[82:83], v8 offset:9216
  s_add_u32 m0, s39, 0
  v_mfma_f32_16x16x32_bf16 v[176:179], v[56:59], a[0:3], v[176:179]
  ds_read_b64_tr_b16 v[104:105], v8 offset:18432
  s_add_u32 s29, s38, 0
  v_mfma_f32_16x16x32_bf16 v[180:183], v[56:59], a[4:7], v[180:183]
  ds_read_b64_tr_b16 v[106:107], v8 offset:21504
  v_mfma_f32_16x16x32_bf16 v[136:139], v[36:39], a[0:3], v[136:139]
  ds_read_b64_tr_b16 v[84:85], v9 offset:6144
  v_mfma_f32_16x16x32_bf16 v[140:143], v[36:39], a[4:7], v[140:143]
  ds_read_b64_tr_b16 v[86:87], v9 offset:9216
  buffer_load_dwordx4 a[56:59], v6, s[8:11], s36 offen offset:3072 sc1
  v_mfma_f32_16x16x32_bf16 v[184:187], v[60:63], a[0:3], v[184:187]
  ds_read_b64_tr_b16 v[108:109], v9 offset:18432
  v_mfma_f32_16x16x32_bf16 v[188:191], v[60:63], a[4:7], v[188:191]
  ds_read_b64_tr_b16 v[110:111], v9 offset:21504
  v_mfma_f32_16x16x32_bf16 v[144:147], v[40:43], a[0:3], v[144:147]
  ds_read_b64_tr_b16 v[88:89], v10 offset:6144
  buffer_load_dwordx4 v248, s[20:23], s29 offen offset:0 lds
  v_mfma_f32_16x16x32_bf16 v[148:151], v[40:43], a[4:7], v[148:151]
  ds_read_b64_tr_b16 v[90:91], v10 offset:9216
  v_mfma_f32_16x16x32_bf16 v[192:195], v[64:67], a[0:3], v[192:195]
  ds_read_b64_tr_b16 v[112:113], v10 offset:18432
  v_mfma_f32_16x16x32_bf16 v[196:199], v[64:67], a[4:7], v[196:199]
  ds_read_b64_tr_b16 v[114:115], v10 offset:21504
  buffer_load_dwordx4 a[60:63], v6, s[12:15], s36 offen offset:3072 sc1
  v_mfma_f32_16x16x32_bf16 v[152:155], v[44:47], a[0:3], v[152:155]
  ds_read_b64_tr_b16 v[92:93], v11 offset:6144
  v_mfma_f32_16x16x32_bf16 v[156:159], v[44:47], a[4:7], v[156:159]
  ds_read_b64_tr_b16 v[94:95], v11 offset:9216
  s_waitcnt lgkmcnt(5)
  v_mfma_f32_16x16x32_bf16 v[200:203], v[68:71], a[0:3], v[200:203]
  ds_read_b64_tr_b16 v[116:117], v11 offset:18432
  buffer_load_dwordx4 v249, s[20:23], s29 offen offset:1024 lds
  v_mfma_f32_16x16x32_bf16 v[204:207], v[68:71], a[4:7], v[204:207]
  ds_read_b64_tr_b16 v[118:119], v11 offset:21504
  v_mfma_f32_16x16x32_bf16 v[160:163], v[48:51], a[0:3], v[160:163]
  ds_read_b64_tr_b16 v[96:97], v12 offset:6144
  v_mfma_f32_16x16x32_bf16 v[164:167], v[48:51], a[4:7], v[164:167]
  ds_read_b64_tr_b16 v[98:99], v12 offset:9216
  v_mfma_f32_16x16x32_bf16 v[208:211], v[72:75], a[0:3], v[208:211]
  ds_read_b64_tr_b16 v[120:121], v12 offset:18432
  v_mfma_f32_16x16x32_bf16 v[212:215], v[72:75], a[4:7], v[212:215]
  ds_read_b64_tr_b16 v[122:123], v12 offset:21504
  buffer_load_dwordx4 v250, s[20:23], s29 offen offset:2048 lds
  v_mfma_f32_16x16x32_bf16 v[168:171], v[52:55], a[0:3], v[168:171]
  ds_read_b64_tr_b16 v[100:101], v13 offset:6144
  v_mfma_f32_16x16x32_bf16 v[172:175], v[52:55], a[4:7], v[172:175]
  ds_read_b64_tr_b16 v[102:103], v13 offset:9216
  v_mfma_f32_16x16x32_bf16 v[216:219], v[76:79], a[0:3], v[216:219]
  ds_read_b64_tr_b16 v[124:125], v13 offset:18432
  v_mfma_f32_16x16x32_bf16 v[220:223], v[76:79], a[4:7], v[220:223]
  ds_read_b64_tr_b16 v[126:127], v13 offset:21504
  s_waitcnt vmcnt(16)
  v_mfma_f32_16x16x32_bf16 v[128:131], v[80:83], a[8:11], v[128:131]
  s_waitcnt vmcnt(15)
  s_barrier
  v_add_u32 v8, 0x6000, v8
  v_add_u32 v9, 0x6000, v9
  s_waitcnt vmcnt(15)
  v_mfma_f32_16x16x32_bf16 v[132:135], v[80:83], a[12:15], v[132:135]
  v_add_u32 v10, 0x6000, v10
  v_add_u32 v11, 0x6000, v11
  s_add_u32 m0, s39, 3072
  v_mfma_f32_16x16x32_bf16 v[176:179], v[104:107], a[8:11], v[176:179]
  v_add_u32 v12, 0x6000, v12
  v_add_u32 v13, 0x6000, v13
  s_add_u32 s29, s38, 44032
  v_mfma_f32_16x16x32_bf16 v[180:183], v[104:107], a[12:15], v[180:183]
  ds_read_b64_tr_b16 v[32:33], v8 offset:0
  ds_read_b64_tr_b16 v[34:35], v8 offset:3072
  ds_read_b64_tr_b16 v[56:57], v8 offset:12288
  ds_read_b64_tr_b16 v[58:59], v8 offset:15360
  v_mfma_f32_16x16x32_bf16 v[136:139], v[84:87], a[8:11], v[136:139]
  ds_read_b64_tr_b16 v[36:37], v9 offset:0
  v_mfma_f32_16x16x32_bf16 v[140:143], v[84:87], a[12:15], v[140:143]
  ds_read_b64_tr_b16 v[38:39], v9 offset:3072
  buffer_load_dwordx4 a[0:3], v6, s[8:11], s37 offen offset:0 sc1
  v_mfma_f32_16x16x32_bf16 v[184:187], v[108:111], a[8:11], v[184:187]
  ds_read_b64_tr_b16 v[60:61], v9 offset:12288
  s_add_u32 s36, s36, 8192
  v_mfma_f32_16x16x32_bf16 v[188:191], v[108:111], a[12:15], v[188:191]
  ds_read_b64_tr_b16 v[62:63], v9 offset:15360
  s_waitcnt lgkmcnt(5)
  v_mfma_f32_16x16x32_bf16 v[144:147], v[88:91], a[8:11], v[144:147]
  ds_read_b64_tr_b16 v[40:41], v10 offset:0
  buffer_load_dwordx4 v248, s[20:23], s29 offen offset:0 lds
  v_mfma_f32_16x16x32_bf16 v[148:151], v[88:91], a[12:15], v[148:151]
  ds_read_b64_tr_b16 v[42:43], v10 offset:3072
  v_mfma_f32_16x16x32_bf16 v[192:195], v[112:115], a[8:11], v[192:195]
  ds_read_b64_tr_b16 v[64:65], v10 offset:12288
  v_mfma_f32_16x16x32_bf16 v[196:199], v[112:115], a[12:15], v[196:199]
  ds_read_b64_tr_b16 v[66:67], v10 offset:15360
  buffer_load_dwordx4 a[4:7], v6, s[12:15], s37 offen offset:0 sc1
  v_mfma_f32_16x16x32_bf16 v[152:155], v[92:95], a[8:11], v[152:155]
  ds_read_b64_tr_b16 v[44:45], v11 offset:0
  v_mfma_f32_16x16x32_bf16 v[156:159], v[92:95], a[12:15], v[156:159]
  ds_read_b64_tr_b16 v[46:47], v11 offset:3072
  v_mfma_f32_16x16x32_bf16 v[200:203], v[116:119], a[8:11], v[200:203]
  ds_read_b64_tr_b16 v[68:69], v11 offset:12288
  buffer_load_dwordx4 v249, s[20:23], s29 offen offset:1024 lds
  v_mfma_f32_16x16x32_bf16 v[204:207], v[116:119], a[12:15], v[204:207]
  ds_read_b64_tr_b16 v[70:71], v11 offset:15360
  v_mfma_f32_16x16x32_bf16 v[160:163], v[96:99], a[8:11], v[160:163]
  ds_read_b64_tr_b16 v[48:49], v12 offset:0
  v_mfma_f32_16x16x32_bf16 v[164:167], v[96:99], a[12:15], v[164:167]
  ds_read_b64_tr_b16 v[50:51], v12 offset:3072
  v_mfma_f32_16x16x32_bf16 v[208:211], v[120:123], a[8:11], v[208:211]
  ds_read_b64_tr_b16 v[72:73], v12 offset:12288
  v_mfma_f32_16x16x32_bf16 v[212:215], v[120:123], a[12:15], v[212:215]
  ds_read_b64_tr_b16 v[74:75], v12 offset:15360
  buffer_load_dwordx4 v250, s[20:23], s29 offen offset:2048 lds
  v_mfma_f32_16x16x32_bf16 v[168:171], v[100:103], a[8:11], v[168:171]
  ds_read_b64_tr_b16 v[52:53], v13 offset:0
  s_add_u32 s38, s38, 176128
  v_mfma_f32_16x16x32_bf16 v[172:175], v[100:103], a[12:15], v[172:175]
  ds_read_b64_tr_b16 v[54:55], v13 offset:3072
  s_add_u32 s39, s39, 24576
  v_mfma_f32_16x16x32_bf16 v[216:219], v[124:127], a[8:11], v[216:219]
  ds_read_b64_tr_b16 v[76:77], v13 offset:12288
  v_mfma_f32_16x16x32_bf16 v[220:223], v[124:127], a[12:15], v[220:223]
  ds_read_b64_tr_b16 v[78:79], v13 offset:15360
  s_waitcnt vmcnt(19)
  v_mfma_f32_16x16x32_bf16 v[128:131], v[32:35], a[16:19], v[128:131]
  ds_read_b64_tr_b16 v[80:81], v8 offset:6144
  s_waitcnt vmcnt(18)
  v_mfma_f32_16x16x32_bf16 v[132:135], v[32:35], a[20:23], v[132:135]
  ds_read_b64_tr_b16 v[82:83], v8 offset:9216
  s_add_u32 m0, s39, 0
  s_waitcnt lgkmcnt(5)
  v_mfma_f32_16x16x32_bf16 v[176:179], v[56:59], a[16:19], v[176:179]
  ds_read_b64_tr_b16 v[104:105], v8 offset:18432
  s_add_u32 s29, s38, 0
  v_mfma_f32_16x16x32_bf16 v[180:183], v[56:59], a[20:23], v[180:183]
  ds_read_b64_tr_b16 v[106:107], v8 offset:21504
  v_mfma_f32_16x16x32_bf16 v[136:139], v[36:39], a[16:19], v[136:139]
  ds_read_b64_tr_b16 v[84:85], v9 offset:6144
  v_mfma_f32_16x16x32_bf16 v[140:143], v[36:39], a[20:23], v[140:143]
  ds_read_b64_tr_b16 v[86:87], v9 offset:9216
  buffer_load_dwordx4 a[8:11], v6, s[8:11], s37 offen offset:1024 sc1
  v_mfma_f32_16x16x32_bf16 v[184:187], v[60:63], a[16:19], v[184:187]
  ds_read_b64_tr_b16 v[108:109], v9 offset:18432
  v_mfma_f32_16x16x32_bf16 v[188:191], v[60:63], a[20:23], v[188:191]
  ds_read_b64_tr_b16 v[110:111], v9 offset:21504
  v_mfma_f32_16x16x32_bf16 v[144:147], v[40:43], a[16:19], v[144:147]
  ds_read_b64_tr_b16 v[88:89], v10 offset:6144
  buffer_load_dwordx4 v248, s[20:23], s29 offen offset:0 lds
  v_mfma_f32_16x16x32_bf16 v[148:151], v[40:43], a[20:23], v[148:151]
  ds_read_b64_tr_b16 v[90:91], v10 offset:9216
  v_mfma_f32_16x16x32_bf16 v[192:195], v[64:67], a[16:19], v[192:195]
  ds_read_b64_tr_b16 v[112:113], v10 offset:18432
  v_mfma_f32_16x16x32_bf16 v[196:199], v[64:67], a[20:23], v[196:199]
  ds_read_b64_tr_b16 v[114:115], v10 offset:21504
  buffer_load_dwordx4 a[12:15], v6, s[12:15], s37 offen offset:1024 sc1
  v_mfma_f32_16x16x32_bf16 v[152:155], v[44:47], a[16:19], v[152:155]
  ds_read_b64_tr_b16 v[92:93], v11 offset:6144
  v_mfma_f32_16x16x32_bf16 v[156:159], v[44:47], a[20:23], v[156:159]
  ds_read_b64_tr_b16 v[94:95], v11 offset:9216
  v_mfma_f32_16x16x32_bf16 v[200:203], v[68:71], a[16:19], v[200:203]
  ds_read_b64_tr_b16 v[116:117], v11 offset:18432
  buffer_load_dwordx4 v249, s[20:23], s29 offen offset:1024 lds
  v_mfma_f32_16x16x32_bf16 v[204:207], v[68:71], a[20:23], v[204:207]
  ds_read_b64_tr_b16 v[118:119], v11 offset:21504
  v_mfma_f32_16x16x32_bf16 v[160:163], v[48:51], a[16:19], v[160:163]
  ds_read_b64_tr_b16 v[96:97], v12 offset:6144
  v_mfma_f32_16x16x32_bf16 v[164:167], v[48:51], a[20:23], v[164:167]
  ds_read_b64_tr_b16 v[98:99], v12 offset:9216
  v_mfma_f32_16x16x32_bf16 v[208:211], v[72:75], a[16:19], v[208:211]
  ds_read_b64_tr_b16 v[120:121], v12 offset:18432
  v_mfma_f32_16x16x32_bf16 v[212:215], v[72:75], a[20:23], v[212:215]
  ds_read_b64_tr_b16 v[122:123], v12 offset:21504
  buffer_load_dwordx4 v250, s[20:23], s29 offen offset:2048 lds
  s_waitcnt lgkmcnt(5)
  v_mfma_f32_16x16x32_bf16 v[168:171], v[52:55], a[16:19], v[168:171]
  ds_read_b64_tr_b16 v[100:101], v13 offset:6144
  v_mfma_f32_16x16x32_bf16 v[172:175], v[52:55], a[20:23], v[172:175]
  ds_read_b64_tr_b16 v[102:103], v13 offset:9216
  v_mfma_f32_16x16x32_bf16 v[216:219], v[76:79], a[16:19], v[216:219]
  ds_read_b64_tr_b16 v[124:125], v13 offset:18432
  v_mfma_f32_16x16x32_bf16 v[220:223], v[76:79], a[20:23], v[220:223]
  ds_read_b64_tr_b16 v[126:127], v13 offset:21504
  s_waitcnt vmcnt(22)
  v_mfma_f32_16x16x32_bf16 v[128:131], v[80:83], a[24:27], v[128:131]
  s_waitcnt vmcnt(15)
  s_barrier
  v_add_u32 v8, s40, v8
  v_add_u32 v9, s40, v9
  s_waitcnt vmcnt(21)
  v_mfma_f32_16x16x32_bf16 v[132:135], v[80:83], a[28:31], v[132:135]
  v_add_u32 v10, s40, v10
  v_add_u32 v11, s40, v11
  s_add_u32 m0, s39, 3072
  v_mfma_f32_16x16x32_bf16 v[176:179], v[104:107], a[24:27], v[176:179]
  v_add_u32 v12, s40, v12
  v_add_u32 v13, s40, v13
  s_add_u32 s29, s38, 44032
  v_mfma_f32_16x16x32_bf16 v[180:183], v[104:107], a[28:31], v[180:183]
  ds_read_b64_tr_b16 v[32:33], v8 offset:0
  ds_read_b64_tr_b16 v[34:35], v8 offset:3072
  ds_read_b64_tr_b16 v[56:57], v8 offset:12288
  ds_read_b64_tr_b16 v[58:59], v8 offset:15360
  v_mfma_f32_16x16x32_bf16 v[136:139], v[84:87], a[24:27], v[136:139]
  ds_read_b64_tr_b16 v[36:37], v9 offset:0
  v_mfma_f32_16x16x32_bf16 v[140:143], v[84:87], a[28:31], v[140:143]
  ds_read_b64_tr_b16 v[38:39], v9 offset:3072
  buffer_load_dwordx4 a[16:19], v6, s[8:11], s37 offen offset:2048 sc1
  v_mfma_f32_16x16x32_bf16 v[184:187], v[108:111], a[24:27], v[184:187]
  ds_read_b64_tr_b16 v[60:61], v9 offset:12288
  v_mfma_f32_16x16x32_bf16 v[188:191], v[108:111], a[28:31], v[188:191]
  ds_read_b64_tr_b16 v[62:63], v9 offset:15360
  v_mfma_f32_16x16x32_bf16 v[144:147], v[88:91], a[24:27], v[144:147]
  ds_read_b64_tr_b16 v[40:41], v10 offset:0
  buffer_load_dwordx4 v248, s[20:23], s29 offen offset:0 lds
  v_mfma_f32_16x16x32_bf16 v[148:151], v[88:91], a[28:31], v[148:151]
  ds_read_b64_tr_b16 v[42:43], v10 offset:3072
  v_mfma_f32_16x16x32_bf16 v[192:195], v[112:115], a[24:27], v[192:195]
  ds_read_b64_tr_b16 v[64:65], v10 offset:12288
  v_mfma_f32_16x16x32_bf16 v[196:199], v[112:115], a[28:31], v[196:199]
  ds_read_b64_tr_b16 v[66:67], v10 offset:15360
  buffer_load_dwordx4 a[20:23], v6, s[12:15], s37 offen offset:2048 sc1
  v_mfma_f32_16x16x32_bf16 v[152:155], v[92:95], a[24:27], v[152:155]
  ds_read_b64_tr_b16 v[44:45], v11 offset:0
  v_mfma_f32_16x16x32_bf16 v[156:159], v[92:95], a[28:31], v[156:159]
  ds_read_b64_tr_b16 v[46:47], v11 offset:3072
  s_waitcnt lgkmcnt(5)
  v_mfma_f32_16x16x32_bf16 v[200:203], v[116:119], a[24:27], v[200:203]
  ds_read_b64_tr_b16 v[68:69], v11 offset:12288
  buffer_load_dwordx4 v249, s[20:23], s29 offen offset:1024 lds
  v_mfma_f32_16x16x32_bf16 v[204:207], v[116:119], a[28:31], v[204:207]
  ds_read_b64_tr_b16 v[70:71], v11 offset:15360
  v_mfma_f32_16x16x32_bf16 v[160:163], v[96:99], a[24:27], v[160:163]
  ds_read_b64_tr_b16 v[48:49], v12 offset:0
  v_mfma_f32_16x16x32_bf16 v[164:167], v[96:99], a[28:31], v[164:167]
  ds_read_b64_tr_b16 v[50:51], v12 offset:3072
  v_mfma_f32_16x16x32_bf16 v[208:211], v[120:123], a[24:27], v[208:211]
  ds_read_b64_tr_b16 v[72:73], v12 offset:12288
  v_mfma_f32_16x16x32_bf16 v[212:215], v[120:123], a[28:31], v[212:215]
  ds_read_b64_tr_b16 v[74:75], v12 offset:15360
  buffer_load_dwordx4 v250, s[20:23], s29 offen offset:2048 lds
  v_mfma_f32_16x16x32_bf16 v[168:171], v[100:103], a[24:27], v[168:171]
  ds_read_b64_tr_b16 v[52:53], v13 offset:0
  s_add_u32 s38, s38, 176128
  v_mfma_f32_16x16x32_bf16 v[172:175], v[100:103], a[28:31], v[172:175]
  ds_read_b64_tr_b16 v[54:55], v13 offset:3072
  s_add_u32 s39, s39, 24576
  v_mfma_f32_16x16x32_bf16 v[216:219], v[124:127], a[24:27], v[216:219]
  ds_read_b64_tr_b16 v[76:77], v13 offset:12288
  v_mfma_f32_16x16x32_bf16 v[220:223], v[124:127], a[28:31], v[220:223]
  ds_read_b64_tr_b16 v[78:79], v13 offset:15360
  s_waitcnt vmcnt(25)
  v_mfma_f32_16x16x32_bf16 v[128:131], v[32:35], a[32:35], v[128:131]
  ds_read_b64_tr_b16 v[80:81], v8 offset:6144
  s_waitcnt vmcnt(24)
  v_mfma_f32_16x16x32_bf16 v[132:135], v[32:35], a[36:39], v[132:135]
  ds_read_b64_tr_b16 v[82:83], v8 offset:9216
  s_add_u32 m0, s39, 0
  v_mfma_f32_16x16x32_bf16 v[176:179], v[56:59], a[32:35], v[176:179]
  ds_read_b64_tr_b16 v[104:105], v8 offset:18432
  s_add_u32 s29, s38, 0
  v_mfma_f32_16x16x32_bf16 v[180:183], v[56:59], a[36:39], v[180:183]
  ds_read_b64_tr_b16 v[106:107], v8 offset:21504
  v_mfma_f32_16x16x32_bf16 v[136:139], v[36:39], a[32:35], v[136:139]
  ds_read_b64_tr_b16 v[84:85], v9 offset:6144
  s_add_u32 s35, s35, 1
  v_mfma_f32_16x16x32_bf16 v[140:143], v[36:39], a[36:39], v[140:143]
  ds_read_b64_tr_b16 v[86:87], v9 offset:9216
  buffer_load_dwordx4 a[24:27], v6, s[8:11], s37 offen offset:3072 sc1
  v_mfma_f32_16x16x32_bf16 v[184:187], v[60:63], a[32:35], v[184:187]
  ds_read_b64_tr_b16 v[108:109], v9 offset:18432
  s_mov_b32 s40, 0xfffe2000
  v_mfma_f32_16x16x32_bf16 v[188:191], v[60:63], a[36:39], v[188:191]
  ds_read_b64_tr_b16 v[110:111], v9 offset:21504
  s_waitcnt lgkmcnt(4)
  v_mfma_f32_16x16x32_bf16 v[144:147], v[40:43], a[32:35], v[144:147]
  ds_read_b64_tr_b16 v[88:89], v10 offset:6144
  buffer_load_dwordx4 v248, s[20:23], s29 offen offset:0 lds
  v_mfma_f32_16x16x32_bf16 v[148:151], v[40:43], a[36:39], v[148:151]
  ds_read_b64_tr_b16 v[90:91], v10 offset:9216
  v_mfma_f32_16x16x32_bf16 v[192:195], v[64:67], a[32:35], v[192:195]
  ds_read_b64_tr_b16 v[112:113], v10 offset:18432
  v_mfma_f32_16x16x32_bf16 v[196:199], v[64:67], a[36:39], v[196:199]
  ds_read_b64_tr_b16 v[114:115], v10 offset:21504
  buffer_load_dwordx4 a[28:31], v6, s[12:15], s37 offen offset:3072 sc1
  v_mfma_f32_16x16x32_bf16 v[152:155], v[44:47], a[32:35], v[152:155]
  ds_read_b64_tr_b16 v[92:93], v11 offset:6144
  v_mfma_f32_16x16x32_bf16 v[156:159], v[44:47], a[36:39], v[156:159]
  ds_read_b64_tr_b16 v[94:95], v11 offset:9216
  v_mfma_f32_16x16x32_bf16 v[200:203], v[68:71], a[32:35], v[200:203]
  ds_read_b64_tr_b16 v[116:117], v11 offset:18432
  buffer_load_dwordx4 v249, s[20:23], s29 offen offset:1024 lds
  v_mfma_f32_16x16x32_bf16 v[204:207], v[68:71], a[36:39], v[204:207]
  ds_read_b64_tr_b16 v[118:119], v11 offset:21504
  v_mfma_f32_16x16x32_bf16 v[160:163], v[48:51], a[32:35], v[160:163]
  ds_read_b64_tr_b16 v[96:97], v12 offset:6144
  v_mfma_f32_16x16x32_bf16 v[164:167], v[48:51], a[36:39], v[164:167]
  ds_read_b64_tr_b16 v[98:99], v12 offset:9216
  v_mfma_f32_16x16x32_bf16 v[208:211], v[72:75], a[32:35], v[208:211]
  ds_read_b64_tr_b16 v[120:121], v12 offset:18432
  v_mfma_f32_16x16x32_bf16 v[212:215], v[72:75], a[36:39], v[212:215]
  ds_read_b64_tr_b16 v[122:123], v12 offset:21504
  buffer_load_dwordx4 v250, s[20:23], s29 offen offset:2048 lds
  v_mfma_f32_16x16x32_bf16 v[168:171], v[52:55], a[32:35], v[168:171]
  ds_read_b64_tr_b16 v[100:101], v13 offset:6144
  v_mfma_f32_16x16x32_bf16 v[172:175], v[52:55], a[36:39], v[172:175]
  ds_read_b64_tr_b16 v[102:103], v13 offset:9216
  v_mfma_f32_16x16x32_bf16 v[216:219], v[76:79], a[32:35], v[216:219]
  ds_read_b64_tr_b16 v[124:125], v13 offset:18432
  v_mfma_f32_16x16x32_bf16 v[220:223], v[76:79], a[36:39], v[220:223]
  ds_read_b64_tr_b16 v[126:127], v13 offset:21504
  s_waitcnt vmcnt(28)
  v_mfma_f32_16x16x32_bf16 v[128:131], v[80:83], a[40:43], v[128:131]
  s_waitcnt vmcnt(15)
  s_barrier
  v_add_u32 v8, 0x6000, v8
  v_add_u32 v9, 0x6000, v9
  v_mfma_f32_16x16x32_bf16 v[132:135], v[80:83], a[44:47], v[132:135]
  v_add_u32 v10, 0x6000, v10
  v_add_u32 v11, 0x6000, v11
  s_add_u32 m0, s39, 3072
  v_mfma_f32_16x16x32_bf16 v[176:179], v[104:107], a[40:43], v[176:179]
  v_add_u32 v12, 0x6000, v12
  v_add_u32 v13, 0x6000, v13
  s_add_u32 s29, s38, 44032
  v_mfma_f32_16x16x32_bf16 v[180:183], v[104:107], a[44:47], v[180:183]
  ds_read_b64_tr_b16 v[32:33], v8 offset:0
  ds_read_b64_tr_b16 v[34:35], v8 offset:3072
  ds_read_b64_tr_b16 v[56:57], v8 offset:12288
  ds_read_b64_tr_b16 v[58:59], v8 offset:15360
  s_add_u32 s37, s37, 8192
  s_waitcnt lgkmcnt(4)
  v_mfma_f32_16x16x32_bf16 v[136:139], v[84:87], a[40:43], v[136:139]
  ds_read_b64_tr_b16 v[36:37], v9 offset:0
  v_mfma_f32_16x16x32_bf16 v[140:143], v[84:87], a[44:47], v[140:143]
  ds_read_b64_tr_b16 v[38:39], v9 offset:3072
  buffer_load_dwordx4 a[32:35], v6, s[8:11], s41 offen offset:0 sc1
  v_mfma_f32_16x16x32_bf16 v[184:187], v[108:111], a[40:43], v[184:187]
  ds_read_b64_tr_b16 v[60:61], v9 offset:12288
  v_mfma_f32_16x16x32_bf16 v[188:191], v[108:111], a[44:47], v[188:191]
  ds_read_b64_tr_b16 v[62:63], v9 offset:15360
  v_mfma_f32_16x16x32_bf16 v[144:147], v[88:91], a[40:43], v[144:147]
  ds_read_b64_tr_b16 v[40:41], v10 offset:0
  buffer_load_dwordx4 v248, s[20:23], s29 offen offset:0 lds
  v_mfma_f32_16x16x32_bf16 v[148:151], v[88:91], a[44:47], v[148:151]
  ds_read_b64_tr_b16 v[42:43], v10 offset:3072
  v_mfma_f32_16x16x32_bf16 v[192:195], v[112:115], a[40:43], v[192:195]
  ds_read_b64_tr_b16 v[64:65], v10 offset:12288
  v_mfma_f32_16x16x32_bf16 v[196:199], v[112:115], a[44:47], v[196:199]
  ds_read_b64_tr_b16 v[66:67], v10 offset:15360
  buffer_load_dwordx4 a[36:39], v6, s[12:15], s41 offen offset:0 sc1
  v_mfma_f32_16x16x32_bf16 v[152:155], v[92:95], a[40:43], v[152:155]
  ds_read_b64_tr_b16 v[44:45], v11 offset:0
  v_mfma_f32_16x16x32_bf16 v[156:159], v[92:95], a[44:47], v[156:159]
  ds_read_b64_tr_b16 v[46:47], v11 offset:3072
  v_mfma_f32_16x16x32_bf16 v[200:203], v[116:119], a[40:43], v[200:203]
  ds_read_b64_tr_b16 v[68:69], v11 offset:12288
  buffer_load_dwordx4 v249, s[20:23], s29 offen offset:1024 lds
  v_mfma_f32_16x16x32_bf16 v[204:207], v[116:119], a[44:47], v[204:207]
  ds_read_b64_tr_b16 v[70:71], v11 offset:15360
  v_mfma_f32_16x16x32_bf16 v[160:163], v[96:99], a[40:43], v[160:163]
  ds_read_b64_tr_b16 v[48:49], v12 offset:0
  v_mfma_f32_16x16x32_bf16 v[164:167], v[96:99], a[44:47], v[164:167]
  ds_read_b64_tr_b16 v[50:51], v12 offset:3072
  v_mfma_f32_16x16x32_bf16 v[208:211], v[120:123], a[40:43], v[208:211]
  ds_read_b64_tr_b16 v[72:73], v12 offset:12288
  v_mfma_f32_16x16x32_bf16 v[212:215], v[120:123], a[44:47], v[212:215]
  ds_read_b64_tr_b16 v[74:75], v12 offset:15360
  buffer_load_dwordx4 v250, s[20:23], s29 offen offset:2048 lds
  v_mfma_f32_16x16x32_bf16 v[168:171], v[100:103], a[40:43], v[168:171]
  ds_read_b64_tr_b16 v[52:53], v13 offset:0
  s_add_u32 s38, s38, 176128
  v_mfma_f32_16x16x32_bf16 v[172:175], v[100:103], a[44:47], v[172:175]
  ds_read_b64_tr_b16 v[54:55], v13 offset:3072
  s_add_u32 s39, s39, 24576
  v_mfma_f32_16x16x32_bf16 v[216:219], v[124:127], a[40:43], v[216:219]
  ds_read_b64_tr_b16 v[76:77], v13 offset:12288
  s_cmp_ge_u32 s39, 147456
  s_cselect_b32 s39, s44, s39
  v_mfma_f32_16x16x32_bf16 v[220:223], v[124:127], a[44:47], v[220:223]
  ds_read_b64_tr_b16 v[78:79], v13 offset:15360
  s_waitcnt lgkmcnt(4)
  v_mfma_f32_16x16x32_bf16 v[128:131], v[32:35], a[48:51], v[128:131]
  ds_read_b64_tr_b16 v[80:81], v8 offset:6144
  v_mfma_f32_16x16x32_bf16 v[132:135], v[32:35], a[52:55], v[132:135]
  ds_read_b64_tr_b16 v[82:83], v8 offset:9216
  s_add_u32 m0, s39, 0
  v_mfma_f32_16x16x32_bf16 v[176:179], v[56:59], a[48:51], v[176:179]
  ds_read_b64_tr_b16 v[104:105], v8 offset:18432
  s_add_u32 s29, s38, 0
  v_mfma_f32_16x16x32_bf16 v[180:183], v[56:59], a[52:55], v[180:183]
  ds_read_b64_tr_b16 v[106:107], v8 offset:21504
  v_mfma_f32_16x16x32_bf16 v[136:139], v[36:39], a[48:51], v[136:139]
  ds_read_b64_tr_b16 v[84:85], v9 offset:6144
  v_mfma_f32_16x16x32_bf16 v[140:143], v[36:39], a[52:55], v[140:143]
  ds_read_b64_tr_b16 v[86:87], v9 offset:9216
  buffer_load_dwordx4 a[40:43], v6, s[8:11], s41 offen offset:1024 sc1
  v_mfma_f32_16x16x32_bf16 v[184:187], v[60:63], a[48:51], v[184:187]
  ds_read_b64_tr_b16 v[108:109], v9 offset:18432
  v_mfma_f32_16x16x32_bf16 v[188:191], v[60:63], a[52:55], v[188:191]
  ds_read_b64_tr_b16 v[110:111], v9 offset:21504
  v_mfma_f32_16x16x32_bf16 v[144:147], v[40:43], a[48:51], v[144:147]
  ds_read_b64_tr_b16 v[88:89], v10 offset:6144
  buffer_load_dwordx4 v248, s[20:23], s29 offen offset:0 lds
  v_mfma_f32_16x16x32_bf16 v[148:151], v[40:43], a[52:55], v[148:151]
  ds_read_b64_tr_b16 v[90:91], v10 offset:9216
  v_mfma_f32_16x16x32_bf16 v[192:195], v[64:67], a[48:51], v[192:195]
  ds_read_b64_tr_b16 v[112:113], v10 offset:18432
  v_mfma_f32_16x16x32_bf16 v[196:199], v[64:67], a[52:55], v[196:199]
  ds_read_b64_tr_b16 v[114:115], v10 offset:21504
  buffer_load_dwordx4 a[44:47], v6, s[12:15], s41 offen offset:1024 sc1
  v_mfma_f32_16x16x32_bf16 v[152:155], v[44:47], a[48:51], v[152:155]
  ds_read_b64_tr_b16 v[92:93], v11 offset:6144
  v_mfma_f32_16x16x32_bf16 v[156:159], v[44:47], a[52:55], v[156:159]
  ds_read_b64_tr_b16 v[94:95], v11 offset:9216
  v_mfma_f32_16x16x32_bf16 v[200:203], v[68:71], a[48:51], v[200:203]
  ds_read_b64_tr_b16 v[116:117], v11 offset:18432
  buffer_load_dwordx4 v249, s[20:23], s29 offen offset:1024 lds
  v_mfma_f32_16x16x32_bf16 v[204:207], v[68:71], a[52:55], v[204:207]
  ds_read_b64_tr_b16 v[118:119], v11 offset:21504
  v_mfma_f32_16x16x32_bf16 v[160:163], v[48:51], a[48:51], v[160:163]
  ds_read_b64_tr_b16 v[96:97], v12 offset:6144
  v_mfma_f32_16x16x32_bf16 v[164:167], v[48:51], a[52:55], v[164:167]
  ds_read_b64_tr_b16 v[98:99], v12 offset:9216
  v_mfma_f32_16x16x32_bf16 v[208:211], v[72:75], a[48:51], v[208:211]
  ds_read_b64_tr_b16 v[120:121], v12 offset:18432
  v_mfma_f32_16x16x32_bf16 v[212:215], v[72:75], a[52:55], v[212:215]
  ds_read_b64_tr_b16 v[122:123], v12 offset:21504
  buffer_load_dwordx4 v250, s[20:23], s29 offen offset:2048 lds
  s_waitcnt lgkmcnt(5)
  v_mfma_f32_16x16x32_bf16 v[168:171], v[52:55], a[48:51], v[168:171]
  ds_read_b64_tr_b16 v[100:101], v13 offset:6144
  v_mfma_f32_16x16x32_bf16 v[172:175], v[52:55], a[52:55], v[172:175]
  ds_read_b64_tr_b16 v[102:103], v13 offset:9216
  v_mfma_f32_16x16x32_bf16 v[216:219], v[76:79], a[48:51], v[216:219]
  ds_read_b64_tr_b16 v[124:125], v13 offset:18432
  v_mfma_f32_16x16x32_bf16 v[220:223], v[76:79], a[52:55], v[220:223]
  ds_read_b64_tr_b16 v[126:127], v13 offset:21504
  v_mfma_f32_16x16x32_bf16 v[128:131], v[80:83], a[56:59], v[128:131]
  s_waitcnt vmcnt(15)
  s_barrier
  v_add_u32 v8, 0x6000, v8
  v_add_u32 v9, 0x6000, v9
  v_mfma_f32_16x16x32_bf16 v[132:135], v[80:83], a[60:63], v[132:135]
  v_add_u32 v10, 0x6000, v10
  v_add_u32 v11, 0x6000, v11
  s_add_u32 m0, s39, 3072
  v_mfma_f32_16x16x32_bf16 v[176:179], v[104:107], a[56:59], v[176:179]
  v_add_u32 v12, 0x6000, v12
  v_add_u32 v13, 0x6000, v13
  s_add_u32 s29, s38, 44032
  v_mfma_f32_16x16x32_bf16 v[180:183], v[104:107], a[60:63], v[180:183]
  ds_read_b64_tr_b16 v[32:33], v8 offset:0
  ds_read_b64_tr_b16 v[34:35], v8 offset:3072
  ds_read_b64_tr_b16 v[56:57], v8 offset:12288
  ds_read_b64_tr_b16 v[58:59], v8 offset:15360
  v_mfma_f32_16x16x32_bf16 v[136:139], v[84:87], a[56:59], v[136:139]
  ds_read_b64_tr_b16 v[36:37], v9 offset:0
  v_mfma_f32_16x16x32_bf16 v[140:143], v[84:87], a[60:63], v[140:143]
  ds_read_b64_tr_b16 v[38:39], v9 offset:3072
  buffer_load_dwordx4 a[48:51], v6, s[8:11], s41 offen offset:2048 sc1
  v_mfma_f32_16x16x32_bf16 v[184:187], v[108:111], a[56:59], v[184:187]
  ds_read_b64_tr_b16 v[60:61], v9 offset:12288
  v_mfma_f32_16x16x32_bf16 v[188:191], v[108:111], a[60:63], v[188:191]
  ds_read_b64_tr_b16 v[62:63], v9 offset:15360
  v_mfma_f32_16x16x32_bf16 v[144:147], v[88:91], a[56:59], v[144:147]
  ds_read_b64_tr_b16 v[40:41], v10 offset:0
  buffer_load_dwordx4 v248, s[20:23], s29 offen offset:0 lds
  v_mfma_f32_16x16x32_bf16 v[148:151], v[88:91], a[60:63], v[148:151]
  ds_read_b64_tr_b16 v[42:43], v10 offset:3072
  v_mfma_f32_16x16x32_bf16 v[192:195], v[112:115], a[56:59], v[192:195]
  ds_read_b64_tr_b16 v[64:65], v10 offset:12288
  v_mfma_f32_16x16x32_bf16 v[196:199], v[112:115], a[60:63], v[196:199]
  ds_read_b64_tr_b16 v[66:67], v10 offset:15360
  buffer_load_dwordx4 a[52:55], v6, s[12:15], s41 offen offset:2048 sc1
  v_mfma_f32_16x16x32_bf16 v[152:155], v[92:95], a[56:59], v[152:155]
  ds_read_b64_tr_b16 v[44:45], v11 offset:0
  v_mfma_f32_16x16x32_bf16 v[156:159], v[92:95], a[60:63], v[156:159]
  ds_read_b64_tr_b16 v[46:47], v11 offset:3072
  s_waitcnt lgkmcnt(5)
  v_mfma_f32_16x16x32_bf16 v[200:203], v[116:119], a[56:59], v[200:203]
  ds_read_b64_tr_b16 v[68:69], v11 offset:12288
  buffer_load_dwordx4 v249, s[20:23], s29 offen offset:1024 lds
  v_mfma_f32_16x16x32_bf16 v[204:207], v[116:119], a[60:63], v[204:207]
  ds_read_b64_tr_b16 v[70:71], v11 offset:15360
  v_mfma_f32_16x16x32_bf16 v[160:163], v[96:99], a[56:59], v[160:163]
  ds_read_b64_tr_b16 v[48:49], v12 offset:0
  v_mfma_f32_16x16x32_bf16 v[164:167], v[96:99], a[60:63], v[164:167]
  ds_read_b64_tr_b16 v[50:51], v12 offset:3072
  v_mfma_f32_16x16x32_bf16 v[208:211], v[120:123], a[56:59], v[208:211]
  ds_read_b64_tr_b16 v[72:73], v12 offset:12288
  v_mfma_f32_16x16x32_bf16 v[212:215], v[120:123], a[60:63], v[212:215]
  ds_read_b64_tr_b16 v[74:75], v12 offset:15360
  buffer_load_dwordx4 v250, s[20:23], s29 offen offset:2048 lds
  v_mfma_f32_16x16x32_bf16 v[168:171], v[100:103], a[56:59], v[168:171]
  ds_read_b64_tr_b16 v[52:53], v13 offset:0
  s_add_u32 s38, s38, 176128
  v_mfma_f32_16x16x32_bf16 v[172:175], v[100:103], a[60:63], v[172:175]
  ds_read_b64_tr_b16 v[54:55], v13 offset:3072
  s_add_u32 s39, s39, 24576
  v_mfma_f32_16x16x32_bf16 v[216:219], v[124:127], a[56:59], v[216:219]
  ds_read_b64_tr_b16 v[76:77], v13 offset:12288
  s_add_u32 s41, s41, 8192
  v_mfma_f32_16x16x32_bf16 v[220:223], v[124:127], a[60:63], v[220:223]
  ds_read_b64_tr_b16 v[78:79], v13 offset:15360
  s_cmp_lt_u32 s35, 2
  s_cbranch_scc1 adaLN_cond__sliding_block_cached__glu_gated_bilinear__prompt_kernel_p4_loop
  v_lshlrev_b32 v20, 4, v0
  v_mul_f32 v128, v128, v176
  v_mul_f32 v129, v129, v177
  v_mul_f32 v130, v130, v178
  v_mul_f32 v131, v131, v179
  v_cvt_pk_bf16_f32 v32, v128, v129
  v_cvt_pk_bf16_f32 v33, v130, v131
  v_mul_f32 v136, v136, v184
  v_mul_f32 v137, v137, v185
  v_mul_f32 v138, v138, v186
  v_mul_f32 v139, v139, v187
  v_cvt_pk_bf16_f32 v34, v136, v137
  v_cvt_pk_bf16_f32 v35, v138, v139
  s_add_u32 s27, s33, 0
  buffer_store_dwordx4 v[32:35], v20, s[4:7], s27 offen offset:0 sc1
  v_mul_f32 v132, v132, v180
  v_mul_f32 v133, v133, v181
  v_mul_f32 v134, v134, v182
  v_mul_f32 v135, v135, v183
  v_cvt_pk_bf16_f32 v40, v132, v133
  v_cvt_pk_bf16_f32 v41, v134, v135
  v_mul_f32 v140, v140, v188
  v_mul_f32 v141, v141, v189
  v_mul_f32 v142, v142, v190
  v_mul_f32 v143, v143, v191
  s_waitcnt lgkmcnt(0)
  v_cvt_pk_bf16_f32 v42, v140, v141
  v_cvt_pk_bf16_f32 v43, v142, v143
  s_add_u32 s27, s33, 44032
  buffer_store_dwordx4 v[40:43], v20, s[4:7], s27 offen offset:0 sc1
  s_cmp_ge_u32 s26, 14
  s_cbranch_scc1 adaLN_cond__sliding_block_cached__glu_gated_bilinear__prompt_kernel_p4_stored
  v_mul_f32 v144, v144, v192
  v_mul_f32 v145, v145, v193
  v_mul_f32 v146, v146, v194
  v_mul_f32 v147, v147, v195
  v_cvt_pk_bf16_f32 v48, v144, v145
  v_cvt_pk_bf16_f32 v49, v146, v147
  v_mul_f32 v152, v152, v200
  v_mul_f32 v153, v153, v201
  v_mul_f32 v154, v154, v202
  v_mul_f32 v155, v155, v203
  v_cvt_pk_bf16_f32 v50, v152, v153
  v_cvt_pk_bf16_f32 v51, v154, v155
  s_add_u32 s27, s33, 0
  buffer_store_dwordx4 v[48:51], v20, s[4:7], s27 offen offset:1024 sc1
  v_mul_f32 v148, v148, v196
  v_mul_f32 v149, v149, v197
  v_mul_f32 v150, v150, v198
  v_mul_f32 v151, v151, v199
  v_cvt_pk_bf16_f32 v56, v148, v149
  v_cvt_pk_bf16_f32 v57, v150, v151
  v_mul_f32 v156, v156, v204
  v_mul_f32 v157, v157, v205
  v_mul_f32 v158, v158, v206
  v_mul_f32 v159, v159, v207
  v_cvt_pk_bf16_f32 v58, v156, v157
  v_cvt_pk_bf16_f32 v59, v158, v159
  s_add_u32 s27, s33, 44032
  buffer_store_dwordx4 v[56:59], v20, s[4:7], s27 offen offset:1024 sc1
  v_mul_f32 v160, v160, v208
  v_mul_f32 v161, v161, v209
  v_mul_f32 v162, v162, v210
  v_mul_f32 v163, v163, v211
  v_cvt_pk_bf16_f32 v64, v160, v161
  v_cvt_pk_bf16_f32 v65, v162, v163
  v_mul_f32 v168, v168, v216
  v_mul_f32 v169, v169, v217
  v_mul_f32 v170, v170, v218
  v_mul_f32 v171, v171, v219
  v_cvt_pk_bf16_f32 v66, v168, v169
  v_cvt_pk_bf16_f32 v67, v170, v171
  s_add_u32 s27, s33, 0
  buffer_store_dwordx4 v[64:67], v20, s[4:7], s27 offen offset:2048 sc1
  v_mul_f32 v164, v164, v212
  v_mul_f32 v165, v165, v213
  v_mul_f32 v166, v166, v214
  v_mul_f32 v167, v167, v215
  v_cvt_pk_bf16_f32 v72, v164, v165
  v_cvt_pk_bf16_f32 v73, v166, v167
  v_mul_f32 v172, v172, v220
  v_mul_f32 v173, v173, v221
  v_mul_f32 v174, v174, v222
  v_mul_f32 v175, v175, v223
  v_cvt_pk_bf16_f32 v74, v172, v173
  v_cvt_pk_bf16_f32 v75, v174, v175
  s_add_u32 s27, s33, 44032
  buffer_store_dwordx4 v[72:75], v20, s[4:7], s27 offen offset:2048 sc1
adaLN_cond__sliding_block_cached__glu_gated_bilinear__prompt_kernel_p4_stored:
  s_lshl_b32 s60, s25, 7
  s_add_u32 s60, s60, 0x12400
  s_waitcnt vmcnt(0)
  s_barrier
  s_cmp_lg_u32 s3, 0
  s_cbranch_scc1 Lsig33
  s_mov_b64 exec, 1
  v_mov_b32 v255, 1
  buffer_atomic_add v255, off, s[4:7], s60
  s_mov_b64 exec, -1
Lsig33:
  s_and_b32 s23, s2, 7
  s_lshr_b32 s24, s2, 3
  s_lshr_b32 s21, s23, 1
  s_mov_b32 s20, s3
  s_lshl_b32 s21, s21, 3
  s_lshr_b32 s25, s24, 2
  s_add_u32 s21, s21, s25
  s_and_b32 s22, s23, 1
  s_lshl_b32 s22, s22, 2
  s_and_b32 s24, s24, 3
  s_add_u32 s22, s22, s24
  v_lshrrev_b32 v16, 3, v0
  v_and_b32 v17, 7, v0
  v_bfe_u32 v18, v16, 1, 2
  v_lshlrev_b32 v18, 1, v18
  v_xor_b32 v17, v17, v18
  v_lshlrev_b32 v17, 4, v17
  v_lshl_add_u32 v2, v16, 10, v17
  v_lshlrev_b32 v4, 4, v0
  v_add_u32 v5, 44032, v4
  v_add_u32 v6, 88064, v4
  v_add_u32 v7, 132096, v4
  s_mul_i32 s23, s20, 11
  s_lshl_b32 s26, s23, 15
  s_lshl_b32 s24, s22, 7
  s_add_u32 s26, s26, s24
  s_mul_i32 s27, s21, 176128
  s_lshl_b32 s24, s23, 10
  s_add_u32 s27, s27, s24
  s_add_u32 s27, s27, 0x2800000
  s_lshl_b32 s28, s20, 15
  s_mov_b32 s30, s28
  s_cmp_eq_u32 s20, 3
  s_cselect_b32 s32, 10, 11
  s_mov_b32 s29, 0
  s_mov_b32 s8, s80
  s_mov_b32 s9, s81
  s_mov_b32 s10, 0x158000
  s_mov_b32 s11, 0x20000
  s_mov_b32 s16, s86
  s_mov_b32 s17, s87
  s_mov_b32 s18, 0x200000
  s_mov_b32 s19, 0x20000
  v_bfe_u32 v16, v0, 2, 2
  v_lshrrev_b32 v17, 4, v0
  v_lshl_add_u32 v17, v17, 2, v16
  v_bfe_u32 v18, v17, 1, 2
  v_lshlrev_b32 v17, 7, v17
  v_and_b32 v19, 3, v0
  v_lshl_add_u32 v17, v19, 3, v17
  v_xor_b32 v19, 0, v18
  v_lshlrev_b32 v19, 5, v19
  v_add3_u32 v8, v19, v17, s28
  v_xor_b32 v19, 1, v18
  v_lshlrev_b32 v19, 5, v19
  v_add3_u32 v9, v19, v17, s28
  v_xor_b32 v19, 2, v18
  v_lshlrev_b32 v19, 5, v19
  v_add3_u32 v10, v19, v17, s28
  v_xor_b32 v19, 3, v18
  v_lshlrev_b32 v19, 5, v19
  v_add3_u32 v11, v19, v17, s28
  v_add_u32 v12, s28, v4
  v_mov_b32 v64, 0
  v_mov_b32 v65, 0
  v_mov_b32 v66, 0
  v_mov_b32 v67, 0
  v_mov_b32 v68, 0
  v_mov_b32 v69, 0
  v_mov_b32 v70, 0
  v_mov_b32 v71, 0
  v_mov_b32 v72, 0
  v_mov_b32 v73, 0
  v_mov_b32 v74, 0
  v_mov_b32 v75, 0
  v_mov_b32 v76, 0
  v_mov_b32 v77, 0
  v_mov_b32 v78, 0
  v_mov_b32 v79, 0
  v_mov_b32 v80, 0
  v_mov_b32 v81, 0
  v_mov_b32 v82, 0
  v_mov_b32 v83, 0
  v_mov_b32 v84, 0
  v_mov_b32 v85, 0
  v_mov_b32 v86, 0
  v_mov_b32 v87, 0
  v_mov_b32 v88, 0
  v_mov_b32 v89, 0
  v_mov_b32 v90, 0
  v_mov_b32 v91, 0
  v_mov_b32 v92, 0
  v_mov_b32 v93, 0
  v_mov_b32 v94, 0
  v_mov_b32 v95, 0
  v_mov_b32 v96, 0
  v_mov_b32 v97, 0
  v_mov_b32 v98, 0
  v_mov_b32 v99, 0
  v_mov_b32 v100, 0
  v_mov_b32 v101, 0
  v_mov_b32 v102, 0
  v_mov_b32 v103, 0
  v_mov_b32 v104, 0
  v_mov_b32 v105, 0
  v_mov_b32 v106, 0
  v_mov_b32 v107, 0
  v_mov_b32 v108, 0
  v_mov_b32 v109, 0
  v_mov_b32 v110, 0
  v_mov_b32 v111, 0
  v_mov_b32 v112, 0
  v_mov_b32 v113, 0
  v_mov_b32 v114, 0
  v_mov_b32 v115, 0
  v_mov_b32 v116, 0
  v_mov_b32 v117, 0
  v_mov_b32 v118, 0
  v_mov_b32 v119, 0
  v_mov_b32 v120, 0
  v_mov_b32 v121, 0
  v_mov_b32 v122, 0
  v_mov_b32 v123, 0
  v_mov_b32 v124, 0
  v_mov_b32 v125, 0
  v_mov_b32 v126, 0
  v_mov_b32 v127, 0
  s_mov_b32 s33, 0
  s_mov_b32 s34, 8192
  s_mov_b32 s31, 8192
  s_lshr_b32 s24, s21, 1
  s_lshl_b32 s63, s24, 7
  s_add_u32 s63, s63, 0x12400
  s_mov_b32 s35, s26
  s_add_u32 m0, s28, 0
  s_add_u32 s25, s35, 0
  buffer_load_dwordx4 v2, s[8:11], s25 offen lds
  s_add_u32 m0, s28, 1024
  s_add_u32 s25, s35, 8192
  buffer_load_dwordx4 v2, s[8:11], s25 offen lds
  s_add_u32 m0, s28, 2048
  s_add_u32 s25, s35, 16384
  buffer_load_dwordx4 v2, s[8:11], s25 offen lds
  s_add_u32 m0, s28, 3072
  s_add_u32 s25, s35, 24576
  buffer_load_dwordx4 v2, s[8:11], s25 offen lds
  s_add_u32 m0, s28, 8192
  s_add_u32 s25, s35, 32768
  buffer_load_dwordx4 v2, s[8:11], s25 offen lds
  s_add_u32 m0, s28, 9216
  s_add_u32 s25, s35, 40960
  buffer_load_dwordx4 v2, s[8:11], s25 offen lds
  s_add_u32 m0, s28, 10240
  s_add_u32 s25, s35, 49152
  buffer_load_dwordx4 v2, s[8:11], s25 offen lds
  s_add_u32 m0, s28, 11264
  s_add_u32 s25, s35, 57344
  buffer_load_dwordx4 v2, s[8:11], s25 offen lds
  s_add_u32 m0, s28, 16384
  s_add_u32 s25, s35, 65536
  buffer_load_dwordx4 v2, s[8:11], s25 offen lds
  s_add_u32 m0, s28, 17408
  s_add_u32 s25, s35, 73728
  buffer_load_dwordx4 v2, s[8:11], s25 offen lds
  s_add_u32 m0, s28, 18432
  s_add_u32 s25, s35, 81920
  buffer_load_dwordx4 v2, s[8:11], s25 offen lds
  s_add_u32 m0, s28, 19456
  s_add_u32 s25, s35, 90112
  buffer_load_dwordx4 v2, s[8:11], s25 offen lds
  s_branch adaLN_cond__sliding_block_cached__glu_gated_bilinear__prompt_kernel_p5_wait
adaLN_cond__sliding_block_cached__glu_gated_bilinear__prompt_kernel_p4_idle:
  s_and_b32 s23, s2, 7
  s_lshr_b32 s24, s2, 3
  s_lshr_b32 s21, s23, 1
  s_mov_b32 s20, s3
  s_lshl_b32 s21, s21, 3
  s_lshr_b32 s25, s24, 2
  s_add_u32 s21, s21, s25
  s_and_b32 s22, s23, 1
  s_lshl_b32 s22, s22, 2
  s_and_b32 s24, s24, 3
  s_add_u32 s22, s22, s24
  v_lshrrev_b32 v16, 3, v0
  v_and_b32 v17, 7, v0
  v_bfe_u32 v18, v16, 1, 2
  v_lshlrev_b32 v18, 1, v18
  v_xor_b32 v17, v17, v18
  v_lshlrev_b32 v17, 4, v17
  v_lshl_add_u32 v2, v16, 10, v17
  v_lshlrev_b32 v4, 4, v0
  v_add_u32 v5, 44032, v4
  v_add_u32 v6, 88064, v4
  v_add_u32 v7, 132096, v4
  s_mul_i32 s23, s20, 11
  s_lshl_b32 s26, s23, 15
  s_lshl_b32 s24, s22, 7
  s_add_u32 s26, s26, s24
  s_mul_i32 s27, s21, 176128
  s_lshl_b32 s24, s23, 10
  s_add_u32 s27, s27, s24
  s_add_u32 s27, s27, 0x2800000
  s_lshl_b32 s28, s20, 15
  s_mov_b32 s30, s28
  s_cmp_eq_u32 s20, 3
  s_cselect_b32 s32, 10, 11
  s_mov_b32 s29, 0
  s_mov_b32 s8, s80
  s_mov_b32 s9, s81
  s_mov_b32 s10, 0x158000
  s_mov_b32 s11, 0x20000
  s_mov_b32 s16, s86
  s_mov_b32 s17, s87
  s_mov_b32 s18, 0x200000
  s_mov_b32 s19, 0x20000
  v_bfe_u32 v16, v0, 2, 2
  v_lshrrev_b32 v17, 4, v0
  v_lshl_add_u32 v17, v17, 2, v16
  v_bfe_u32 v18, v17, 1, 2
  v_lshlrev_b32 v17, 7, v17
  v_and_b32 v19, 3, v0
  v_lshl_add_u32 v17, v19, 3, v17
  v_xor_b32 v19, 0, v18
  v_lshlrev_b32 v19, 5, v19
  v_add3_u32 v8, v19, v17, s28
  v_xor_b32 v19, 1, v18
  v_lshlrev_b32 v19, 5, v19
  v_add3_u32 v9, v19, v17, s28
  v_xor_b32 v19, 2, v18
  v_lshlrev_b32 v19, 5, v19
  v_add3_u32 v10, v19, v17, s28
  v_xor_b32 v19, 3, v18
  v_lshlrev_b32 v19, 5, v19
  v_add3_u32 v11, v19, v17, s28
  v_add_u32 v12, s28, v4
  v_mov_b32 v64, 0
  v_mov_b32 v65, 0
  v_mov_b32 v66, 0
  v_mov_b32 v67, 0
  v_mov_b32 v68, 0
  v_mov_b32 v69, 0
  v_mov_b32 v70, 0
  v_mov_b32 v71, 0
  v_mov_b32 v72, 0
  v_mov_b32 v73, 0
  v_mov_b32 v74, 0
  v_mov_b32 v75, 0
  v_mov_b32 v76, 0
  v_mov_b32 v77, 0
  v_mov_b32 v78, 0
  v_mov_b32 v79, 0
  v_mov_b32 v80, 0
  v_mov_b32 v81, 0
  v_mov_b32 v82, 0
  v_mov_b32 v83, 0
  v_mov_b32 v84, 0
  v_mov_b32 v85, 0
  v_mov_b32 v86, 0
  v_mov_b32 v87, 0
  v_mov_b32 v88, 0
  v_mov_b32 v89, 0
  v_mov_b32 v90, 0
  v_mov_b32 v91, 0
  v_mov_b32 v92, 0
  v_mov_b32 v93, 0
  v_mov_b32 v94, 0
  v_mov_b32 v95, 0
  v_mov_b32 v96, 0
  v_mov_b32 v97, 0
  v_mov_b32 v98, 0
  v_mov_b32 v99, 0
  v_mov_b32 v100, 0
  v_mov_b32 v101, 0
  v_mov_b32 v102, 0
  v_mov_b32 v103, 0
  v_mov_b32 v104, 0
  v_mov_b32 v105, 0
  v_mov_b32 v106, 0
  v_mov_b32 v107, 0
  v_mov_b32 v108, 0
  v_mov_b32 v109, 0
  v_mov_b32 v110, 0
  v_mov_b32 v111, 0
  v_mov_b32 v112, 0
  v_mov_b32 v113, 0
  v_mov_b32 v114, 0
  v_mov_b32 v115, 0
  v_mov_b32 v116, 0
  v_mov_b32 v117, 0
  v_mov_b32 v118, 0
  v_mov_b32 v119, 0
  v_mov_b32 v120, 0
  v_mov_b32 v121, 0
  v_mov_b32 v122, 0
  v_mov_b32 v123, 0
  v_mov_b32 v124, 0
  v_mov_b32 v125, 0
  v_mov_b32 v126, 0
  v_mov_b32 v127, 0
  s_mov_b32 s33, 0
  s_mov_b32 s34, 8192
  s_mov_b32 s31, 8192
  s_lshr_b32 s24, s21, 1
  s_lshl_b32 s63, s24, 7
  s_add_u32 s63, s63, 0x12400
  s_mov_b32 s35, s26
  s_add_u32 m0, s28, 0
  s_add_u32 s25, s35, 0
  buffer_load_dwordx4 v2, s[8:11], s25 offen lds
  s_add_u32 m0, s28, 1024
  s_add_u32 s25, s35, 8192
  buffer_load_dwordx4 v2, s[8:11], s25 offen lds
  s_add_u32 m0, s28, 2048
  s_add_u32 s25, s35, 16384
  buffer_load_dwordx4 v2, s[8:11], s25 offen lds
  s_add_u32 m0, s28, 3072
  s_add_u32 s25, s35, 24576
  buffer_load_dwordx4 v2, s[8:11], s25 offen lds
  s_add_u32 m0, s28, 8192
  s_add_u32 s25, s35, 32768
  buffer_load_dwordx4 v2, s[8:11], s25 offen lds
  s_add_u32 m0, s28, 9216
  s_add_u32 s25, s35, 40960
  buffer_load_dwordx4 v2, s[8:11], s25 offen lds
  s_add_u32 m0, s28, 10240
  s_add_u32 s25, s35, 49152
  buffer_load_dwordx4 v2, s[8:11], s25 offen lds
  s_add_u32 m0, s28, 11264
  s_add_u32 s25, s35, 57344
  buffer_load_dwordx4 v2, s[8:11], s25 offen lds
  s_add_u32 m0, s28, 16384
  s_add_u32 s25, s35, 65536
  buffer_load_dwordx4 v2, s[8:11], s25 offen lds
  s_add_u32 m0, s28, 17408
  s_add_u32 s25, s35, 73728
  buffer_load_dwordx4 v2, s[8:11], s25 offen lds
  s_add_u32 m0, s28, 18432
  s_add_u32 s25, s35, 81920
  buffer_load_dwordx4 v2, s[8:11], s25 offen lds
  s_add_u32 m0, s28, 19456
  s_add_u32 s25, s35, 90112
  buffer_load_dwordx4 v2, s[8:11], s25 offen lds
adaLN_cond__sliding_block_cached__glu_gated_bilinear__prompt_kernel_p5_wait:
  s_cmp_lg_u32 s3, 0
  s_cbranch_scc1 Lgot35
  s_mov_b32 s61, 100000
Lpoll34:
  buffer_load_dword v255, off, s[4:7], s63 sc1
  s_waitcnt vmcnt(0)
  v_readfirstlane_b32 s62, v255
  s_nop 3
  s_cmp_ge_u32 s62, 15
  s_cbranch_scc1 Lgot35
  s_sub_u32 s61, s61, 1
  s_cmp_lg_u32 s61, 0
  s_cbranch_scc1 Lpoll34
Lgot35:
  s_barrier
  s_waitcnt vmcnt(0)
  s_add_u32 m0, s28, 4096
  s_add_u32 s25, s27, 0
  buffer_load_dwordx4 v4, s[4:7], s25 offen sc1 lds
  s_add_u32 m0, s28, 5120
  s_add_u32 s25, s27, 0
  buffer_load_dwordx4 v5, s[4:7], s25 offen sc1 lds
  s_add_u32 m0, s28, 6144
  s_add_u32 s25, s27, 0
  buffer_load_dwordx4 v6, s[4:7], s25 offen sc1 lds
  s_add_u32 m0, s28, 7168
  s_add_u32 s25, s27, 0
  buffer_load_dwordx4 v7, s[4:7], s25 offen sc1 lds
  s_add_u32 m0, s28, 12288
  s_add_u32 s25, s27, 1024
  buffer_load_dwordx4 v4, s[4:7], s25 offen sc1 lds
  s_add_u32 m0, s28, 13312
  s_add_u32 s25, s27, 1024
  buffer_load_dwordx4 v5, s[4:7], s25 offen sc1 lds
  s_add_u32 m0, s28, 14336
  s_add_u32 s25, s27, 1024
  buffer_load_dwordx4 v6, s[4:7], s25 offen sc1 lds
  s_add_u32 m0, s28, 15360
  s_add_u32 s25, s27, 1024
  buffer_load_dwordx4 v7, s[4:7], s25 offen sc1 lds
  s_add_u32 m0, s28, 20480
  s_add_u32 s25, s27, 2048
  buffer_load_dwordx4 v4, s[4:7], s25 offen sc1 lds
  s_add_u32 m0, s28, 21504
  s_add_u32 s25, s27, 2048
  buffer_load_dwordx4 v5, s[4:7], s25 offen sc1 lds
  s_add_u32 m0, s28, 22528
  s_add_u32 s25, s27, 2048
  buffer_load_dwordx4 v6, s[4:7], s25 offen sc1 lds
  s_add_u32 m0, s28, 23552
  s_add_u32 s25, s27, 2048
  buffer_load_dwordx4 v7, s[4:7], s25 offen sc1 lds
  s_lshl_b32 s23, s21, 2
  s_add_u32 s23, s23, s20
  s_lshl_b32 s24, s23, 14
  s_lshl_b32 s25, s22, 11
  s_add_u32 s24, s24, s25
  s_add_u32 s24, s24, 0x2400000
  buffer_load_dwordx4 v[192:195], v4, s[4:7], s24 offen offset:0 sc1
  buffer_load_dwordx4 v[196:199], v4, s[4:7], s24 offen offset:1024 sc1
  v_lshrrev_b32 v216, 4, v0
  v_lshlrev_b32 v216, 4, v216
  s_lshl_b32 s36, s22, 8
  s_add_u32 s36, s36, 10240
  buffer_load_dwordx4 v[200:203], v216, s[4:7], s36 offen offset:0 sc1
  buffer_load_dwordx4 v[204:207], v216, s[4:7], s36 offen offset:64 sc1
  buffer_load_dwordx4 v[208:211], v216, s[4:7], s36 offen offset:128 sc1
  buffer_load_dwordx4 v[212:215], v216, s[4:7], s36 offen offset:192 sc1
  s_mov_b32 s29, 3
  s_add_u32 s26, s26, 98304
  s_add_u32 s27, s27, 3072
  s_add_u32 s30, s28, 24576
  s_waitcnt vmcnt(10)
adaLN_cond__sliding_block_cached__glu_gated_bilinear__prompt_kernel_p5_loop:
  s_waitcnt vmcnt(16)
  ds_read_b64_tr_b16 v[32:33], v8 offset:0
  ds_read_b64_tr_b16 v[34:35], v8 offset:2048
  ds_read_b128 v[48:51], v12 offset:4096
  ds_read_b128 v[52:55], v12 offset:5120
  ds_read_b128 v[56:59], v12 offset:6144
  ds_read_b128 v[60:63], v12 offset:7168
  ds_read_b64_tr_b16 v[36:37], v9 offset:0
  ds_read_b64_tr_b16 v[38:39], v9 offset:2048
  ds_read_b64_tr_b16 v[40:41], v10 offset:0
  ds_read_b64_tr_b16 v[42:43], v10 offset:2048
  ds_read_b64_tr_b16 v[44:45], v11 offset:0
  ds_read_b64_tr_b16 v[46:47], v11 offset:2048
  s_add_u32 m0, s30, 0
  s_add_u32 s25, s26, 0
  buffer_load_dwordx4 v2, s[8:11], s25 offen lds
  s_add_u32 m0, s30, 1024
  s_add_u32 s25, s26, 8192
  buffer_load_dwordx4 v2, s[8:11], s25 offen lds
  s_waitcnt lgkmcnt(5)
  v_mfma_f32_16x16x32_bf16 v[64:67], v[32:35], v[48:51], v[64:67]
  s_add_u32 m0, s30, 2048
  s_add_u32 s25, s26, 16384
  buffer_load_dwordx4 v2, s[8:11], s25 offen lds
  v_mfma_f32_16x16x32_bf16 v[68:71], v[32:35], v[52:55], v[68:71]
  v_mfma_f32_16x16x32_bf16 v[72:75], v[32:35], v[56:59], v[72:75]
  s_add_u32 m0, s30, 3072
  s_add_u32 s25, s26, 24576
  buffer_load_dwordx4 v2, s[8:11], s25 offen lds
  v_mfma_f32_16x16x32_bf16 v[76:79], v[32:35], v[60:63], v[76:79]
  v_add_u32 v8, s31, v8
  s_waitcnt lgkmcnt(0)
  v_mfma_f32_16x16x32_bf16 v[80:83], v[36:39], v[48:51], v[80:83]
  s_add_u32 m0, s30, 4096
  s_nop 0
  buffer_load_dwordx4 v4, s[4:7], s27 offen sc1 lds
  v_mfma_f32_16x16x32_bf16 v[84:87], v[36:39], v[52:55], v[84:87]
  v_add_u32 v12, s31, v12
  v_mfma_f32_16x16x32_bf16 v[88:91], v[36:39], v[56:59], v[88:91]
  s_add_u32 m0, s30, 5120
  s_nop 0
  buffer_load_dwordx4 v5, s[4:7], s27 offen sc1 lds
  v_mfma_f32_16x16x32_bf16 v[92:95], v[36:39], v[60:63], v[92:95]
  v_add_u32 v9, s31, v9
  v_mfma_f32_16x16x32_bf16 v[96:99], v[40:43], v[48:51], v[96:99]
  s_add_u32 m0, s30, 6144
  s_nop 0
  buffer_load_dwordx4 v6, s[4:7], s27 offen sc1 lds
  v_mfma_f32_16x16x32_bf16 v[100:103], v[40:43], v[52:55], v[100:103]
  v_mfma_f32_16x16x32_bf16 v[104:107], v[40:43], v[56:59], v[104:107]
  s_add_u32 m0, s30, 7168
  s_nop 0
  buffer_load_dwordx4 v7, s[4:7], s27 offen sc1 lds
  v_mfma_f32_16x16x32_bf16 v[108:111], v[40:43], v[60:63], v[108:111]
  v_add_u32 v10, s31, v10
  v_mfma_f32_16x16x32_bf16 v[112:115], v[44:47], v[48:51], v[112:115]
  s_sub_u32 s30, s30, s28
  s_add_u32 s29, s29, 1
  s_add_u32 s26, s26, 32768
  s_add_u32 s27, s27, 1024
  v_mfma_f32_16x16x32_bf16 v[116:119], v[44:47], v[52:55], v[116:119]
  s_cmp_ge_u32 s29, s32
  s_cselect_b32 s26, 0x10000000, s26
  s_cselect_b32 s27, 0x10000000, s27
  v_mfma_f32_16x16x32_bf16 v[120:123], v[44:47], v[56:59], v[120:123]
  s_add_u32 s30, s30, 8192
  s_and_b32 s30, s30, 0x7fff
  s_add_u32 s30, s30, s28
  v_mfma_f32_16x16x32_bf16 v[124:127], v[44:47], v[60:63], v[124:127]
  v_add_u32 v11, s31, v11
  s_add_u32 s33, s33, 1
  s_and_b32 s24, s33, 3
  s_cmp_eq_u32 s24, 3
  s_cselect_b32 s31, 0xffffa000, s34
  s_cmp_lt_u32 s33, 11
  s_cbranch_scc1 adaLN_cond__sliding_block_cached__glu_gated_bilinear__prompt_kernel_p5_loop
  v_max3_u32 v19, v200, v201, v202
  v_max3_u32 v19, v19, v203, v204
  v_max3_u32 v19, v19, v205, v206
  v_max3_u32 v19, v19, v207, v208
  v_max3_u32 v19, v19, v209, v210
  v_max3_u32 v19, v19, v211, v212
  v_max3_u32 v19, v19, v213, v214
  v_max_u32 v19, v19, v215
  v_cmp_eq_u32 vcc, -1, v19
  s_nop 2
  s_cmp_eq_u64 vcc, 0
  s_cbranch_scc1 Lchk36
  s_mov_b32 s61, 100000
Lmod37:
  buffer_load_dwordx4 v[200:203], v216, s[4:7], s36 offen offset:0 sc1
  buffer_load_dwordx4 v[204:207], v216, s[4:7], s36 offen offset:64 sc1
  buffer_load_dwordx4 v[208:211], v216, s[4:7], s36 offen offset:128 sc1
  buffer_load_dwordx4 v[212:215], v216, s[4:7], s36 offen offset:192 sc1
  s_waitcnt vmcnt(0)
  v_max3_u32 v19, v200, v201, v202
  v_max3_u32 v19, v19, v203, v204
  v_max3_u32 v19, v19, v205, v206
  v_max3_u32 v19, v19, v207, v208
  v_max3_u32 v19, v19, v209, v210
  v_max3_u32 v19, v19, v211, v212
  v_max3_u32 v19, v19, v213, v214
  v_max_u32 v19, v19, v215
  v_cmp_eq_u32 vcc, -1, v19
  s_nop 4
  s_cmp_eq_u64 vcc, 0
  s_cbranch_scc1 Lmodok38
  s_sub_u32 s61, s61, 1
  s_cmp_lg_u32 s61, 0
  s_cbranch_scc1 Lmod37
Lmodok38:
Lchk36:
  s_waitcnt vmcnt(0)
  s_barrier
  s_lshl_b32 s24, s20, 12
  v_add_u32 v17, s24, v4
  ds_write_b128 v17, v[64:67] offset:0
  ds_write_b128 v17, v[80:83] offset:1024
  ds_write_b128 v17, v[96:99] offset:2048
  ds_write_b128 v17, v[112:115] offset:3072
  ds_write_b128 v17, v[68:71] offset:16384
  ds_write_b128 v17, v[84:87] offset:17408
  ds_write_b128 v17, v[100:103] offset:18432
  ds_write_b128 v17, v[116:119] offset:19456
  ds_write_b128 v17, v[72:75] offset:32768
  ds_write_b128 v17, v[88:91] offset:33792
  ds_write_b128 v17, v[104:107] offset:34816
  ds_write_b128 v17, v[120:123] offset:35840
  ds_write_b128 v17, v[76:79] offset:49152
  ds_write_b128 v17, v[92:95] offset:50176
  ds_write_b128 v17, v[108:111] offset:51200
  ds_write_b128 v17, v[124:127] offset:52224
  s_waitcnt lgkmcnt(0)
  s_barrier
  s_lshl_b32 s24, s20, 14
  v_add_u32 v17, s24, v4
  ds_read_b128 v[128:131], v17 offset:0
  ds_read_b128 v[132:135], v17 offset:1024
  ds_read_b128 v[136:139], v17 offset:2048
  ds_read_b128 v[140:143], v17 offset:3072
  ds_read_b128 v[144:147], v17 offset:4096
  ds_read_b128 v[148:151], v17 offset:5120
  ds_read_b128 v[152:155], v17 offset:6144
  ds_read_b128 v[156:159], v17 offset:7168
  ds_read_b128 v[160:163], v17 offset:8192
  ds_read_b128 v[164:167], v17 offset:9216
  ds_read_b128 v[168:171], v17 offset:10240
  ds_read_b128 v[172:175], v17 offset:11264
  ds_read_b128 v[176:179], v17 offset:12288
  ds_read_b128 v[180:183], v17 offset:13312
  ds_read_b128 v[184:187], v17 offset:14336
  ds_read_b128 v[188:191], v17 offset:15360
  s_waitcnt lgkmcnt(11)
  v_add_f32 v128, v128, v144
  s_waitcnt lgkmcnt(3)
  v_add_f32 v160, v160, v176
  v_add_f32 v129, v129, v145
  v_add_f32 v161, v161, v177
  v_add_f32 v130, v130, v146
  v_add_f32 v162, v162, v178
  v_add_f32 v131, v131, v147
  v_add_f32 v163, v163, v179
  v_add_f32 v132, v132, v148
  s_waitcnt lgkmcnt(2)
  v_add_f32 v164, v164, v180
  v_add_f32 v133, v133, v149
  v_add_f32 v165, v165, v181
  v_add_f32 v134, v134, v150
  v_add_f32 v166, v166, v182
  v_add_f32 v135, v135, v151
  v_add_f32 v167, v167, v183
  v_add_f32 v136, v136, v152
  s_waitcnt lgkmcnt(0)
  v_add_f32 v168, v168, v184
  v_add_f32 v137, v137, v153
  v_add_f32 v169, v169, v185
  v_add_f32 v138, v138, v154
  v_add_f32 v170, v170, v186
  v_add_f32 v139, v139, v155
  v_add_f32 v171, v171, v187
  v_add_f32 v140, v140, v156
  v_add_f32 v172, v172, v188
  v_add_f32 v141, v141, v157
  v_add_f32 v173, v173, v189
  v_add_f32 v142, v142, v158
  v_add_f32 v174, v174, v190
  v_add_f32 v143, v143, v159
  v_add_f32 v175, v175, v191
  v_add_f32 v128, v128, v160
  v_add_f32 v129, v129, v161
  v_add_f32 v130, v130, v162
  v_add_f32 v131, v131, v163
  v_add_f32 v132, v132, v164
  v_add_f32 v133, v133, v165
  v_add_f32 v134, v134, v166
  v_add_f32 v135, v135, v167
  v_add_f32 v136, v136, v168
  v_add_f32 v137, v137, v169
  v_add_f32 v138, v138, v170
  v_add_f32 v139, v139, v171
  v_add_f32 v140, v140, v172
  v_add_f32 v141, v141, v173
  v_add_f32 v142, v142, v174
  v_add_f32 v143, v143, v175
  v_lshlrev_b32 v96, 16, v192
  v_and_b32 v97, s100, v192
  v_lshlrev_b32 v98, 16, v193
  v_and_b32 v99, s100, v193
  v_lshlrev_b32 v100, 16, v194
  v_and_b32 v101, s100, v194
  v_lshlrev_b32 v102, 16, v195
  v_and_b32 v103, s100, v195
  v_lshlrev_b32 v104, 16, v196
  v_and_b32 v105, s100, v196
  v_lshlrev_b32 v106, 16, v197
  v_and_b32 v107, s100, v197
  v_lshlrev_b32 v108, 16, v198
  v_and_b32 v109, s100, v198
  v_lshlrev_b32 v110, 16, v199
  v_and_b32 v111, s100, v199
  v_fmac_f32 v96, v200, v128
  v_fmac_f32 v97, v201, v129
  v_fmac_f32 v98, v202, v130
  v_fmac_f32 v99, v203, v131
  v_fmac_f32 v100, v204, v132
  v_fmac_f32 v101, v205, v133
  v_fmac_f32 v102, v206, v134
  v_fmac_f32 v103, v207, v135
  v_fmac_f32 v104, v208, v136
  v_fmac_f32 v105, v209, v137
  v_fmac_f32 v106, v210, v138
  v_fmac_f32 v107, v211, v139
  v_fmac_f32 v108, v212, v140
  v_fmac_f32 v109, v213, v141
  v_fmac_f32 v110, v214, v142
  v_fmac_f32 v111, v215, v143
  v_cvt_pk_bf16_f32 v112, v96, v97
  v_cvt_pk_bf16_f32 v113, v98, v99
  v_cvt_pk_bf16_f32 v114, v100, v101
  v_cvt_pk_bf16_f32 v115, v102, v103
  v_cvt_pk_bf16_f32 v116, v104, v105
  v_cvt_pk_bf16_f32 v117, v106, v107
  v_cvt_pk_bf16_f32 v118, v108, v109
  v_cvt_pk_bf16_f32 v119, v110, v111
  v_permlane16_swap_b32 v112, v114
  v_permlane16_swap_b32 v113, v115
  v_permlane16_swap_b32 v116, v118
  v_permlane16_swap_b32 v117, v119
  v_and_b32 v16, 15, v0
  v_lshlrev_b32 v16, 10, v16
  v_bfe_u32 v17, v0, 4, 1
  v_lshlrev_b32 v17, 5, v17
  v_lshrrev_b32 v18, 5, v0
  v_lshlrev_b32 v18, 4, v18
  v_add3_u32 v16, v16, v17, v18
  s_lshl_b32 s24, s23, 14
  s_lshl_b32 s25, s22, 7
  s_add_u32 s24, s24, s25
  buffer_store_dwordx4 v[112:115], v16, s[16:19], s24 offen offset:0
  buffer_store_dwordx4 v[116:119], v16, s[16:19], s24 offen offset:64
  s_endpgm
adaLN_cond__sliding_block_cached__glu_gated_bilinear__prompt_kernel_fallback:
  s_waitcnt vmcnt(0) lgkmcnt(0)
  s_barrier
  v_add_u32 v24, 0xffff8000, v24
  v_add_u32 v25, 0xffff8000, v25
  v_add_u32 v26, 0xffff8000, v26
  v_add_u32 v27, 0xffff8000, v27
  v_add_u32 v16, 0xffff4000, v16
  v_add_u32 v17, 0xffff4000, v17
  v_add_u32 v18, 0xffff4000, v18
  v_add_u32 v19, 0xffff4000, v19
  v_add_u32 v20, 0xffff4000, v20
  v_add_u32 v21, 0xffff4000, v21
  v_add_u32 v22, 0xffff4000, v22
  v_add_u32 v23, 0xffff4000, v23
  v_mov_b32 v212, 0xff800000
  v_mov_b32 v213, 0xff800000
  v_mov_b32 v214, 0xff800000
  v_mov_b32 v215, 0xff800000
  s_mov_b32 s42, 0
adaLN_cond__sliding_block_cached__glu_gated_bilinear__prompt_kernel_fb_loop:
  s_lshl_b32 s46, s42, 14
  s_add_u32 s46, s46, s29
  s_mov_b32 m0, s29
  s_nop 0
  buffer_load_dwordx4 v6, s[12:15], s46 offen offset:0 lds
  buffer_load_dwordx4 v7, s[12:15], s46 offen offset:1024 lds
  buffer_load_dwordx4 v8, s[12:15], s46 offen offset:2048 lds
  buffer_load_dwordx4 v9, s[12:15], s46 offen offset:3072 lds
  s_waitcnt vmcnt(0)
  s_barrier
  ds_read_b128 a[128:131], v24 offset:0
  ds_read_b128 a[132:135], v25 offset:0
  ds_read_b128 a[136:139], v26 offset:0
  ds_read_b128 a[140:143], v27 offset:0
  ds_read_b128 a[144:147], v24 offset:4096
  ds_read_b128 a[148:151], v25 offset:4096
  ds_read_b128 a[152:155], v26 offset:4096
  ds_read_b128 a[156:159], v27 offset:4096
  s_waitcnt lgkmcnt(7)
  v_mfma_f32_16x16x32_bf16 v[128:131], a[128:131], v[64:67], 0
  s_waitcnt lgkmcnt(6)
  v_mfma_f32_16x16x32_bf16 v[128:131], a[132:135], v[68:71], v[128:131]
  s_waitcnt lgkmcnt(5)
  v_mfma_f32_16x16x32_bf16 v[128:131], a[136:139], v[72:75], v[128:131]
  s_waitcnt lgkmcnt(4)
  v_mfma_f32_16x16x32_bf16 v[128:131], a[140:143], v[76:79], v[128:131]
  s_waitcnt lgkmcnt(3)
  v_mfma_f32_16x16x32_bf16 v[132:135], a[144:147], v[64:67], 0
  s_waitcnt lgkmcnt(2)
  v_mfma_f32_16x16x32_bf16 v[132:135], a[148:151], v[68:71], v[132:135]
  s_waitcnt lgkmcnt(1)
  v_mfma_f32_16x16x32_bf16 v[132:135], a[152:155], v[72:75], v[132:135]
  s_waitcnt lgkmcnt(0)
  v_mfma_f32_16x16x32_bf16 v[132:135], a[156:159], v[76:79], v[132:135]
  v_mfma_f32_16x16x32_bf16 v[136:139], a[128:131], v[80:83], 0
  v_mfma_f32_16x16x32_bf16 v[136:139], a[132:135], v[84:87], v[136:139]
  v_mfma_f32_16x16x32_bf16 v[136:139], a[136:139], v[88:91], v[136:139]
  v_mfma_f32_16x16x32_bf16 v[136:139], a[140:143], v[92:95], v[136:139]
  v_mfma_f32_16x16x32_bf16 v[140:143], a[144:147], v[80:83], 0
  v_mfma_f32_16x16x32_bf16 v[140:143], a[148:151], v[84:87], v[140:143]
  v_mfma_f32_16x16x32_bf16 v[140:143], a[152:155], v[88:91], v[140:143]
  v_mfma_f32_16x16x32_bf16 v[140:143], a[156:159], v[92:95], v[140:143]
  v_mfma_f32_16x16x32_bf16 v[144:147], a[128:131], v[96:99], 0
  v_mfma_f32_16x16x32_bf16 v[144:147], a[132:135], v[100:103], v[144:147]
  v_mfma_f32_16x16x32_bf16 v[144:147], a[136:139], v[104:107], v[144:147]
  v_mfma_f32_16x16x32_bf16 v[144:147], a[140:143], v[108:111], v[144:147]
  v_mfma_f32_16x16x32_bf16 v[148:151], a[144:147], v[96:99], 0
  v_mfma_f32_16x16x32_bf16 v[148:151], a[148:151], v[100:103], v[148:151]
  v_mfma_f32_16x16x32_bf16 v[148:151], a[152:155], v[104:107], v[148:151]
  v_mfma_f32_16x16x32_bf16 v[148:151], a[156:159], v[108:111], v[148:151]
  v_mfma_f32_16x16x32_bf16 v[152:155], a[128:131], v[112:115], 0
  v_mfma_f32_16x16x32_bf16 v[152:155], a[132:135], v[116:119], v[152:155]
  v_mfma_f32_16x16x32_bf16 v[152:155], a[136:139], v[120:123], v[152:155]
  v_mfma_f32_16x16x32_bf16 v[152:155], a[140:143], v[124:127], v[152:155]
  v_mfma_f32_16x16x32_bf16 v[156:159], a[144:147], v[112:115], 0
  v_mfma_f32_16x16x32_bf16 v[156:159], a[148:151], v[116:119], v[156:159]
  v_mfma_f32_16x16x32_bf16 v[156:159], a[152:155], v[120:123], v[156:159]
  v_mfma_f32_16x16x32_bf16 v[156:159], a[156:159], v[124:127], v[156:159]
  v_max3_f32 v212, v212, v128, v129
  v_max3_f32 v212, v212, v130, v131
  v_max3_f32 v212, v212, v132, v133
  v_max3_f32 v212, v212, v134, v135
  v_max3_f32 v213, v213, v136, v137
  v_max3_f32 v213, v213, v138, v139
  v_max3_f32 v213, v213, v140, v141
  v_max3_f32 v213, v213, v142, v143
  v_max3_f32 v214, v214, v144, v145
  v_max3_f32 v214, v214, v146, v147
  v_max3_f32 v214, v214, v148, v149
  v_max3_f32 v214, v214, v150, v151
  v_max3_f32 v215, v215, v152, v153
  v_max3_f32 v215, v215, v154, v155
  v_max3_f32 v215, v215, v156, v157
  v_max3_f32 v215, v215, v158, v159
  ds_read_b128 a[128:131], v24 offset:8192
  ds_read_b128 a[132:135], v25 offset:8192
  ds_read_b128 a[136:139], v26 offset:8192
  ds_read_b128 a[140:143], v27 offset:8192
  ds_read_b128 a[144:147], v24 offset:12288
  ds_read_b128 a[148:151], v25 offset:12288
  ds_read_b128 a[152:155], v26 offset:12288
  ds_read_b128 a[156:159], v27 offset:12288
  s_waitcnt lgkmcnt(7)
  v_mfma_f32_16x16x32_bf16 v[128:131], a[128:131], v[64:67], 0
  s_waitcnt lgkmcnt(6)
  v_mfma_f32_16x16x32_bf16 v[128:131], a[132:135], v[68:71], v[128:131]
  s_waitcnt lgkmcnt(5)
  v_mfma_f32_16x16x32_bf16 v[128:131], a[136:139], v[72:75], v[128:131]
  s_waitcnt lgkmcnt(4)
  v_mfma_f32_16x16x32_bf16 v[128:131], a[140:143], v[76:79], v[128:131]
  s_waitcnt lgkmcnt(3)
  v_mfma_f32_16x16x32_bf16 v[132:135], a[144:147], v[64:67], 0
  s_waitcnt lgkmcnt(2)
  v_mfma_f32_16x16x32_bf16 v[132:135], a[148:151], v[68:71], v[132:135]
  s_waitcnt lgkmcnt(1)
  v_mfma_f32_16x16x32_bf16 v[132:135], a[152:155], v[72:75], v[132:135]
  s_waitcnt lgkmcnt(0)
  v_mfma_f32_16x16x32_bf16 v[132:135], a[156:159], v[76:79], v[132:135]
  v_mfma_f32_16x16x32_bf16 v[136:139], a[128:131], v[80:83], 0
  v_mfma_f32_16x16x32_bf16 v[136:139], a[132:135], v[84:87], v[136:139]
  v_mfma_f32_16x16x32_bf16 v[136:139], a[136:139], v[88:91], v[136:139]
  v_mfma_f32_16x16x32_bf16 v[136:139], a[140:143], v[92:95], v[136:139]
  v_mfma_f32_16x16x32_bf16 v[140:143], a[144:147], v[80:83], 0
  v_mfma_f32_16x16x32_bf16 v[140:143], a[148:151], v[84:87], v[140:143]
  v_mfma_f32_16x16x32_bf16 v[140:143], a[152:155], v[88:91], v[140:143]
  v_mfma_f32_16x16x32_bf16 v[140:143], a[156:159], v[92:95], v[140:143]
  v_mfma_f32_16x16x32_bf16 v[144:147], a[128:131], v[96:99], 0
  v_mfma_f32_16x16x32_bf16 v[144:147], a[132:135], v[100:103], v[144:147]
  v_mfma_f32_16x16x32_bf16 v[144:147], a[136:139], v[104:107], v[144:147]
  v_mfma_f32_16x16x32_bf16 v[144:147], a[140:143], v[108:111], v[144:147]
  v_mfma_f32_16x16x32_bf16 v[148:151], a[144:147], v[96:99], 0
  v_mfma_f32_16x16x32_bf16 v[148:151], a[148:151], v[100:103], v[148:151]
  v_mfma_f32_16x16x32_bf16 v[148:151], a[152:155], v[104:107], v[148:151]
  v_mfma_f32_16x16x32_bf16 v[148:151], a[156:159], v[108:111], v[148:151]
  v_mfma_f32_16x16x32_bf16 v[152:155], a[128:131], v[112:115], 0
  v_mfma_f32_16x16x32_bf16 v[152:155], a[132:135], v[116:119], v[152:155]
  v_mfma_f32_16x16x32_bf16 v[152:155], a[136:139], v[120:123], v[152:155]
  v_mfma_f32_16x16x32_bf16 v[152:155], a[140:143], v[124:127], v[152:155]
  v_mfma_f32_16x16x32_bf16 v[156:159], a[144:147], v[112:115], 0
  v_mfma_f32_16x16x32_bf16 v[156:159], a[148:151], v[116:119], v[156:159]
  v_mfma_f32_16x16x32_bf16 v[156:159], a[152:155], v[120:123], v[156:159]
  v_mfma_f32_16x16x32_bf16 v[156:159], a[156:159], v[124:127], v[156:159]
  v_max3_f32 v212, v212, v128, v129
  v_max3_f32 v212, v212, v130, v131
  v_max3_f32 v212, v212, v132, v133
  v_max3_f32 v212, v212, v134, v135
  v_max3_f32 v213, v213, v136, v137
  v_max3_f32 v213, v213, v138, v139
  v_max3_f32 v213, v213, v140, v141
  v_max3_f32 v213, v213, v142, v143
  v_max3_f32 v214, v214, v144, v145
  v_max3_f32 v214, v214, v146, v147
  v_max3_f32 v214, v214, v148, v149
  v_max3_f32 v214, v214, v150, v151
  v_max3_f32 v215, v215, v152, v153
  v_max3_f32 v215, v215, v154, v155
  v_max3_f32 v215, v215, v156, v157
  v_max3_f32 v215, v215, v158, v159
  s_waitcnt lgkmcnt(0)
  s_barrier
  s_add_u32 s42, s42, 1
  s_cmp_lt_u32 s42, 8
  s_cbranch_scc1 adaLN_cond__sliding_block_cached__glu_gated_bilinear__prompt_kernel_fb_loop
  v_mov_b32 v40, v212
  s_nop 1
  v_permlane16_swap_b32 v212, v40
  v_max_f32 v212, v212, v40
  v_mov_b32 v40, v212
  s_nop 1
  v_permlane32_swap_b32 v212, v40
  v_max_f32 v212, v212, v40
  v_mov_b32 v41, v213
  s_nop 1
  v_permlane16_swap_b32 v213, v41
  v_max_f32 v213, v213, v41
  v_mov_b32 v41, v213
  s_nop 1
  v_permlane32_swap_b32 v213, v41
  v_max_f32 v213, v213, v41
  v_mov_b32 v42, v214
  s_nop 1
  v_permlane16_swap_b32 v214, v42
  v_max_f32 v214, v214, v42
  v_mov_b32 v42, v214
  s_nop 1
  v_permlane32_swap_b32 v214, v42
  v_max_f32 v214, v214, v42
  v_mov_b32 v43, v215
  s_nop 1
  v_permlane16_swap_b32 v215, v43
  v_max_f32 v215, v215, v43
  v_mov_b32 v43, v215
  s_nop 1
  v_permlane32_swap_b32 v215, v43
  v_max_f32 v215, v215, v43
  s_mov_b32 s44, 1
  s_add_u32 m0, s29, 131072
  s_add_u32 s46, s29, 0
  buffer_load_dwordx4 v6, s[12:15], s46 offen offset:0 lds
  buffer_load_dwordx4 v7, s[12:15], s46 offen offset:1024 lds
  buffer_load_dwordx4 v8, s[12:15], s46 offen offset:2048 lds
  buffer_load_dwordx4 v9, s[12:15], s46 offen offset:3072 lds
  s_add_u32 m0, s29, 147456
  s_nop 0
  buffer_load_dwordx4 v10, s[16:19], s46 offen offset:0 lds
  buffer_load_dwordx4 v11, s[16:19], s46 offen offset:1024 lds
  buffer_load_dwordx4 v10, s[16:19], s46 offen offset:2048 lds
  buffer_load_dwordx4 v11, s[16:19], s46 offen offset:3072 lds
  s_waitcnt vmcnt(0)
  s_branch adaLN_cond__sliding_block_cached__glu_gated_bilinear__prompt_kernel_attn
adaLN_cond__sliding_block_cached__glu_gated_bilinear__prompt_kernel_end:
  s_endpgm

.section .rodata,"a"
.p2align 6
.amdhsa_kernel adaLN_cond__sliding_block_cached__glu_gated_bilinear__prompt_kernel
  .amdhsa_next_free_vgpr 512
  .amdhsa_next_free_sgpr 102
  .amdhsa_accum_offset 256
  .amdhsa_group_segment_fixed_size 0
  .amdhsa_kernarg_size 112
  .amdhsa_user_sgpr_count 2
  .amdhsa_user_sgpr_kernarg_segment_ptr 1
  .amdhsa_system_sgpr_workgroup_id_x 1
  .amdhsa_float_denorm_mode_32 3
.end_amdhsa_kernel
```
